```python
import torch

def _softmax(x, axis=-1):
    return torch.softmax(x, dim=axis)
def _gelu(x):
    return torch.nn.functional.gelu(x, approximate="tanh")
def _silu(x):
    return torch.nn.functional.silu(x)
def _sigmoid(x):
    return torch.sigmoid(x)
def _layernorm(x, axis=-1, eps=1e-5):
    m = x.mean(dim=axis, keepdim=True)
    v = x.var(dim=axis, keepdim=True, unbiased=False)
    return (x - m) / torch.sqrt(v + eps)
def _scatter_add(tgt, idx, src, axis=0):
    return tgt.clone().index_add_(axis, idx, src)
def _segment_sum(src, seg, n):
    out = torch.zeros((n,) + src.shape[1:], dtype=src.dtype)
    return out.index_add_(0, seg, src)
def _pad(x, pw):
    flat = tuple(v for pair in reversed(pw) for v in pair)
    return torch.nn.functional.pad(x, flat)

kernel_name = 'interleave_layers__sliding_local_dilated__glu_gated_bilinear__prompt'

def setup_inputs():

    _w = (lambda a: (lambda t: t.to(torch.bfloat16) if t.is_floating_point() else t)(torch.as_tensor(a)))
    def _A_setup():
        B, S, D = 1, 2048, 640
        return {
            "x": _w((lambda *s: torch.randn(*s, dtype=torch.bfloat16) * 0.05)(B, S, D)),
            "wqkv": _w((lambda *s: torch.randn(*s, dtype=torch.bfloat16) * 0.05)(D, 3 * D)),
            "wo": _w((lambda *s: torch.randn(*s, dtype=torch.bfloat16) * 0.05)(D, D)),
        }
    _A_in = _A_setup()

    def _B_setup():
        B, S, D, F = 1, 2048, 640, 1728
        return {
            "x": _w((lambda *s: torch.randn(*s, dtype=torch.bfloat16) * 0.05)(B, S, D)),
            "w_gate": _w((lambda *s: torch.randn(*s, dtype=torch.bfloat16) * 0.8)(D, F) * (D ** -0.5)),
            "w_up": _w((lambda *s: torch.randn(*s, dtype=torch.bfloat16) * 0.8)(D, F) * (D ** -0.5)),
            "w_down": _w((lambda *s: torch.randn(*s, dtype=torch.bfloat16) * 0.8)(F, D) * (F ** -0.5)),
        }
    _B_in = _B_setup()

    return {
        "A_x": _A_in["x"],
        "A_wqkv": _A_in["wqkv"],
        "A_wo": _A_in["wo"],
        "B_x": _B_in["x"],
        "B_w_gate": _B_in["w_gate"],
        "B_w_up": _B_in["w_up"],
        "B_w_down": _B_in["w_down"],
    }

def reference(A_x, A_wqkv, A_wo, B_x, B_w_gate, B_w_up, B_w_down):
    def _A_ref(x, wqkv, wo):
        B, S, D = x.shape
        H = 32; Dh = D // H
        W, dil = 8, 2
        qkv = (lambda x, *d: x.permute(*d))((x @ wqkv).reshape(B, S, 3, H, Dh), 2, 0, 3, 1, 4)
        q, k, v = qkv[0], qkv[1], qkv[2]
        scale = Dh ** -0.5
        pos = torch.arange(S)
        off = torch.arange(W) * dil
        idx = pos[:, None] - off[None, :]
        mask = idx >= 0
        idx_c = torch.where(mask, idx, 0).reshape(-1)
        kg = k[:, :, idx_c, :].reshape(B, H, S, W, Dh)
        vg = v[:, :, idx_c, :].reshape(B, H, S, W, Dh)
        logits = torch.einsum("bhsd,bhswd->bhsw", q, kg) * scale
        logits = torch.where(mask[None, None, :, :], logits, -1e9)
        attn = _softmax(logits, axis=-1)
        o = torch.einsum("bhsw,bhswd->bhsd", attn, vg)
        return (lambda x, *d: x.permute(*d))(o, 0, 2, 1, 3).reshape(B, S, D) @ wo

    def _B_ref(x, w_gate, w_up, w_down):
        g = torch.einsum("bsd,df->bsf", x, w_gate)
        u = torch.einsum("bsd,df->bsf", x, w_up)
        h = g * u
        return torch.einsum("bsf,fd->bsd", h, w_down)

    x = A_x
    x = x + _A_ref(_layernorm(x, axis=-1), A_wqkv, A_wo)
    x = x + _B_ref(_layernorm(x, axis=-1), B_w_gate, B_w_up, B_w_down)
    x = x + _A_ref(_layernorm(x, axis=-1), A_wqkv, A_wo)
    x = x + _B_ref(_layernorm(x, axis=-1), B_w_gate, B_w_up, B_w_down)
    return x
```

```asm
; @launch grid=(256,1,1) block=(256,1,1) lds=163840
.amdgcn_target "amdgcn-amd-amdhsa--gfx950"
.text
.globl interleave_layers__sliding_local_dilated__glu_gated_bilinear__prompt_kernel
.p2align 8
.type interleave_layers__sliding_local_dilated__glu_gated_bilinear__prompt_kernel,@function
interleave_layers__sliding_local_dilated__glu_gated_bilinear__prompt_kernel:
L_start:
    s_cmp_ge_u32 s2, 256
    s_cbranch_scc1 L_end
    s_load_dwordx16 s[32:47], s[0:1], 0
    s_load_dwordx4 s[48:51], s[0:1], 64
    v_and_b32 v1, 63, v0
    v_lshrrev_b32 v2, 6, v0
    s_getpc_b64 s[26:27]
L_pc0:
    s_lshr_b32 s28, s2, 3
    s_lshl_b32 s28, s28, 11
    v_lshlrev_b32 v4, 3, v0
    v_add_u32 v4, s28, v4
    v_min_u32 v4, L_end-L_pc0-4, v4
    v_mov_b32 v5, s27
    v_add_co_u32 v4, vcc, s26, v4
    s_nop 1
    v_addc_co_u32 v5, vcc, 0, v5, vcc
    s_mov_b32 exec_lo, 0x10001
    s_mov_b32 exec_hi, 0x10001
    global_load_dword v136, v[4:5], off
    s_mov_b64 exec, -1
    v_readfirstlane_b32 s23, v2
    s_and_b32 s24, s2, 7
    s_lshr_b32 s22, s2, 3
    s_lshl_b32 s21, s24, 12
    s_lshl_b32 s54, s24, 13
    s_add_u32 s54, s54, 0x20000
    s_waitcnt lgkmcnt(0)
    s_mov_b32 s4, s50
    s_mov_b32 s5, s51
    s_mov_b32 s6, 0x2000000
    s_mov_b32 s7, 0x20000
    s_mov_b32 s16, s48
    s_mov_b32 s17, s49
    s_mov_b32 s18, 0x100
    s_mov_b32 s19, 0x20000
    s_mov_b32 s52, s46
    s_mov_b32 s53, s47
    s_cmp_ge_u32 s22, 8
    s_cbranch_scc1 L_rest
    s_mov_b32 s8, s32
    s_mov_b32 s9, s33
    s_mov_b32 s10, 0x280000
    s_mov_b32 s11, 0x20000
    s_mov_b32 s12, s34
    s_mov_b32 s13, s35
    s_mov_b32 s14, 0x258000
    s_mov_b32 s15, 0x20000
    s_lshl_b32 s25, s24, 5
    s_lshl_b32 s26, s22, 2
    s_add_u32 s25, s25, s26
    s_add_u32 s25, s25, s23
    s_lshl_b32 s80, s25, 12
    s_add_u32 s80, s80, 0x1d00000
    s_sub_u32 s81, s80, 131072
    s_lshl_b32 s83, s25, 7
    s_add_u32 s83, s83, 0x10000
    s_add_u32 s82, s83, 4096
    s_and_b32 s25, s24, 3
    s_cmp_eq_u32 s25, 3
    s_cselect_b32 s82, 0x2000000, s82
    s_cselect_b32 s89, 0, 1
    v_lshrrev_b32 v110, 5, v1
    s_lshl_b32 s25, s23, 2
    v_lshlrev_b32 v111, 1, v110
    v_add_u32 v111, s25, v111
    v_sub_u32 v111, v1, v111
    v_and_b32 v111, 31, v111
    v_mul_u32_u24 v112, 26, v111
    v_lshrrev_b32 v112, 8, v112
    v_mul_u32_u24 v112, 1120, v112
    v_lshl_add_u32 v112, v111, 4, v112
    v_mul_u32_u24 v110, 3840, v110
    v_add_u32 v112, v112, v110
    s_and_b32 s25, s23, 1
    s_lshl_b32 s25, s25, 1
    s_lshr_b32 s26, s23, 1
    s_lshl_b32 s26, s26, 3
    s_add_u32 s25, s25, s26
    s_mul_i32 s25, s25, 3840
    s_mul_i32 s26, s22, 160
    s_add_u32 s25, s25, s26
    v_add_u32 v112, s25, v112
    v_mov_b32 v113, 0x80000000
    v_cmp_gt_u32 vcc, 30, v111
    s_nop 1
    v_cndmask_b32 v128, v113, v112, vcc
    s_lshl_b32 s27, s23, 10
    s_add_u32 s27, s27, 40960
    s_add_u32 m0, s27, 0
    s_mov_b32 s25, 0
    buffer_load_dwordx4 v128, s[12:15], s25 offen lds
    s_add_u32 m0, s27, 4096
    s_mov_b32 s25, 15360
    buffer_load_dwordx4 v128, s[12:15], s25 offen lds
    s_add_u32 m0, s27, 8192
    s_mov_b32 s25, 61440
    buffer_load_dwordx4 v128, s[12:15], s25 offen lds
    s_add_u32 m0, s27, 12288
    s_mov_b32 s25, 76800
    buffer_load_dwordx4 v128, s[12:15], s25 offen lds
    s_and_b32 s25, s23, 1
    s_lshl_b32 s25, s25, 3
    v_lshrrev_b32 v110, 3, v1
    v_add_u32 v110, s25, v110
    v_lshrrev_b32 v111, 1, v110
    v_xor_b32 v111, v1, v111
    v_and_b32 v111, 7, v111
    v_mul_u32_u24 v110, 2560, v110
    v_lshl_add_u32 v110, v111, 4, v110
    s_lshr_b32 s26, s23, 1
    s_mul_i32 s25, s26, 640
    v_add_u32 v4, s25, v110
    s_mul_i32 s25, s26, 10240
    s_and_b32 s26, s23, 1
    s_lshl_b32 s26, s26, 10
    s_add_u32 s25, s25, s26
    s_add_u32 s56, s25, 0
    s_add_u32 s57, s25, 1920
    s_add_u32 s58, s25, 3840
    s_add_u32 s59, s25, 5760
    s_add_u32 s60, s25, 7680
    s_add_u32 s61, s25, 20480
    s_add_u32 s62, s25, 22400
    s_add_u32 s63, s25, 24320
    s_add_u32 s64, s25, 26240
    s_add_u32 s65, s25, 28160
    s_and_b32 s25, s24, 3
    s_cmp_eq_u32 s25, 0
    s_cselect_b32 s79, 1, 0
    s_lshl_b32 s25, s25, 9
    s_lshr_b32 s26, s24, 2
    s_add_u32 s25, s25, s26
    s_add_u32 s25, s25, 480
    s_mul_i32 s76, s25, 1280
    s_sub_u32 s68, s76, 40960
    s_sub_u32 s69, s68, 40960
    s_add_u32 m0, s56, 0
    s_nop 0
    buffer_load_dwordx4 v4, s[8:11], s76 offen offset:0 sc1 lds
    s_add_u32 m0, s56, 20480
    s_nop 0
    buffer_load_dwordx4 v4, s[8:11], s68 offen offset:0 sc1 lds
    s_add_u32 m0, s56, 106496
    s_nop 0
    buffer_load_dwordx4 v4, s[8:11], s69 offen offset:0 sc1 lds
    s_add_u32 m0, s27, 16384
    s_mov_b32 s25, 122880
    buffer_load_dwordx4 v128, s[12:15], s25 offen lds
    s_add_u32 m0, s27, 20480
    s_mov_b32 s25, 138240
    buffer_load_dwordx4 v128, s[12:15], s25 offen lds
    s_add_u32 m0, s27, 24576
    s_mov_b32 s25, 184320
    buffer_load_dwordx4 v128, s[12:15], s25 offen lds
    s_add_u32 m0, s27, 28672
    s_mov_b32 s25, 199680
    buffer_load_dwordx4 v128, s[12:15], s25 offen lds
    s_add_u32 m0, s57, 0
    s_nop 0
    buffer_load_dwordx4 v4, s[8:11], s76 offen offset:128 sc1 lds
    s_add_u32 m0, s57, 20480
    s_nop 0
    buffer_load_dwordx4 v4, s[8:11], s68 offen offset:128 sc1 lds
    s_add_u32 m0, s57, 106496
    s_nop 0
    buffer_load_dwordx4 v4, s[8:11], s69 offen offset:128 sc1 lds
    s_add_u32 m0, s27, 32768
    s_mov_b32 s25, 245760
    buffer_load_dwordx4 v128, s[12:15], s25 offen lds
    s_add_u32 m0, s27, 36864
    s_mov_b32 s25, 261120
    buffer_load_dwordx4 v128, s[12:15], s25 offen lds
    s_add_u32 m0, s27, 40960
    s_mov_b32 s25, 307200
    buffer_load_dwordx4 v128, s[12:15], s25 offen lds
    s_add_u32 m0, s27, 45056
    s_mov_b32 s25, 322560
    buffer_load_dwordx4 v128, s[12:15], s25 offen lds
    s_lshl_b32 s77, s24, 14
    s_add_u32 s77, s77, 0x43c00
    s_add_u32 s73, s54, 1024
    s_mul_i32 s78, s24, 1572864
    s_add_u32 s78, s78, 0x100000
    s_cmp_lg_u32 s79, 0
    s_cselect_b32 s81, 0x2000000, s81
    s_cselect_b32 s90, 0, -1
    s_mov_b32 s84, 0x48244824
    s_mov_b32 s88, 1
    s_lshl_b32 s85, s22, 2
    s_add_u32 s85, s85, s23
    s_mov_b32 s91, 0x3acccccd
    s_mov_b32 s92, 0x3727c5ac
    s_mov_b32 s93, 0x3ea52b5c
    s_mov_b32 s30, 0xffff
    s_mov_b32 s31, 0
    v_lshrrev_b32 v110, 5, v1
    v_lshlrev_b32 v110, 13, v110
    v_bfe_u32 v111, v1, 2, 3
    v_lshl_add_u32 v110, v111, 9, v110
    v_add_u32 v110, 40960, v110
    v_lshlrev_b32 v111, 5, v111
    s_mul_i32 s25, s23, 40
    v_mov_b32 v112, 0x0
    s_mov_b32 exec_lo, 0x22222222
    s_mov_b32 exec_hi, 0x22222222
    v_mov_b32 v112, 0x8
    s_mov_b32 exec_lo, 0x44444444
    s_mov_b32 exec_hi, 0x44444444
    v_mov_b32 v112, 0x10
    s_mov_b32 exec_lo, 0x88888888
    s_mov_b32 exec_hi, 0x88888888
    v_mov_b32 v112, 0x18
    s_mov_b64 exec, -1
    v_add_u32 v112, s25, v112
    v_add_u32 v112, v112, v111
    v_and_b32 v112, 511, v112
    v_add_u32 v102, v112, v110
    v_mov_b32 v112, 0xa0
    s_mov_b32 exec_lo, 0x88888888
    s_mov_b32 exec_hi, 0x88888888
    v_mov_b32 v112, 0xb8
    s_mov_b32 exec_lo, 0x22222222
    s_mov_b32 exec_hi, 0x22222222
    v_mov_b32 v112, 0xa8
    s_mov_b32 exec_lo, 0x44444444
    s_mov_b32 exec_hi, 0x44444444
    v_mov_b32 v112, 0xb0
    s_mov_b64 exec, -1
    v_add_u32 v112, s25, v112
    v_add_u32 v112, v112, v111
    v_and_b32 v112, 511, v112
    v_add_u32 v103, v112, v110
    v_mov_b32 v112, 0x20
    s_mov_b32 exec_lo, 0x44444444
    s_mov_b32 exec_hi, 0x44444444
    v_mov_b32 v112, 0x150
    s_mov_b32 exec_lo, 0x22222222
    s_mov_b32 exec_hi, 0x22222222
    v_mov_b32 v112, 0x148
    s_mov_b32 exec_lo, 0x88888888
    s_mov_b32 exec_hi, 0x88888888
    v_mov_b32 v112, 0x158
    s_mov_b64 exec, -1
    v_add_u32 v112, s25, v112
    v_add_u32 v112, v112, v111
    v_and_b32 v112, 511, v112
    v_add_u32 v104, v112, v110
    v_mov_b32 v112, 0xc0
    s_mov_b32 exec_lo, 0x88888888
    s_mov_b32 exec_hi, 0x88888888
    v_mov_b32 v112, 0x0
    s_mov_b32 exec_lo, 0x22222222
    s_mov_b32 exec_hi, 0x22222222
    v_mov_b32 v112, 0x140
    s_mov_b32 exec_lo, 0x44444444
    s_mov_b32 exec_hi, 0x44444444
    v_mov_b32 v112, 0x160
    s_mov_b64 exec, -1
    v_add_u32 v112, s25, v112
    s_mov_b32 exec_lo, 0x88888888
    s_mov_b32 exec_hi, 0x88888888
    v_mov_b32 v112, 480
    s_mov_b64 exec, -1
    v_add_u32 v112, v112, v111
    v_and_b32 v112, 511, v112
    v_add_u32 v105, v112, v110
    v_and_b32 v110, 15, v1
    v_lshrrev_b32 v111, 1, v110
    v_lshrrev_b32 v112, 4, v1
    v_xor_b32 v111, v111, v112
    v_lshlrev_b32 v110, 7, v110
    v_lshl_add_u32 v2, v111, 4, v110
    v_xor_b32 v3, 64, v2
    v_lshlrev_b32 v5, 4, v1
    v_lshlrev_b32 v6, 7, v1
    v_mov_b32 v110, 0x80000000
    s_mov_b32 exec_lo, 0x7ff
    s_mov_b32 exec_hi, 0x0
    v_mov_b32 v110, 0x0
    s_mov_b64 exec, -1
    v_or_b32 v6, v6, v110
    v_mov_b32 v11, 0x2
    s_mov_b32 exec_lo, 0xff
    s_mov_b32 exec_hi, 0x0
    v_mov_b32 v11, 0x0
    s_mov_b64 exec, -1
    v_mov_b32 v7, 0x80000000
    s_mov_b32 exec_lo, 0x1
    s_mov_b32 exec_hi, 0x0
    v_mov_b32 v7, 0x0
    s_mov_b64 exec, -1
    s_lshl_b32 s25, s22, 2
    s_add_u32 s25, s25, s23
    v_and_b32 v110, 15, v1
    v_lshrrev_b32 v111, 5, v1
    v_bfe_u32 v112, v1, 4, 1
    v_lshlrev_b32 v113, 4, v110
    v_lshl_add_u32 v113, v111, 8, v113
    v_lshl_add_u32 v113, v112, 3, v113
    s_lshl_b32 s26, s25, 9
    v_add_u32 v8, s26, v113
    v_lshlrev_b32 v113, 3, v110
    v_lshl_add_u32 v113, v112, 2, v113
    v_lshl_add_u32 v113, v111, 31, v113
    s_lshl_b32 s26, s25, 7
    s_add_u32 s26, s26, 16384
    v_add_u32 v9, s26, v113
    v_mov_b32 v10, 0x0
    s_mov_b32 exec_lo, 0xffff
    s_mov_b32 exec_hi, 0x0
    v_mov_b32 v10, 0xffffffff
    s_mov_b64 exec, -1
    s_cmp_lg_u32 s79, 0
    s_cselect_b32 s28, 0xff800000, 0
    v_mov_b32 v32, 0xff800000
    s_mov_b32 exec_lo, 0xff000ff
    s_mov_b32 exec_hi, 0xf000ff00
    v_mov_b32 v32, 0x0
    s_mov_b64 exec, -1
    v_mov_b32 v36, 0xff800000
    s_mov_b32 exec_lo, 0x0
    s_mov_b32 exec_hi, 0xf0000
    v_mov_b32 v36, 0x0
    s_mov_b64 exec, -1
    v_or_b32 v40, s28, v36
    v_mov_b32 v28, 0x3f800000
    s_mov_b32 exec_lo, 0x330033
    s_mov_b32 exec_hi, 0x330033
    v_mov_b32 v28, 0x0
    s_mov_b64 exec, -1
    v_mov_b32 v106, 0x3f803f80
    v_mov_b32 v33, 0xff800000
    s_mov_b32 exec_lo, 0x1fe001fe
    s_mov_b32 exec_hi, 0xe000fe00
    v_mov_b32 v33, 0x0
    s_mov_b64 exec, -1
    v_mov_b32 v37, 0xff800000
    s_mov_b32 exec_lo, 0x0
    s_mov_b32 exec_hi, 0x1f0001
    v_mov_b32 v37, 0x0
    s_mov_b64 exec, -1
    v_or_b32 v41, s28, v37
    v_mov_b32 v29, 0x3f800000
    s_mov_b32 exec_lo, 0x330033
    s_mov_b32 exec_hi, 0x330033
    v_mov_b32 v29, 0x0
    s_mov_b64 exec, -1
    v_mov_b32 v107, 0x3f803f80
    v_mov_b32 v34, 0xff800000
    s_mov_b32 exec_lo, 0x3fc003fc
    s_mov_b32 exec_hi, 0xc000fc00
    v_mov_b32 v34, 0x0
    s_mov_b64 exec, -1
    v_mov_b32 v38, 0xff800000
    s_mov_b32 exec_lo, 0x0
    s_mov_b32 exec_hi, 0x3f0003
    v_mov_b32 v38, 0x0
    s_mov_b64 exec, -1
    v_or_b32 v42, s28, v38
    v_mov_b32 v30, 0x3f800000
    s_mov_b32 exec_lo, 0x330033
    s_mov_b32 exec_hi, 0x330033
    v_mov_b32 v30, 0x0
    s_mov_b64 exec, -1
    v_mov_b32 v108, 0x3f803f80
    v_mov_b32 v35, 0xff800000
    s_mov_b32 exec_lo, 0x7f8007f8
    s_mov_b32 exec_hi, 0x8000f800
    v_mov_b32 v35, 0x0
    s_mov_b64 exec, -1
    v_mov_b32 v39, 0xff800000
    s_mov_b32 exec_lo, 0x0
    s_mov_b32 exec_hi, 0x7f0007
    v_mov_b32 v39, 0x0
    s_mov_b64 exec, -1
    v_or_b32 v43, s28, v39
    v_mov_b32 v31, 0x3f800000
    s_mov_b32 exec_lo, 0x330033
    s_mov_b32 exec_hi, 0x330033
    v_mov_b32 v31, 0x0
    s_mov_b64 exec, -1
    v_mov_b32 v109, 0x3f803f80
    v_mov_b32 v12, 0xffffffff
    s_mov_b32 exec_lo, 0xf0000
    s_mov_b32 exec_hi, 0xfff00ff
    v_mov_b32 v12, 0x0
    s_mov_b32 exec_lo, 0x100001
    s_mov_b32 exec_hi, 0x10000100
    v_mov_b32 v12, 0xffff
    s_mov_b64 exec, -1
    v_mov_b32 v13, 0x0
    s_mov_b32 exec_lo, 0xff80fff8
    s_mov_b32 exec_hi, 0x8000f800
    v_mov_b32 v13, 0xffffffff
    s_mov_b32 exec_lo, 0x400004
    s_mov_b32 exec_hi, 0x40000400
    v_mov_b32 v13, 0xffff
    s_mov_b64 exec, -1
    v_mov_b32 v20, 0x0
    s_mov_b32 exec_lo, 0x200000
    s_mov_b32 exec_hi, 0x20000200
    v_mov_b32 v20, 0x3f800000
    s_mov_b32 exec_lo, 0x100000
    s_mov_b32 exec_hi, 0x10000100
    v_mov_b32 v20, 0x3f80
    s_mov_b64 exec, -1
    v_mov_b32 v24, 0x0
    v_mov_b32 v21, 0x0
    s_mov_b32 exec_lo, 0x800000
    s_mov_b32 exec_hi, 0x80000800
    v_mov_b32 v21, 0x3f800000
    s_mov_b32 exec_lo, 0x400000
    s_mov_b32 exec_hi, 0x40000400
    v_mov_b32 v21, 0x3f80
    s_mov_b64 exec, -1
    v_mov_b32 v25, 0x0
    v_mov_b32 v22, 0x0
    s_mov_b32 exec_lo, 0x20000
    s_mov_b32 exec_hi, 0x0
    v_mov_b32 v22, 0x3f800000
    s_mov_b32 exec_lo, 0x10000
    s_mov_b32 exec_hi, 0x0
    v_mov_b32 v22, 0x3f80
    s_mov_b64 exec, -1
    v_mov_b32 v26, 0x0
    s_mov_b32 exec_lo, 0x0
    s_mov_b32 exec_hi, 0x2
    v_mov_b32 v26, 0x3f800000
    s_mov_b32 exec_lo, 0x0
    s_mov_b32 exec_hi, 0x1
    v_mov_b32 v26, 0x3f80
    s_mov_b64 exec, -1
    v_mov_b32 v23, 0x0
    s_mov_b32 exec_lo, 0x80000
    s_mov_b32 exec_hi, 0x0
    v_mov_b32 v23, 0x3f800000
    s_mov_b32 exec_lo, 0x40000
    s_mov_b32 exec_hi, 0x0
    v_mov_b32 v23, 0x3f80
    s_mov_b64 exec, -1
    v_mov_b32 v27, 0x0
    s_mov_b32 exec_lo, 0x0
    s_mov_b32 exec_hi, 0x20
    v_mov_b32 v27, 0x3f800000
    s_mov_b32 exec_lo, 0x0
    s_mov_b32 exec_hi, 0x10
    v_mov_b32 v27, 0x3f80
    s_mov_b64 exec, -1
    v_add_u32 v70, 106496, v2
    v_add_u32 v71, 106496, v3
    s_waitcnt vmcnt(11)
    s_waitcnt lgkmcnt(0)
    s_barrier
    ds_read_b64_tr_b16 a[0:1], v102 offset:0
    ds_read_b64_tr_b16 a[2:3], v102 offset:4096
    ds_read_b64_tr_b16 a[4:5], v103 offset:0
    ds_read_b64_tr_b16 a[6:7], v103 offset:4096
    ds_read_b64_tr_b16 a[8:9], v104 offset:0
    ds_read_b64_tr_b16 a[10:11], v104 offset:4096
    ds_read_b64_tr_b16 a[12:13], v105 offset:0
    ds_read_b64_tr_b16 a[14:15], v105 offset:4096
    ds_read_b128 v[140:143], v2 offset:0
    ds_read_b128 v[144:147], v2 offset:20480
    ds_read_b128 v[148:151], v70 offset:0
    s_cmp_lg_u32 s23, 0
    s_cbranch_scc1 an1_1
    v_mul_u32_u24 v123, s89, v1
    v_add_u32 v123, s24, v123
    v_lshlrev_b32 v123, 5, v123
    s_mov_b64 exec, 3
    buffer_load_dword v122, v123, s[16:19], 0 offen sc1
    s_mov_b64 exec, -1
an1_1:
    s_add_u32 m0, s27, 49152
    s_mov_b32 s25, 368640
    buffer_load_dwordx4 v128, s[12:15], s25 offen lds
    s_add_u32 m0, s27, 53248
    s_mov_b32 s25, 384000
    buffer_load_dwordx4 v128, s[12:15], s25 offen lds
    s_add_u32 m0, s27, 57344
    s_mov_b32 s25, 430080
    buffer_load_dwordx4 v128, s[12:15], s25 offen lds
    s_add_u32 m0, s27, 61440
    s_mov_b32 s25, 445440
    buffer_load_dwordx4 v128, s[12:15], s25 offen lds
    s_waitcnt vmcnt(11)
    s_waitcnt lgkmcnt(0)
    s_barrier
    v_mfma_f32_16x16x32_bf16 v[48:51], a[0:3], v[106:109], 0
    s_add_u32 m0, s58, 0
    ds_read_b64_tr_b16 a[16:17], v102 offset:16384
    ds_read_b64_tr_b16 a[18:19], v102 offset:20480
    v_mfma_f32_16x16x32_bf16 v[52:55], a[4:7], v[106:109], 0
    buffer_load_dwordx4 v4, s[8:11], s76 offen offset:256 sc1 lds
    v_mfma_f32_16x16x32_bf16 v[56:59], a[8:11], v[106:109], 0
    s_add_u32 m0, s58, 20480
    ds_read_b64_tr_b16 a[20:21], v103 offset:16384
    ds_read_b64_tr_b16 a[22:23], v103 offset:20480
    v_mfma_f32_16x16x32_bf16 v[60:63], a[12:15], v[106:109], 0
    buffer_load_dwordx4 v4, s[8:11], s68 offen offset:256 sc1 lds
    v_mfma_f32_16x16x32_bf16 v[160:163], a[0:3], v[140:143], 0
    s_add_u32 m0, s58, 106496
    ds_read_b64_tr_b16 a[24:25], v104 offset:16384
    ds_read_b64_tr_b16 a[26:27], v104 offset:20480
    v_mfma_f32_16x16x32_bf16 v[164:167], a[4:7], v[140:143], 0
    buffer_load_dwordx4 v4, s[8:11], s69 offen offset:256 sc1 lds
    v_mfma_f32_16x16x32_bf16 v[168:171], a[8:11], v[140:143], 0
    s_add_u32 m0, s27, 0
    ds_read_b64_tr_b16 a[28:29], v105 offset:16384
    ds_read_b64_tr_b16 a[30:31], v105 offset:20480
    v_mfma_f32_16x16x32_bf16 v[172:175], a[12:15], v[140:143], 0
    s_mov_b32 s25, 491520
    buffer_load_dwordx4 v128, s[12:15], s25 offen lds
    v_mfma_f32_16x16x32_bf16 v[176:179], a[0:3], v[144:147], 0
    s_add_u32 m0, s27, 4096
    ds_read_b128 v[76:79], v3 offset:0
    ds_read_b128 v[80:83], v3 offset:20480
    v_mfma_f32_16x16x32_bf16 v[180:183], a[4:7], v[144:147], 0
    s_mov_b32 s25, 506880
    buffer_load_dwordx4 v128, s[12:15], s25 offen lds
    v_mfma_f32_16x16x32_bf16 v[184:187], a[8:11], v[144:147], 0
    s_add_u32 m0, s27, 8192
    ds_read_b128 v[84:87], v71 offset:0
    s_mov_b32 s25, 552960
    v_mfma_f32_16x16x32_bf16 v[188:191], a[12:15], v[144:147], 0
    buffer_load_dwordx4 v128, s[12:15], s25 offen lds
    v_mfma_f32_16x16x32_bf16 v[110:113], a[0:3], v[148:151], 0
    s_add_u32 m0, s27, 12288
    s_mov_b32 s25, 568320
    v_mfma_f32_16x16x32_bf16 v[114:117], a[4:7], v[148:151], 0
    buffer_load_dwordx4 v128, s[12:15], s25 offen lds
    v_mfma_f32_16x16x32_bf16 v[96:99], a[8:11], v[148:151], 0
    v_mfma_f32_16x16x32_bf16 v[44:47], a[12:15], v[148:151], 0
    s_waitcnt vmcnt(11)
    s_waitcnt lgkmcnt(0)
    s_barrier
    v_mfma_f32_16x16x32_bf16 v[48:51], a[16:19], v[106:109], v[48:51]
    s_add_u32 m0, s27, 16384
    ds_read_b64_tr_b16 a[32:33], v102 offset:32768
    ds_read_b64_tr_b16 a[34:35], v102 offset:36864
    v_mfma_f32_16x16x32_bf16 v[52:55], a[20:23], v[106:109], v[52:55]
    s_mov_b32 s25, 614400
    buffer_load_dwordx4 v128, s[12:15], s25 offen lds
    v_mfma_f32_16x16x32_bf16 v[56:59], a[24:27], v[106:109], v[56:59]
    s_add_u32 m0, s27, 20480
    ds_read_b64_tr_b16 a[36:37], v103 offset:32768
    ds_read_b64_tr_b16 a[38:39], v103 offset:36864
    v_mfma_f32_16x16x32_bf16 v[60:63], a[28:31], v[106:109], v[60:63]
    s_mov_b32 s25, 629760
    buffer_load_dwordx4 v128, s[12:15], s25 offen lds
    v_mfma_f32_16x16x32_bf16 v[160:163], a[16:19], v[76:79], v[160:163]
    s_add_u32 m0, s27, 24576
    ds_read_b64_tr_b16 a[40:41], v104 offset:32768
    ds_read_b64_tr_b16 a[42:43], v104 offset:36864
    v_mfma_f32_16x16x32_bf16 v[164:167], a[20:23], v[76:79], v[164:167]
    s_mov_b32 s25, 675840
    buffer_load_dwordx4 v128, s[12:15], s25 offen lds
    v_mfma_f32_16x16x32_bf16 v[168:171], a[24:27], v[76:79], v[168:171]
    s_add_u32 m0, s27, 28672
    ds_read_b64_tr_b16 a[44:45], v105 offset:32768
    ds_read_b64_tr_b16 a[46:47], v105 offset:36864
    v_mfma_f32_16x16x32_bf16 v[172:175], a[28:31], v[76:79], v[172:175]
    s_mov_b32 s25, 691200
    buffer_load_dwordx4 v128, s[12:15], s25 offen lds
    v_mfma_f32_16x16x32_bf16 v[176:179], a[16:19], v[80:83], v[176:179]
    ds_read_b128 v[140:143], v2 offset:2048
    ds_read_b128 v[144:147], v2 offset:22528
    v_mfma_f32_16x16x32_bf16 v[180:183], a[20:23], v[80:83], v[180:183]
    ds_read_b128 v[148:151], v70 offset:2048
    v_mfma_f32_16x16x32_bf16 v[184:187], a[24:27], v[80:83], v[184:187]
    v_mfma_f32_16x16x32_bf16 v[188:191], a[28:31], v[80:83], v[188:191]
    v_mfma_f32_16x16x32_bf16 v[110:113], a[16:19], v[84:87], v[110:113]
    v_mfma_f32_16x16x32_bf16 v[114:117], a[20:23], v[84:87], v[114:117]
    v_mfma_f32_16x16x32_bf16 v[96:99], a[24:27], v[84:87], v[96:99]
    v_mfma_f32_16x16x32_bf16 v[44:47], a[28:31], v[84:87], v[44:47]
    s_waitcnt vmcnt(11)
    s_waitcnt lgkmcnt(0)
    s_barrier
    ds_read_b64_tr_b16 a[48:49], v102 offset:49152
    ds_read_b64_tr_b16 a[50:51], v102 offset:53248
    ds_read_b64_tr_b16 a[52:53], v103 offset:49152
    ds_read_b64_tr_b16 a[54:55], v103 offset:53248
    ds_read_b64_tr_b16 a[56:57], v104 offset:49152
    ds_read_b64_tr_b16 a[58:59], v104 offset:53248
    ds_read_b64_tr_b16 a[60:61], v105 offset:49152
    ds_read_b64_tr_b16 a[62:63], v105 offset:53248
    ds_read_b128 v[76:79], v3 offset:2048
    ds_read_b128 v[80:83], v3 offset:22528
    ds_read_b128 v[84:87], v71 offset:2048
    s_cmp_lg_u32 s23, 0
    s_cbranch_scc1 an2_2
    s_mov_b32 s29, 0
    s_branch gse_5
gs_3:
    v_mul_u32_u24 v123, s89, v1
    v_add_u32 v123, s24, v123
    v_lshlrev_b32 v123, 5, v123
    s_mov_b64 exec, 3
    buffer_load_dword v122, v123, s[16:19], 0 offen sc1
    s_mov_b64 exec, -1
    s_waitcnt vmcnt(0)
gse_5:
    s_mov_b64 exec, 3
    v_cmp_eq_u32 vcc, 0, v122
    s_mov_b64 exec, -1
    s_nop 1
    s_cbranch_vccz gsd_4
    s_sleep 2
    s_add_u32 s29, s29, 1
    s_cmp_lt_u32 s29, 20000
    s_cbranch_scc1 gs_3
    s_mov_b32 s29, 99
    s_branch L_fail
gsd_4:
    s_cmp_lg_u32 s23, 0
    s_cbranch_scc1 ann_6
    s_getreg_b32 s25, hwreg(HW_REG_XCC_ID, 0, 4)
    s_add_u32 s25, s25, 1
    v_mov_b32 v122, s25
    v_lshlrev_b32 v123, 26, v1
    s_lshr_b32 s26, s2, 3
    s_lshl_b32 s26, s26, 7
    s_add_u32 s26, s26, s21
    s_add_u32 s26, s26, 0x8000
    buffer_store_dword v122, v123, s[4:7], s26 offen sc1
ann_6:
an2_2:
    s_add_u32 m0, s59, 0
    s_nop 0
    buffer_load_dwordx4 v4, s[8:11], s76 offen offset:384 sc1 lds
    s_add_u32 m0, s59, 20480
    s_nop 0
    buffer_load_dwordx4 v4, s[8:11], s68 offen offset:384 sc1 lds
    s_add_u32 m0, s59, 106496
    s_nop 0
    buffer_load_dwordx4 v4, s[8:11], s69 offen offset:384 sc1 lds
    s_add_u32 m0, s27, 32768
    s_mov_b32 s25, 737280
    buffer_load_dwordx4 v128, s[12:15], s25 offen lds
    s_add_u32 m0, s27, 36864
    s_mov_b32 s25, 752640
    buffer_load_dwordx4 v128, s[12:15], s25 offen lds
    s_add_u32 m0, s27, 40960
    s_mov_b32 s25, 798720
    buffer_load_dwordx4 v128, s[12:15], s25 offen lds
    s_add_u32 m0, s27, 45056
    s_mov_b32 s25, 814080
    buffer_load_dwordx4 v128, s[12:15], s25 offen lds
    v_mfma_f32_16x16x32_bf16 v[48:51], a[32:35], v[106:109], v[48:51]
    v_mfma_f32_16x16x32_bf16 v[52:55], a[36:39], v[106:109], v[52:55]
    v_mfma_f32_16x16x32_bf16 v[56:59], a[40:43], v[106:109], v[56:59]
    v_mfma_f32_16x16x32_bf16 v[60:63], a[44:47], v[106:109], v[60:63]
    v_mfma_f32_16x16x32_bf16 v[160:163], a[32:35], v[140:143], v[160:163]
    v_mfma_f32_16x16x32_bf16 v[164:167], a[36:39], v[140:143], v[164:167]
    v_mfma_f32_16x16x32_bf16 v[168:171], a[40:43], v[140:143], v[168:171]
    v_mfma_f32_16x16x32_bf16 v[172:175], a[44:47], v[140:143], v[172:175]
    v_mfma_f32_16x16x32_bf16 v[176:179], a[32:35], v[144:147], v[176:179]
    v_mfma_f32_16x16x32_bf16 v[180:183], a[36:39], v[144:147], v[180:183]
    v_mfma_f32_16x16x32_bf16 v[184:187], a[40:43], v[144:147], v[184:187]
    v_mfma_f32_16x16x32_bf16 v[188:191], a[44:47], v[144:147], v[188:191]
    v_mfma_f32_16x16x32_bf16 v[110:113], a[32:35], v[148:151], v[110:113]
    v_mfma_f32_16x16x32_bf16 v[114:117], a[36:39], v[148:151], v[114:117]
    v_mfma_f32_16x16x32_bf16 v[96:99], a[40:43], v[148:151], v[96:99]
    v_mfma_f32_16x16x32_bf16 v[44:47], a[44:47], v[148:151], v[44:47]
    s_waitcnt vmcnt(11)
    s_waitcnt lgkmcnt(0)
    s_barrier
    v_mfma_f32_16x16x32_bf16 v[48:51], a[48:51], v[106:109], v[48:51]
    s_add_u32 m0, s27, 49152
    ds_read_b64_tr_b16 a[64:65], v102 offset:0
    ds_read_b64_tr_b16 a[66:67], v102 offset:4096
    v_mfma_f32_16x16x32_bf16 v[52:55], a[52:55], v[106:109], v[52:55]
    s_mov_b32 s25, 860160
    buffer_load_dwordx4 v128, s[12:15], s25 offen lds
    v_mfma_f32_16x16x32_bf16 v[56:59], a[56:59], v[106:109], v[56:59]
    s_add_u32 m0, s27, 53248
    ds_read_b64_tr_b16 a[68:69], v103 offset:0
    ds_read_b64_tr_b16 a[70:71], v103 offset:4096
    v_mfma_f32_16x16x32_bf16 v[60:63], a[60:63], v[106:109], v[60:63]
    s_mov_b32 s25, 875520
    buffer_load_dwordx4 v128, s[12:15], s25 offen lds
    v_mfma_f32_16x16x32_bf16 v[160:163], a[48:51], v[76:79], v[160:163]
    s_add_u32 m0, s27, 57344
    ds_read_b64_tr_b16 a[72:73], v104 offset:0
    ds_read_b64_tr_b16 a[74:75], v104 offset:4096
    v_mfma_f32_16x16x32_bf16 v[164:167], a[52:55], v[76:79], v[164:167]
    s_mov_b32 s25, 921600
    buffer_load_dwordx4 v128, s[12:15], s25 offen lds
    v_mfma_f32_16x16x32_bf16 v[168:171], a[56:59], v[76:79], v[168:171]
    s_add_u32 m0, s27, 61440
    ds_read_b64_tr_b16 a[76:77], v105 offset:0
    ds_read_b64_tr_b16 a[78:79], v105 offset:4096
    v_mfma_f32_16x16x32_bf16 v[172:175], a[60:63], v[76:79], v[172:175]
    s_mov_b32 s25, 936960
    buffer_load_dwordx4 v128, s[12:15], s25 offen lds
    v_mfma_f32_16x16x32_bf16 v[176:179], a[48:51], v[80:83], v[176:179]
    ds_read_b128 v[140:143], v2 offset:4096
    ds_read_b128 v[144:147], v2 offset:24576
    v_mfma_f32_16x16x32_bf16 v[180:183], a[52:55], v[80:83], v[180:183]
    ds_read_b128 v[148:151], v70 offset:4096
    v_mfma_f32_16x16x32_bf16 v[184:187], a[56:59], v[80:83], v[184:187]
    v_mfma_f32_16x16x32_bf16 v[188:191], a[60:63], v[80:83], v[188:191]
    v_mfma_f32_16x16x32_bf16 v[110:113], a[48:51], v[84:87], v[110:113]
    v_mfma_f32_16x16x32_bf16 v[114:117], a[52:55], v[84:87], v[114:117]
    v_mfma_f32_16x16x32_bf16 v[96:99], a[56:59], v[84:87], v[96:99]
    v_mfma_f32_16x16x32_bf16 v[44:47], a[60:63], v[84:87], v[44:47]
    s_waitcnt vmcnt(11)
    s_waitcnt lgkmcnt(0)
    s_barrier
    v_mfma_f32_16x16x32_bf16 v[48:51], a[64:67], v[106:109], v[48:51]
    s_add_u32 m0, s60, 0
    ds_read_b64_tr_b16 a[80:81], v102 offset:16384
    ds_read_b64_tr_b16 a[82:83], v102 offset:20480
    v_mfma_f32_16x16x32_bf16 v[52:55], a[68:71], v[106:109], v[52:55]
    buffer_load_dwordx4 v4, s[8:11], s76 offen offset:512 sc1 lds
    v_mfma_f32_16x16x32_bf16 v[56:59], a[72:75], v[106:109], v[56:59]
    s_add_u32 m0, s60, 20480
    ds_read_b64_tr_b16 a[84:85], v103 offset:16384
    ds_read_b64_tr_b16 a[86:87], v103 offset:20480
    v_mfma_f32_16x16x32_bf16 v[60:63], a[76:79], v[106:109], v[60:63]
    buffer_load_dwordx4 v4, s[8:11], s68 offen offset:512 sc1 lds
    v_mfma_f32_16x16x32_bf16 v[160:163], a[64:67], v[140:143], v[160:163]
    s_add_u32 m0, s60, 106496
    ds_read_b64_tr_b16 a[88:89], v104 offset:16384
    ds_read_b64_tr_b16 a[90:91], v104 offset:20480
    v_mfma_f32_16x16x32_bf16 v[164:167], a[68:71], v[140:143], v[164:167]
    buffer_load_dwordx4 v4, s[8:11], s69 offen offset:512 sc1 lds
    v_mfma_f32_16x16x32_bf16 v[168:171], a[72:75], v[140:143], v[168:171]
    s_add_u32 m0, s27, 0
    ds_read_b64_tr_b16 a[92:93], v105 offset:16384
    ds_read_b64_tr_b16 a[94:95], v105 offset:20480
    v_mfma_f32_16x16x32_bf16 v[172:175], a[76:79], v[140:143], v[172:175]
    s_mov_b32 s25, 983040
    buffer_load_dwordx4 v128, s[12:15], s25 offen lds
    v_mfma_f32_16x16x32_bf16 v[176:179], a[64:67], v[144:147], v[176:179]
    s_add_u32 m0, s27, 4096
    ds_read_b128 v[76:79], v3 offset:4096
    ds_read_b128 v[80:83], v3 offset:24576
    v_mfma_f32_16x16x32_bf16 v[180:183], a[68:71], v[144:147], v[180:183]
    s_mov_b32 s25, 998400
    buffer_load_dwordx4 v128, s[12:15], s25 offen lds
    v_mfma_f32_16x16x32_bf16 v[184:187], a[72:75], v[144:147], v[184:187]
    s_add_u32 m0, s27, 8192
    ds_read_b128 v[84:87], v71 offset:4096
    s_mov_b32 s25, 1044480
    v_mfma_f32_16x16x32_bf16 v[188:191], a[76:79], v[144:147], v[188:191]
    buffer_load_dwordx4 v128, s[12:15], s25 offen lds
    v_mfma_f32_16x16x32_bf16 v[110:113], a[64:67], v[148:151], v[110:113]
    s_add_u32 m0, s27, 12288
    s_mov_b32 s25, 1059840
    v_mfma_f32_16x16x32_bf16 v[114:117], a[68:71], v[148:151], v[114:117]
    buffer_load_dwordx4 v128, s[12:15], s25 offen lds
    v_mfma_f32_16x16x32_bf16 v[96:99], a[72:75], v[148:151], v[96:99]
    v_mfma_f32_16x16x32_bf16 v[44:47], a[76:79], v[148:151], v[44:47]
    s_waitcnt vmcnt(11)
    s_waitcnt lgkmcnt(0)
    s_barrier
    v_mfma_f32_16x16x32_bf16 v[48:51], a[80:83], v[106:109], v[48:51]
    s_add_u32 m0, s27, 16384
    ds_read_b64_tr_b16 a[96:97], v102 offset:32768
    ds_read_b64_tr_b16 a[98:99], v102 offset:36864
    v_mfma_f32_16x16x32_bf16 v[52:55], a[84:87], v[106:109], v[52:55]
    s_mov_b32 s25, 1105920
    buffer_load_dwordx4 v128, s[12:15], s25 offen lds
    v_mfma_f32_16x16x32_bf16 v[56:59], a[88:91], v[106:109], v[56:59]
    s_add_u32 m0, s27, 20480
    ds_read_b64_tr_b16 a[100:101], v103 offset:32768
    ds_read_b64_tr_b16 a[102:103], v103 offset:36864
    v_mfma_f32_16x16x32_bf16 v[60:63], a[92:95], v[106:109], v[60:63]
    s_mov_b32 s25, 1121280
    buffer_load_dwordx4 v128, s[12:15], s25 offen lds
    v_mfma_f32_16x16x32_bf16 v[160:163], a[80:83], v[76:79], v[160:163]
    s_add_u32 m0, s27, 24576
    ds_read_b64_tr_b16 a[104:105], v104 offset:32768
    ds_read_b64_tr_b16 a[106:107], v104 offset:36864
    v_mfma_f32_16x16x32_bf16 v[164:167], a[84:87], v[76:79], v[164:167]
    s_mov_b32 s25, 1167360
    buffer_load_dwordx4 v128, s[12:15], s25 offen lds
    v_mfma_f32_16x16x32_bf16 v[168:171], a[88:91], v[76:79], v[168:171]
    s_add_u32 m0, s27, 28672
    ds_read_b64_tr_b16 a[108:109], v105 offset:32768
    ds_read_b64_tr_b16 a[110:111], v105 offset:36864
    v_mfma_f32_16x16x32_bf16 v[172:175], a[92:95], v[76:79], v[172:175]
    s_mov_b32 s25, 1182720
    buffer_load_dwordx4 v128, s[12:15], s25 offen lds
    v_mfma_f32_16x16x32_bf16 v[176:179], a[80:83], v[80:83], v[176:179]
    ds_read_b128 v[140:143], v2 offset:6144
    ds_read_b128 v[144:147], v2 offset:26624
    v_mfma_f32_16x16x32_bf16 v[180:183], a[84:87], v[80:83], v[180:183]
    ds_read_b128 v[148:151], v70 offset:6144
    v_mfma_f32_16x16x32_bf16 v[184:187], a[88:91], v[80:83], v[184:187]
    v_mfma_f32_16x16x32_bf16 v[188:191], a[92:95], v[80:83], v[188:191]
    v_mfma_f32_16x16x32_bf16 v[110:113], a[80:83], v[84:87], v[110:113]
    v_mfma_f32_16x16x32_bf16 v[114:117], a[84:87], v[84:87], v[114:117]
    v_mfma_f32_16x16x32_bf16 v[96:99], a[88:91], v[84:87], v[96:99]
    v_mfma_f32_16x16x32_bf16 v[44:47], a[92:95], v[84:87], v[44:47]
    s_waitcnt vmcnt(11)
    s_waitcnt lgkmcnt(0)
    s_barrier
    v_mfma_f32_16x16x32_bf16 v[48:51], a[96:99], v[106:109], v[48:51]
    s_add_u32 m0, s27, 32768
    ds_read_b64_tr_b16 a[112:113], v102 offset:49152
    ds_read_b64_tr_b16 a[114:115], v102 offset:53248
    v_mfma_f32_16x16x32_bf16 v[52:55], a[100:103], v[106:109], v[52:55]
    s_mov_b32 s25, 1228800
    buffer_load_dwordx4 v128, s[12:15], s25 offen lds
    v_mfma_f32_16x16x32_bf16 v[56:59], a[104:107], v[106:109], v[56:59]
    s_add_u32 m0, s27, 36864
    ds_read_b64_tr_b16 a[116:117], v103 offset:49152
    ds_read_b64_tr_b16 a[118:119], v103 offset:53248
    v_mfma_f32_16x16x32_bf16 v[60:63], a[108:111], v[106:109], v[60:63]
    s_mov_b32 s25, 1244160
    buffer_load_dwordx4 v128, s[12:15], s25 offen lds
    v_mfma_f32_16x16x32_bf16 v[160:163], a[96:99], v[140:143], v[160:163]
    s_add_u32 m0, s27, 40960
    ds_read_b64_tr_b16 a[120:121], v104 offset:49152
    ds_read_b64_tr_b16 a[122:123], v104 offset:53248
    v_mfma_f32_16x16x32_bf16 v[164:167], a[100:103], v[140:143], v[164:167]
    s_mov_b32 s25, 1290240
    buffer_load_dwordx4 v128, s[12:15], s25 offen lds
    v_mfma_f32_16x16x32_bf16 v[168:171], a[104:107], v[140:143], v[168:171]
    s_add_u32 m0, s27, 45056
    ds_read_b64_tr_b16 a[124:125], v105 offset:49152
    ds_read_b64_tr_b16 a[126:127], v105 offset:53248
    v_mfma_f32_16x16x32_bf16 v[172:175], a[108:111], v[140:143], v[172:175]
    s_mov_b32 s25, 1305600
    buffer_load_dwordx4 v128, s[12:15], s25 offen lds
    v_mfma_f32_16x16x32_bf16 v[176:179], a[96:99], v[144:147], v[176:179]
    ds_read_b128 v[76:79], v3 offset:6144
    ds_read_b128 v[80:83], v3 offset:26624
    v_mfma_f32_16x16x32_bf16 v[180:183], a[100:103], v[144:147], v[180:183]
    ds_read_b128 v[84:87], v71 offset:6144
    v_mfma_f32_16x16x32_bf16 v[184:187], a[104:107], v[144:147], v[184:187]
    v_mfma_f32_16x16x32_bf16 v[188:191], a[108:111], v[144:147], v[188:191]
    v_mfma_f32_16x16x32_bf16 v[110:113], a[96:99], v[148:151], v[110:113]
    v_mfma_f32_16x16x32_bf16 v[114:117], a[100:103], v[148:151], v[114:117]
    v_mfma_f32_16x16x32_bf16 v[96:99], a[104:107], v[148:151], v[96:99]
    v_mfma_f32_16x16x32_bf16 v[44:47], a[108:111], v[148:151], v[44:47]
    s_waitcnt vmcnt(8)
    s_waitcnt lgkmcnt(0)
    s_barrier
    v_mfma_f32_16x16x32_bf16 v[48:51], a[112:115], v[106:109], v[48:51]
    s_add_u32 m0, s27, 49152
    ds_read_b64_tr_b16 a[128:129], v102 offset:0
    ds_read_b64_tr_b16 a[130:131], v102 offset:4096
    v_mfma_f32_16x16x32_bf16 v[52:55], a[116:119], v[106:109], v[52:55]
    s_mov_b32 s25, 1351680
    buffer_load_dwordx4 v128, s[12:15], s25 offen lds
    v_mfma_f32_16x16x32_bf16 v[56:59], a[120:123], v[106:109], v[56:59]
    s_add_u32 m0, s27, 53248
    ds_read_b64_tr_b16 a[132:133], v103 offset:0
    ds_read_b64_tr_b16 a[134:135], v103 offset:4096
    v_mfma_f32_16x16x32_bf16 v[60:63], a[124:127], v[106:109], v[60:63]
    s_mov_b32 s25, 1367040
    buffer_load_dwordx4 v128, s[12:15], s25 offen lds
    v_mfma_f32_16x16x32_bf16 v[160:163], a[112:115], v[76:79], v[160:163]
    s_add_u32 m0, s27, 57344
    ds_read_b64_tr_b16 a[136:137], v104 offset:0
    ds_read_b64_tr_b16 a[138:139], v104 offset:4096
    v_mfma_f32_16x16x32_bf16 v[164:167], a[116:119], v[76:79], v[164:167]
    s_mov_b32 s25, 1413120
    buffer_load_dwordx4 v128, s[12:15], s25 offen lds
    v_mfma_f32_16x16x32_bf16 v[168:171], a[120:123], v[76:79], v[168:171]
    s_add_u32 m0, s27, 61440
    ds_read_b64_tr_b16 a[140:141], v105 offset:0
    ds_read_b64_tr_b16 a[142:143], v105 offset:4096
    v_mfma_f32_16x16x32_bf16 v[172:175], a[124:127], v[76:79], v[172:175]
    s_mov_b32 s25, 1428480
    buffer_load_dwordx4 v128, s[12:15], s25 offen lds
    v_mfma_f32_16x16x32_bf16 v[176:179], a[112:115], v[80:83], v[176:179]
    ds_read_b128 v[140:143], v2 offset:8192
    ds_read_b128 v[144:147], v2 offset:28672
    v_mfma_f32_16x16x32_bf16 v[180:183], a[116:119], v[80:83], v[180:183]
    ds_read_b128 v[148:151], v70 offset:8192
    v_mfma_f32_16x16x32_bf16 v[184:187], a[120:123], v[80:83], v[184:187]
    v_mfma_f32_16x16x32_bf16 v[188:191], a[124:127], v[80:83], v[188:191]
    v_mfma_f32_16x16x32_bf16 v[110:113], a[112:115], v[84:87], v[110:113]
    v_mfma_f32_16x16x32_bf16 v[114:117], a[116:119], v[84:87], v[114:117]
    v_mfma_f32_16x16x32_bf16 v[96:99], a[120:123], v[84:87], v[96:99]
    v_mfma_f32_16x16x32_bf16 v[44:47], a[124:127], v[84:87], v[44:47]
    s_waitcnt vmcnt(8)
    s_waitcnt lgkmcnt(0)
    s_barrier
    v_mfma_f32_16x16x32_bf16 v[48:51], a[128:131], v[106:109], v[48:51]
    s_add_u32 m0, s27, 0
    ds_read_b64_tr_b16 a[144:145], v102 offset:16384
    ds_read_b64_tr_b16 a[146:147], v102 offset:20480
    v_mfma_f32_16x16x32_bf16 v[52:55], a[132:135], v[106:109], v[52:55]
    s_mov_b32 s25, 1474560
    buffer_load_dwordx4 v128, s[12:15], s25 offen lds
    v_mfma_f32_16x16x32_bf16 v[56:59], a[136:139], v[106:109], v[56:59]
    s_add_u32 m0, s27, 4096
    ds_read_b64_tr_b16 a[148:149], v103 offset:16384
    ds_read_b64_tr_b16 a[150:151], v103 offset:20480
    v_mfma_f32_16x16x32_bf16 v[60:63], a[140:143], v[106:109], v[60:63]
    s_mov_b32 s25, 1489920
    buffer_load_dwordx4 v128, s[12:15], s25 offen lds
    v_mfma_f32_16x16x32_bf16 v[160:163], a[128:131], v[140:143], v[160:163]
    s_add_u32 m0, s27, 8192
    ds_read_b64_tr_b16 a[152:153], v104 offset:16384
    ds_read_b64_tr_b16 a[154:155], v104 offset:20480
    v_mfma_f32_16x16x32_bf16 v[164:167], a[132:135], v[140:143], v[164:167]
    s_mov_b32 s25, 1536000
    buffer_load_dwordx4 v128, s[12:15], s25 offen lds
    v_mfma_f32_16x16x32_bf16 v[168:171], a[136:139], v[140:143], v[168:171]
    s_add_u32 m0, s27, 12288
    ds_read_b64_tr_b16 a[156:157], v105 offset:16384
    ds_read_b64_tr_b16 a[158:159], v105 offset:20480
    v_mfma_f32_16x16x32_bf16 v[172:175], a[140:143], v[140:143], v[172:175]
    s_mov_b32 s25, 1551360
    buffer_load_dwordx4 v128, s[12:15], s25 offen lds
    v_mfma_f32_16x16x32_bf16 v[176:179], a[128:131], v[144:147], v[176:179]
    ds_read_b128 v[76:79], v3 offset:8192
    ds_read_b128 v[80:83], v3 offset:28672
    v_mfma_f32_16x16x32_bf16 v[180:183], a[132:135], v[144:147], v[180:183]
    ds_read_b128 v[84:87], v71 offset:8192
    v_mfma_f32_16x16x32_bf16 v[184:187], a[136:139], v[144:147], v[184:187]
    v_mfma_f32_16x16x32_bf16 v[188:191], a[140:143], v[144:147], v[188:191]
    v_mfma_f32_16x16x32_bf16 v[110:113], a[128:131], v[148:151], v[110:113]
    v_mfma_f32_16x16x32_bf16 v[114:117], a[132:135], v[148:151], v[114:117]
    v_mfma_f32_16x16x32_bf16 v[96:99], a[136:139], v[148:151], v[96:99]
    v_mfma_f32_16x16x32_bf16 v[44:47], a[140:143], v[148:151], v[44:47]
    s_waitcnt vmcnt(8)
    s_waitcnt lgkmcnt(0)
    s_barrier
    v_mfma_f32_16x16x32_bf16 v[48:51], a[144:147], v[106:109], v[48:51]
    s_add_u32 m0, s27, 16384
    ds_read_b64_tr_b16 a[160:161], v102 offset:32768
    ds_read_b64_tr_b16 a[162:163], v102 offset:36864
    v_mfma_f32_16x16x32_bf16 v[52:55], a[148:151], v[106:109], v[52:55]
    s_mov_b32 s25, 1597440
    buffer_load_dwordx4 v128, s[12:15], s25 offen lds
    v_mfma_f32_16x16x32_bf16 v[56:59], a[152:155], v[106:109], v[56:59]
    s_add_u32 m0, s27, 20480
    ds_read_b64_tr_b16 a[164:165], v103 offset:32768
    ds_read_b64_tr_b16 a[166:167], v103 offset:36864
    v_mfma_f32_16x16x32_bf16 v[60:63], a[156:159], v[106:109], v[60:63]
    s_mov_b32 s25, 1612800
    buffer_load_dwordx4 v128, s[12:15], s25 offen lds
    v_mfma_f32_16x16x32_bf16 v[160:163], a[144:147], v[76:79], v[160:163]
    s_add_u32 m0, s27, 24576
    ds_read_b64_tr_b16 a[168:169], v104 offset:32768
    ds_read_b64_tr_b16 a[170:171], v104 offset:36864
    v_mfma_f32_16x16x32_bf16 v[164:167], a[148:151], v[76:79], v[164:167]
    s_mov_b32 s25, 1658880
    buffer_load_dwordx4 v128, s[12:15], s25 offen lds
    v_mfma_f32_16x16x32_bf16 v[168:171], a[152:155], v[76:79], v[168:171]
    s_add_u32 m0, s27, 28672
    ds_read_b64_tr_b16 a[172:173], v105 offset:32768
    ds_read_b64_tr_b16 a[174:175], v105 offset:36864
    v_mfma_f32_16x16x32_bf16 v[172:175], a[156:159], v[76:79], v[172:175]
    s_mov_b32 s25, 1674240
    buffer_load_dwordx4 v128, s[12:15], s25 offen lds
    v_mfma_f32_16x16x32_bf16 v[176:179], a[144:147], v[80:83], v[176:179]
    ds_read_b128 v[140:143], v2 offset:10240
    ds_read_b128 v[144:147], v2 offset:30720
    v_mfma_f32_16x16x32_bf16 v[180:183], a[148:151], v[80:83], v[180:183]
    ds_read_b128 v[148:151], v70 offset:10240
    v_mfma_f32_16x16x32_bf16 v[184:187], a[152:155], v[80:83], v[184:187]
    v_mfma_f32_16x16x32_bf16 v[188:191], a[156:159], v[80:83], v[188:191]
    v_mfma_f32_16x16x32_bf16 v[110:113], a[144:147], v[84:87], v[110:113]
    v_mfma_f32_16x16x32_bf16 v[114:117], a[148:151], v[84:87], v[114:117]
    v_mfma_f32_16x16x32_bf16 v[96:99], a[152:155], v[84:87], v[96:99]
    v_mfma_f32_16x16x32_bf16 v[44:47], a[156:159], v[84:87], v[44:47]
    s_waitcnt vmcnt(8)
    s_waitcnt lgkmcnt(0)
    s_barrier
    v_mfma_f32_16x16x32_bf16 v[48:51], a[160:163], v[106:109], v[48:51]
    s_add_u32 m0, s27, 32768
    ds_read_b64_tr_b16 a[176:177], v102 offset:49152
    ds_read_b64_tr_b16 a[178:179], v102 offset:53248
    v_mfma_f32_16x16x32_bf16 v[52:55], a[164:167], v[106:109], v[52:55]
    s_mov_b32 s25, 1720320
    buffer_load_dwordx4 v128, s[12:15], s25 offen lds
    v_mfma_f32_16x16x32_bf16 v[56:59], a[168:171], v[106:109], v[56:59]
    s_add_u32 m0, s27, 36864
    ds_read_b64_tr_b16 a[180:181], v103 offset:49152
    ds_read_b64_tr_b16 a[182:183], v103 offset:53248
    v_mfma_f32_16x16x32_bf16 v[60:63], a[172:175], v[106:109], v[60:63]
    s_mov_b32 s25, 1735680
    buffer_load_dwordx4 v128, s[12:15], s25 offen lds
    v_mfma_f32_16x16x32_bf16 v[160:163], a[160:163], v[140:143], v[160:163]
    s_add_u32 m0, s27, 40960
    ds_read_b64_tr_b16 a[184:185], v104 offset:49152
    ds_read_b64_tr_b16 a[186:187], v104 offset:53248
    v_mfma_f32_16x16x32_bf16 v[164:167], a[164:167], v[140:143], v[164:167]
    s_mov_b32 s25, 1781760
    buffer_load_dwordx4 v128, s[12:15], s25 offen lds
    v_mfma_f32_16x16x32_bf16 v[168:171], a[168:171], v[140:143], v[168:171]
    s_add_u32 m0, s27, 45056
    ds_read_b64_tr_b16 a[188:189], v105 offset:49152
    ds_read_b64_tr_b16 a[190:191], v105 offset:53248
    v_mfma_f32_16x16x32_bf16 v[172:175], a[172:175], v[140:143], v[172:175]
    s_mov_b32 s25, 1797120
    buffer_load_dwordx4 v128, s[12:15], s25 offen lds
    v_mfma_f32_16x16x32_bf16 v[176:179], a[160:163], v[144:147], v[176:179]
    ds_read_b128 v[76:79], v3 offset:10240
    ds_read_b128 v[80:83], v3 offset:30720
    v_mfma_f32_16x16x32_bf16 v[180:183], a[164:167], v[144:147], v[180:183]
    ds_read_b128 v[84:87], v71 offset:10240
    v_mfma_f32_16x16x32_bf16 v[184:187], a[168:171], v[144:147], v[184:187]
    v_mfma_f32_16x16x32_bf16 v[188:191], a[172:175], v[144:147], v[188:191]
    v_mfma_f32_16x16x32_bf16 v[110:113], a[160:163], v[148:151], v[110:113]
    v_mfma_f32_16x16x32_bf16 v[114:117], a[164:167], v[148:151], v[114:117]
    v_mfma_f32_16x16x32_bf16 v[96:99], a[168:171], v[148:151], v[96:99]
    v_mfma_f32_16x16x32_bf16 v[44:47], a[172:175], v[148:151], v[44:47]
    s_waitcnt vmcnt(8)
    s_waitcnt lgkmcnt(0)
    s_barrier
    v_mfma_f32_16x16x32_bf16 v[48:51], a[176:179], v[106:109], v[48:51]
    s_add_u32 m0, s27, 49152
    ds_read_b64_tr_b16 a[192:193], v102 offset:0
    ds_read_b64_tr_b16 a[194:195], v102 offset:4096
    v_mfma_f32_16x16x32_bf16 v[52:55], a[180:183], v[106:109], v[52:55]
    s_mov_b32 s25, 1843200
    buffer_load_dwordx4 v128, s[12:15], s25 offen lds
    v_mfma_f32_16x16x32_bf16 v[56:59], a[184:187], v[106:109], v[56:59]
    s_add_u32 m0, s27, 53248
    ds_read_b64_tr_b16 a[196:197], v103 offset:0
    ds_read_b64_tr_b16 a[198:199], v103 offset:4096
    v_mfma_f32_16x16x32_bf16 v[60:63], a[188:191], v[106:109], v[60:63]
    s_mov_b32 s25, 1858560
    buffer_load_dwordx4 v128, s[12:15], s25 offen lds
    v_mfma_f32_16x16x32_bf16 v[160:163], a[176:179], v[76:79], v[160:163]
    s_add_u32 m0, s27, 57344
    ds_read_b64_tr_b16 a[200:201], v104 offset:0
    ds_read_b64_tr_b16 a[202:203], v104 offset:4096
    v_mfma_f32_16x16x32_bf16 v[164:167], a[180:183], v[76:79], v[164:167]
    s_mov_b32 s25, 1904640
    buffer_load_dwordx4 v128, s[12:15], s25 offen lds
    v_mfma_f32_16x16x32_bf16 v[168:171], a[184:187], v[76:79], v[168:171]
    s_add_u32 m0, s27, 61440
    ds_read_b64_tr_b16 a[204:205], v105 offset:0
    ds_read_b64_tr_b16 a[206:207], v105 offset:4096
    v_mfma_f32_16x16x32_bf16 v[172:175], a[188:191], v[76:79], v[172:175]
    s_mov_b32 s25, 1920000
    buffer_load_dwordx4 v128, s[12:15], s25 offen lds
    v_mfma_f32_16x16x32_bf16 v[176:179], a[176:179], v[80:83], v[176:179]
    ds_read_b128 v[140:143], v2 offset:12288
    ds_read_b128 v[144:147], v2 offset:32768
    v_mfma_f32_16x16x32_bf16 v[180:183], a[180:183], v[80:83], v[180:183]
    ds_read_b128 v[148:151], v70 offset:12288
    v_mfma_f32_16x16x32_bf16 v[184:187], a[184:187], v[80:83], v[184:187]
    v_mfma_f32_16x16x32_bf16 v[188:191], a[188:191], v[80:83], v[188:191]
    v_mfma_f32_16x16x32_bf16 v[110:113], a[176:179], v[84:87], v[110:113]
    v_mfma_f32_16x16x32_bf16 v[114:117], a[180:183], v[84:87], v[114:117]
    v_mfma_f32_16x16x32_bf16 v[96:99], a[184:187], v[84:87], v[96:99]
    v_mfma_f32_16x16x32_bf16 v[44:47], a[188:191], v[84:87], v[44:47]
    s_waitcnt vmcnt(8)
    s_waitcnt lgkmcnt(0)
    s_barrier
    v_mfma_f32_16x16x32_bf16 v[48:51], a[192:195], v[106:109], v[48:51]
    s_add_u32 m0, s27, 0
    ds_read_b64_tr_b16 a[208:209], v102 offset:16384
    ds_read_b64_tr_b16 a[210:211], v102 offset:20480
    v_mfma_f32_16x16x32_bf16 v[52:55], a[196:199], v[106:109], v[52:55]
    s_mov_b32 s25, 1966080
    buffer_load_dwordx4 v128, s[12:15], s25 offen lds
    v_mfma_f32_16x16x32_bf16 v[56:59], a[200:203], v[106:109], v[56:59]
    s_add_u32 m0, s27, 4096
    ds_read_b64_tr_b16 a[212:213], v103 offset:16384
    ds_read_b64_tr_b16 a[214:215], v103 offset:20480
    v_mfma_f32_16x16x32_bf16 v[60:63], a[204:207], v[106:109], v[60:63]
    s_mov_b32 s25, 1981440
    buffer_load_dwordx4 v128, s[12:15], s25 offen lds
    v_mfma_f32_16x16x32_bf16 v[160:163], a[192:195], v[140:143], v[160:163]
    s_add_u32 m0, s27, 8192
    ds_read_b64_tr_b16 a[216:217], v104 offset:16384
    ds_read_b64_tr_b16 a[218:219], v104 offset:20480
    v_mfma_f32_16x16x32_bf16 v[164:167], a[196:199], v[140:143], v[164:167]
    s_mov_b32 s25, 2027520
    buffer_load_dwordx4 v128, s[12:15], s25 offen lds
    v_mfma_f32_16x16x32_bf16 v[168:171], a[200:203], v[140:143], v[168:171]
    s_add_u32 m0, s27, 12288
    ds_read_b64_tr_b16 a[220:221], v105 offset:16384
    ds_read_b64_tr_b16 a[222:223], v105 offset:20480
    v_mfma_f32_16x16x32_bf16 v[172:175], a[204:207], v[140:143], v[172:175]
    s_mov_b32 s25, 2042880
    buffer_load_dwordx4 v128, s[12:15], s25 offen lds
    v_mfma_f32_16x16x32_bf16 v[176:179], a[192:195], v[144:147], v[176:179]
    buffer_load_dwordx4 v[122:125], v6, s[4:7], s73 offen sc1
    v_mfma_f32_16x16x32_bf16 v[180:183], a[196:199], v[144:147], v[180:183]
    ds_read_b128 v[76:79], v3 offset:12288
    ds_read_b128 v[80:83], v3 offset:32768
    v_mfma_f32_16x16x32_bf16 v[184:187], a[200:203], v[144:147], v[184:187]
    ds_read_b128 v[84:87], v71 offset:12288
    v_mfma_f32_16x16x32_bf16 v[188:191], a[204:207], v[144:147], v[188:191]
    v_mfma_f32_16x16x32_bf16 v[110:113], a[192:195], v[148:151], v[110:113]
    v_mfma_f32_16x16x32_bf16 v[114:117], a[196:199], v[148:151], v[114:117]
    v_mfma_f32_16x16x32_bf16 v[96:99], a[200:203], v[148:151], v[96:99]
    v_mfma_f32_16x16x32_bf16 v[44:47], a[204:207], v[148:151], v[44:47]
    s_waitcnt vmcnt(9)
    s_waitcnt lgkmcnt(0)
    s_barrier
    v_mfma_f32_16x16x32_bf16 v[48:51], a[208:211], v[106:109], v[48:51]
    s_add_u32 m0, s27, 16384
    ds_read_b64_tr_b16 a[224:225], v102 offset:32768
    ds_read_b64_tr_b16 a[226:227], v102 offset:36864
    v_mfma_f32_16x16x32_bf16 v[52:55], a[212:215], v[106:109], v[52:55]
    s_mov_b32 s25, 2088960
    buffer_load_dwordx4 v128, s[12:15], s25 offen lds
    v_mfma_f32_16x16x32_bf16 v[56:59], a[216:219], v[106:109], v[56:59]
    s_add_u32 m0, s27, 20480
    ds_read_b64_tr_b16 a[228:229], v103 offset:32768
    ds_read_b64_tr_b16 a[230:231], v103 offset:36864
    v_mfma_f32_16x16x32_bf16 v[60:63], a[220:223], v[106:109], v[60:63]
    s_mov_b32 s25, 2104320
    buffer_load_dwordx4 v128, s[12:15], s25 offen lds
    v_mfma_f32_16x16x32_bf16 v[160:163], a[208:211], v[76:79], v[160:163]
    s_add_u32 m0, s27, 24576
    ds_read_b64_tr_b16 a[232:233], v104 offset:32768
    ds_read_b64_tr_b16 a[234:235], v104 offset:36864
    v_mfma_f32_16x16x32_bf16 v[164:167], a[212:215], v[76:79], v[164:167]
    s_mov_b32 s25, 2150400
    buffer_load_dwordx4 v128, s[12:15], s25 offen lds
    v_mfma_f32_16x16x32_bf16 v[168:171], a[216:219], v[76:79], v[168:171]
    s_add_u32 m0, s27, 28672
    ds_read_b64_tr_b16 a[236:237], v105 offset:32768
    ds_read_b64_tr_b16 a[238:239], v105 offset:36864
    v_mfma_f32_16x16x32_bf16 v[172:175], a[220:223], v[76:79], v[172:175]
    s_mov_b32 s25, 2165760
    buffer_load_dwordx4 v128, s[12:15], s25 offen lds
    v_mfma_f32_16x16x32_bf16 v[176:179], a[208:211], v[80:83], v[176:179]
    ds_read_b128 v[140:143], v2 offset:14336
    ds_read_b128 v[144:147], v2 offset:34816
    v_mfma_f32_16x16x32_bf16 v[180:183], a[212:215], v[80:83], v[180:183]
    ds_read_b128 v[148:151], v70 offset:14336
    v_mfma_f32_16x16x32_bf16 v[184:187], a[216:219], v[80:83], v[184:187]
    v_mfma_f32_16x16x32_bf16 v[188:191], a[220:223], v[80:83], v[188:191]
    v_mfma_f32_16x16x32_bf16 v[110:113], a[208:211], v[84:87], v[110:113]
    v_mfma_f32_16x16x32_bf16 v[114:117], a[212:215], v[84:87], v[114:117]
    v_mfma_f32_16x16x32_bf16 v[96:99], a[216:219], v[84:87], v[96:99]
    v_mfma_f32_16x16x32_bf16 v[44:47], a[220:223], v[84:87], v[44:47]
    s_waitcnt vmcnt(9)
    s_waitcnt lgkmcnt(0)
    s_barrier
    v_mfma_f32_16x16x32_bf16 v[48:51], a[224:227], v[106:109], v[48:51]
    s_add_u32 m0, s27, 32768
    ds_read_b64_tr_b16 a[240:241], v102 offset:49152
    ds_read_b64_tr_b16 a[242:243], v102 offset:53248
    v_mfma_f32_16x16x32_bf16 v[52:55], a[228:231], v[106:109], v[52:55]
    s_mov_b32 s25, 2211840
    buffer_load_dwordx4 v128, s[12:15], s25 offen lds
    v_mfma_f32_16x16x32_bf16 v[56:59], a[232:235], v[106:109], v[56:59]
    s_add_u32 m0, s27, 36864
    ds_read_b64_tr_b16 a[244:245], v103 offset:49152
    ds_read_b64_tr_b16 a[246:247], v103 offset:53248
    v_mfma_f32_16x16x32_bf16 v[60:63], a[236:239], v[106:109], v[60:63]
    s_mov_b32 s25, 2227200
    buffer_load_dwordx4 v128, s[12:15], s25 offen lds
    v_mfma_f32_16x16x32_bf16 v[160:163], a[224:227], v[140:143], v[160:163]
    s_add_u32 m0, s27, 40960
    ds_read_b64_tr_b16 a[248:249], v104 offset:49152
    ds_read_b64_tr_b16 a[250:251], v104 offset:53248
    v_mfma_f32_16x16x32_bf16 v[164:167], a[228:231], v[140:143], v[164:167]
    s_mov_b32 s25, 2273280
    buffer_load_dwordx4 v128, s[12:15], s25 offen lds
    v_mfma_f32_16x16x32_bf16 v[168:171], a[232:235], v[140:143], v[168:171]
    s_add_u32 m0, s27, 45056
    ds_read_b64_tr_b16 a[252:253], v105 offset:49152
    ds_read_b64_tr_b16 a[254:255], v105 offset:53248
    v_mfma_f32_16x16x32_bf16 v[172:175], a[236:239], v[140:143], v[172:175]
    s_mov_b32 s25, 2288640
    buffer_load_dwordx4 v128, s[12:15], s25 offen lds
    v_mfma_f32_16x16x32_bf16 v[176:179], a[224:227], v[144:147], v[176:179]
    ds_read_b128 v[76:79], v3 offset:14336
    ds_read_b128 v[80:83], v3 offset:34816
    v_mfma_f32_16x16x32_bf16 v[180:183], a[228:231], v[144:147], v[180:183]
    ds_read_b128 v[84:87], v71 offset:14336
    v_mfma_f32_16x16x32_bf16 v[184:187], a[232:235], v[144:147], v[184:187]
    v_mfma_f32_16x16x32_bf16 v[188:191], a[236:239], v[144:147], v[188:191]
    v_mfma_f32_16x16x32_bf16 v[110:113], a[224:227], v[148:151], v[110:113]
    v_mfma_f32_16x16x32_bf16 v[114:117], a[228:231], v[148:151], v[114:117]
    v_mfma_f32_16x16x32_bf16 v[96:99], a[232:235], v[148:151], v[96:99]
    v_mfma_f32_16x16x32_bf16 v[44:47], a[236:239], v[148:151], v[44:47]
    s_waitcnt vmcnt(9)
    s_waitcnt lgkmcnt(0)
    s_barrier
    ds_read_b64_tr_b16 v[192:193], v102 offset:0
    ds_read_b64_tr_b16 v[194:195], v102 offset:4096
    ds_read_b64_tr_b16 v[196:197], v103 offset:0
    ds_read_b64_tr_b16 v[198:199], v103 offset:4096
    ds_read_b64_tr_b16 v[200:201], v104 offset:0
    ds_read_b64_tr_b16 v[202:203], v104 offset:4096
    ds_read_b64_tr_b16 v[204:205], v105 offset:0
    ds_read_b64_tr_b16 v[206:207], v105 offset:4096
    ds_read_b128 v[140:143], v2 offset:16384
    ds_read_b128 v[144:147], v2 offset:36864
    ds_read_b128 v[148:151], v70 offset:16384
    s_add_u32 m0, s27, 49152
    s_mov_b32 s25, 2334720
    buffer_load_dwordx4 v128, s[12:15], s25 offen lds
    s_add_u32 m0, s27, 53248
    s_mov_b32 s25, 2350080
    buffer_load_dwordx4 v128, s[12:15], s25 offen lds
    s_add_u32 m0, s27, 57344
    s_mov_b32 s25, 2396160
    buffer_load_dwordx4 v128, s[12:15], s25 offen lds
    s_add_u32 m0, s27, 61440
    s_mov_b32 s25, 2411520
    buffer_load_dwordx4 v128, s[12:15], s25 offen lds
    s_mov_b32 s72, 63
    s_waitcnt vmcnt(12)
    v_max3_u32 v126, v122, v123, v124
    v_max_u32 v126, v126, v125
    v_add_u32 v127, s72, v11
    v_cmp_lt_u32 vcc, v127, v126
    s_nop 1
    s_cbranch_vccz s0g_7
    s_mov_b32 s29, 0
spin_8:
    buffer_load_dwordx4 v[122:125], v6, s[4:7], s73 offen sc1
    s_waitcnt vmcnt(0)
    v_max3_u32 v126, v122, v123, v124
    v_max_u32 v126, v126, v125
    v_add_u32 v127, s72, v11
    v_cmp_lt_u32 vcc, v127, v126
    s_nop 1
    s_cbranch_vccz spind_9
    s_sleep 3
    s_add_u32 s29, s29, 1
    s_cmp_lt_u32 s29, 20000
    s_cbranch_scc1 spin_8
    s_mov_b32 s29, 1
    s_branch L_fail
spind_9:
s0g_7:
    s_sub_u32 s25, s77, 2048
    buffer_load_dwordx4 v[118:121], v5, s[4:7], s25 offen offset:2048 sc1
    buffer_load_dwordx4 v[152:155], v5, s[4:7], s25 offen offset:1024 sc1
    buffer_load_dwordx4 v[156:159], v5, s[4:7], s25 offen offset:0 sc1
    v_mfma_f32_16x16x32_bf16 v[48:51], a[240:243], v[106:109], v[48:51]
    v_mfma_f32_16x16x32_bf16 v[52:55], a[244:247], v[106:109], v[52:55]
    v_mfma_f32_16x16x32_bf16 v[56:59], a[248:251], v[106:109], v[56:59]
    v_mfma_f32_16x16x32_bf16 v[60:63], a[252:255], v[106:109], v[60:63]
    v_mfma_f32_16x16x32_bf16 v[160:163], a[240:243], v[76:79], v[160:163]
    v_mfma_f32_16x16x32_bf16 v[164:167], a[244:247], v[76:79], v[164:167]
    v_mfma_f32_16x16x32_bf16 v[168:171], a[248:251], v[76:79], v[168:171]
    v_mfma_f32_16x16x32_bf16 v[172:175], a[252:255], v[76:79], v[172:175]
    v_mfma_f32_16x16x32_bf16 v[176:179], a[240:243], v[80:83], v[176:179]
    v_mfma_f32_16x16x32_bf16 v[180:183], a[244:247], v[80:83], v[180:183]
    v_mfma_f32_16x16x32_bf16 v[184:187], a[248:251], v[80:83], v[184:187]
    v_mfma_f32_16x16x32_bf16 v[188:191], a[252:255], v[80:83], v[188:191]
    v_mfma_f32_16x16x32_bf16 v[110:113], a[240:243], v[84:87], v[110:113]
    v_mfma_f32_16x16x32_bf16 v[114:117], a[244:247], v[84:87], v[114:117]
    v_mfma_f32_16x16x32_bf16 v[96:99], a[248:251], v[84:87], v[96:99]
    v_mfma_f32_16x16x32_bf16 v[44:47], a[252:255], v[84:87], v[44:47]
    s_waitcnt vmcnt(11)
    s_waitcnt lgkmcnt(0)
    s_barrier
    v_mfma_f32_16x16x32_bf16 v[48:51], v[192:195], v[106:109], v[48:51]
    ds_read_b64_tr_b16 v[208:209], v102 offset:16384
    ds_read_b64_tr_b16 v[210:211], v102 offset:20480
    v_mfma_f32_16x16x32_bf16 v[52:55], v[196:199], v[106:109], v[52:55]
    ds_read_b64_tr_b16 v[212:213], v103 offset:16384
    ds_read_b64_tr_b16 v[214:215], v103 offset:20480
    v_mfma_f32_16x16x32_bf16 v[56:59], v[200:203], v[106:109], v[56:59]
    ds_read_b64_tr_b16 v[216:217], v104 offset:16384
    ds_read_b64_tr_b16 v[218:219], v104 offset:20480
    v_mfma_f32_16x16x32_bf16 v[60:63], v[204:207], v[106:109], v[60:63]
    ds_read_b64_tr_b16 v[220:221], v105 offset:16384
    ds_read_b64_tr_b16 v[222:223], v105 offset:20480
    v_mfma_f32_16x16x32_bf16 v[160:163], v[192:195], v[140:143], v[160:163]
    ds_read_b128 v[76:79], v3 offset:16384
    ds_read_b128 v[80:83], v3 offset:36864
    v_mfma_f32_16x16x32_bf16 v[164:167], v[196:199], v[140:143], v[164:167]
    ds_read_b128 v[84:87], v71 offset:16384
    v_mfma_f32_16x16x32_bf16 v[168:171], v[200:203], v[140:143], v[168:171]
    v_mfma_f32_16x16x32_bf16 v[172:175], v[204:207], v[140:143], v[172:175]
    v_mfma_f32_16x16x32_bf16 v[176:179], v[192:195], v[144:147], v[176:179]
    v_mfma_f32_16x16x32_bf16 v[180:183], v[196:199], v[144:147], v[180:183]
    v_mfma_f32_16x16x32_bf16 v[184:187], v[200:203], v[144:147], v[184:187]
    v_mfma_f32_16x16x32_bf16 v[188:191], v[204:207], v[144:147], v[188:191]
    v_mfma_f32_16x16x32_bf16 v[110:113], v[192:195], v[148:151], v[110:113]
    v_mfma_f32_16x16x32_bf16 v[114:117], v[196:199], v[148:151], v[114:117]
    v_mfma_f32_16x16x32_bf16 v[96:99], v[200:203], v[148:151], v[96:99]
    v_mfma_f32_16x16x32_bf16 v[44:47], v[204:207], v[148:151], v[44:47]
    s_waitcnt vmcnt(7)
    s_waitcnt lgkmcnt(0)
    s_barrier
    v_mfma_f32_16x16x32_bf16 v[48:51], v[208:211], v[106:109], v[48:51]
    ds_read_b64_tr_b16 v[224:225], v102 offset:32768
    ds_read_b64_tr_b16 v[226:227], v102 offset:36864
    v_mfma_f32_16x16x32_bf16 v[52:55], v[212:215], v[106:109], v[52:55]
    ds_read_b64_tr_b16 v[228:229], v103 offset:32768
    ds_read_b64_tr_b16 v[230:231], v103 offset:36864
    v_mfma_f32_16x16x32_bf16 v[56:59], v[216:219], v[106:109], v[56:59]
    ds_read_b64_tr_b16 v[232:233], v104 offset:32768
    ds_read_b64_tr_b16 v[234:235], v104 offset:36864
    v_mfma_f32_16x16x32_bf16 v[60:63], v[220:223], v[106:109], v[60:63]
    ds_read_b64_tr_b16 v[236:237], v105 offset:32768
    ds_read_b64_tr_b16 v[238:239], v105 offset:36864
    v_mfma_f32_16x16x32_bf16 v[160:163], v[208:211], v[76:79], v[160:163]
    ds_read_b128 v[140:143], v2 offset:18432
    ds_read_b128 v[144:147], v2 offset:38912
    v_mfma_f32_16x16x32_bf16 v[164:167], v[212:215], v[76:79], v[164:167]
    ds_read_b128 v[148:151], v70 offset:18432
    v_mfma_f32_16x16x32_bf16 v[168:171], v[216:219], v[76:79], v[168:171]
    v_mfma_f32_16x16x32_bf16 v[172:175], v[220:223], v[76:79], v[172:175]
    v_mfma_f32_16x16x32_bf16 v[176:179], v[208:211], v[80:83], v[176:179]
    v_mfma_f32_16x16x32_bf16 v[180:183], v[212:215], v[80:83], v[180:183]
    v_mfma_f32_16x16x32_bf16 v[184:187], v[216:219], v[80:83], v[184:187]
    v_mfma_f32_16x16x32_bf16 v[188:191], v[220:223], v[80:83], v[188:191]
    v_mfma_f32_16x16x32_bf16 v[110:113], v[208:211], v[84:87], v[110:113]
    v_mfma_f32_16x16x32_bf16 v[114:117], v[212:215], v[84:87], v[114:117]
    v_mfma_f32_16x16x32_bf16 v[96:99], v[216:219], v[84:87], v[96:99]
    v_mfma_f32_16x16x32_bf16 v[44:47], v[220:223], v[84:87], v[44:47]
    s_waitcnt vmcnt(3)
    s_waitcnt lgkmcnt(0)
    s_barrier
    ds_read_b64_tr_b16 v[240:241], v102 offset:49152
    ds_read_b64_tr_b16 v[242:243], v102 offset:53248
    ds_read_b64_tr_b16 v[244:245], v103 offset:49152
    ds_read_b64_tr_b16 v[246:247], v103 offset:53248
    ds_read_b64_tr_b16 v[248:249], v104 offset:49152
    ds_read_b64_tr_b16 v[250:251], v104 offset:53248
    ds_read_b64_tr_b16 v[252:253], v105 offset:49152
    ds_read_b64_tr_b16 v[254:255], v105 offset:53248
    ds_read_b128 v[76:79], v3 offset:18432
    ds_read_b128 v[80:83], v3 offset:38912
    ds_read_b128 v[84:87], v71 offset:18432
    v_lshlrev_b32 v130, 7, v1
    s_add_u32 s26, s21, 0x8000
    s_mov_b32 exec_hi, 0
    buffer_load_dword v135, v130, s[4:7], s26 offen sc1
    s_mov_b32 exec_hi, -1
    v_mfma_f32_16x16x32_bf16 v[48:51], v[224:227], v[106:109], v[48:51]
    v_mfma_f32_16x16x32_bf16 v[52:55], v[228:231], v[106:109], v[52:55]
    v_mfma_f32_16x16x32_bf16 v[56:59], v[232:235], v[106:109], v[56:59]
    v_mfma_f32_16x16x32_bf16 v[60:63], v[236:239], v[106:109], v[60:63]
    v_mfma_f32_16x16x32_bf16 v[160:163], v[224:227], v[140:143], v[160:163]
    v_mfma_f32_16x16x32_bf16 v[164:167], v[228:231], v[140:143], v[164:167]
    v_mfma_f32_16x16x32_bf16 v[168:171], v[232:235], v[140:143], v[168:171]
    v_mfma_f32_16x16x32_bf16 v[172:175], v[236:239], v[140:143], v[172:175]
    v_mfma_f32_16x16x32_bf16 v[176:179], v[224:227], v[144:147], v[176:179]
    v_mfma_f32_16x16x32_bf16 v[180:183], v[228:231], v[144:147], v[180:183]
    v_mfma_f32_16x16x32_bf16 v[184:187], v[232:235], v[144:147], v[184:187]
    v_mfma_f32_16x16x32_bf16 v[188:191], v[236:239], v[144:147], v[188:191]
    v_mfma_f32_16x16x32_bf16 v[110:113], v[224:227], v[148:151], v[110:113]
    v_mfma_f32_16x16x32_bf16 v[114:117], v[228:231], v[148:151], v[114:117]
    v_mfma_f32_16x16x32_bf16 v[96:99], v[232:235], v[148:151], v[96:99]
    v_mfma_f32_16x16x32_bf16 v[44:47], v[236:239], v[148:151], v[44:47]
S_p1:
RE_p1:
    s_waitcnt lgkmcnt(0)
    s_barrier
    s_sub_u32 s68, s76, 122880
    s_mov_b32 m0, s61
    s_nop 0
    buffer_load_dwordx4 v4, s[8:11], s68 offen offset:0 sc1 lds
    s_mov_b32 m0, s62
    s_nop 0
    buffer_load_dwordx4 v4, s[8:11], s68 offen offset:128 sc1 lds
    s_mov_b32 m0, s63
    s_nop 0
    buffer_load_dwordx4 v4, s[8:11], s68 offen offset:256 sc1 lds
    s_mov_b32 m0, s64
    s_nop 0
    buffer_load_dwordx4 v4, s[8:11], s68 offen offset:384 sc1 lds
    s_mov_b32 m0, s65
    s_nop 0
    buffer_load_dwordx4 v4, s[8:11], s68 offen offset:512 sc1 lds
    v_mfma_f32_16x16x32_bf16 v[48:51], v[240:243], v[106:109], v[48:51]
    v_mfma_f32_16x16x32_bf16 v[52:55], v[244:247], v[106:109], v[52:55]
    v_mfma_f32_16x16x32_bf16 v[56:59], v[248:251], v[106:109], v[56:59]
    v_mfma_f32_16x16x32_bf16 v[60:63], v[252:255], v[106:109], v[60:63]
    v_mfma_f32_16x16x32_bf16 v[160:163], v[240:243], v[76:79], v[160:163]
    v_mfma_f32_16x16x32_bf16 v[164:167], v[244:247], v[76:79], v[164:167]
    v_mfma_f32_16x16x32_bf16 v[168:171], v[248:251], v[76:79], v[168:171]
    v_mfma_f32_16x16x32_bf16 v[172:175], v[252:255], v[76:79], v[172:175]
    v_mfma_f32_16x16x32_bf16 v[176:179], v[240:243], v[80:83], v[176:179]
    v_mfma_f32_16x16x32_bf16 v[180:183], v[244:247], v[80:83], v[180:183]
    v_mfma_f32_16x16x32_bf16 v[184:187], v[248:251], v[80:83], v[184:187]
    v_mfma_f32_16x16x32_bf16 v[188:191], v[252:255], v[80:83], v[188:191]
    v_mfma_f32_16x16x32_bf16 v[110:113], v[240:243], v[84:87], v[110:113]
    v_mfma_f32_16x16x32_bf16 v[114:117], v[244:247], v[84:87], v[114:117]
    v_mfma_f32_16x16x32_bf16 v[96:99], v[248:251], v[84:87], v[96:99]
    v_mfma_f32_16x16x32_bf16 v[44:47], v[252:255], v[84:87], v[44:47]
    s_waitcnt vmcnt(8)
    v_add_f32 v118, v118, v120
    v_add_f32 v119, v119, v121
    s_nop 1
    v_permlane32_swap_b32 v118, v119
    v_add_f32 v118, v118, v119
    v_mov_b32 v119, v118
    s_nop 1
    v_permlane16_swap_b32 v118, v119
    v_add_f32 v118, v118, v119
    v_mov_b32 v119, v118
    s_nop 1
    v_permlane32_swap_b32 v118, v119
    v_mul_f32 v16, s91, v118
    v_fma_f32 v118, v16, v16, -s92
    v_fma_f32 v119, v119, s91, -v118
    v_max_f32 v119, s92, v119
    v_rsq_f32 v17, v119
    s_nop 0
    v_mul_f32 v14, s93, v17
    v_cndmask_b32 v18, v17, 1.0, s[30:31]
    v_fma_f32 v164, -v16, v52, v164
    v_fma_f32 v165, -v16, v53, v165
    v_fma_f32 v166, -v16, v54, v166
    v_fma_f32 v167, -v16, v55, v167
    v_mul_f32 v164, v17, v164
    v_mul_f32 v165, v17, v165
    v_mul_f32 v166, v17, v166
    v_mul_f32 v167, v17, v167
    v_cvt_pk_bf16_f32 v76, v164, v165
    v_cvt_pk_bf16_f32 v77, v166, v167
    v_fma_f32 v172, -v16, v60, v172
    v_fma_f32 v173, -v16, v61, v173
    v_fma_f32 v174, -v16, v62, v174
    v_fma_f32 v175, -v16, v63, v175
    v_mul_f32 v172, v17, v172
    v_mul_f32 v173, v17, v173
    v_mul_f32 v174, v17, v174
    v_mul_f32 v175, v17, v175
    v_cvt_pk_bf16_f32 v68, v172, v173
    v_cvt_pk_bf16_f32 v69, v174, v175
    v_and_b32 v78, v10, v68
    v_and_b32 v79, v10, v69
    v_fma_f32 v168, -v16, v56, v168
    v_fma_f32 v169, -v16, v57, v169
    v_fma_f32 v170, -v16, v58, v170
    v_fma_f32 v171, -v16, v59, v171
    v_mul_f32 v168, v18, v168
    v_mul_f32 v169, v18, v169
    v_mul_f32 v170, v18, v170
    v_mul_f32 v171, v18, v171
    v_cvt_pk_bf16_f32 v66, v168, v169
    v_cvt_pk_bf16_f32 v67, v170, v171
    s_nop 1
    v_mfma_f32_16x16x32_bf16 v[102:105], v[66:69], v[20:23], 0
    v_mfma_f32_16x16x32_bf16 v[106:109], v[66:69], v[24:27], v[28:31]
    s_nop 6
    v_cvt_pk_bf16_f32 v84, v102, v103
    v_cvt_pk_bf16_f32 v85, v104, v105
    v_cvt_pk_bf16_f32 v90, v106, v107
    v_cvt_pk_bf16_f32 v91, v108, v109
    v_fma_f32 v160, -v16, v48, v160
    v_fma_f32 v161, -v16, v49, v161
    v_fma_f32 v162, -v16, v50, v162
    v_fma_f32 v163, -v16, v51, v163
    v_cvt_pk_bf16_f32 v64, v160, v161
    v_cvt_pk_bf16_f32 v65, v162, v163
    v_mov_b32 v160, v110
    v_mov_b32 v161, v111
    v_mov_b32 v162, v112
    v_mov_b32 v163, v113
    v_mov_b32 v164, v114
    v_mov_b32 v165, v115
    v_mov_b32 v166, v116
    v_mov_b32 v167, v117
    v_mov_b32 v168, v96
    v_mov_b32 v169, v97
    v_mov_b32 v170, v98
    v_mov_b32 v171, v99
    v_mov_b32 v172, v44
    v_mov_b32 v173, v45
    v_mov_b32 v174, v46
    v_mov_b32 v175, v47
    s_waitcnt vmcnt(7)
    v_add_f32 v152, v152, v154
    v_add_f32 v153, v153, v155
    s_nop 1
    v_permlane32_swap_b32 v152, v153
    v_add_f32 v152, v152, v153
    v_mov_b32 v153, v152
    s_nop 1
    v_permlane16_swap_b32 v152, v153
    v_add_f32 v152, v152, v153
    v_mov_b32 v153, v152
    s_nop 1
    v_permlane32_swap_b32 v152, v153
    v_mul_f32 v16, s91, v152
    v_fma_f32 v152, v16, v16, -s92
    v_fma_f32 v153, v153, s91, -v152
    v_max_f32 v153, s92, v153
    v_rsq_f32 v17, v153
    s_nop 0
    v_mul_f32 v15, s93, v17
    v_cndmask_b32 v18, v17, 1.0, s[30:31]
    s_waitcnt vmcnt(5)
    v_mov_b32 v131, v135
    s_mov_b32 s29, 0
    s_branch gse_12
gs_10:
    v_lshlrev_b32 v130, 7, v1
    s_add_u32 s26, s21, 0x8000
    s_mov_b32 exec_hi, 0
    buffer_load_dword v135, v130, s[4:7], s26 offen sc1
    s_mov_b32 exec_hi, -1
    s_waitcnt vmcnt(0)
gse_12:
    s_mov_b32 exec_hi, 0
    v_cmp_eq_u32 vcc, 0, v135
    s_mov_b32 exec_hi, -1
    s_nop 1
    s_cbranch_vccz gsd_11
    s_sleep 2
    s_add_u32 s29, s29, 1
    s_cmp_lt_u32 s29, 20000
    s_cbranch_scc1 gs_10
    s_mov_b32 s29, 98
    s_branch L_fail
gsd_11:
    s_getreg_b32 s25, hwreg(HW_REG_XCC_ID, 0, 4)
    s_add_u32 s25, s25, 1
    s_mov_b32 exec_hi, 0
    v_cmp_ne_u32 vcc, s25, v135
    s_mov_b32 exec_hi, -1
    s_nop 0
    s_cmp_eq_u64 vcc, 0
    s_cselect_b32 s20, 0, 0xff
    s_lshr_b32 s26, s2, 3
    s_add_u32 s26, s26, 0
    s_lshl_b32 s26, s26, 7
    s_add_u32 s26, s26, s54
    s_lshl_b32 s25, s23, 2
    s_add_u32 s66, s26, s25
    s_cmp_eq_u32 s20, 0
    s_cselect_b32 s67, s66, 0x2000000
    s_mov_b32 s71, s78
    v_mfma_f32_16x16x32_bf16 v[114:117], v[76:79], v[64:67], v[32:35]
    v_fma_f32 v180, -v16, v52, v180
    v_fma_f32 v181, -v16, v53, v181
    v_fma_f32 v182, -v16, v54, v182
    v_fma_f32 v183, -v16, v55, v183
    v_mul_f32 v180, v17, v180
    v_mul_f32 v181, v17, v181
    v_mul_f32 v182, v17, v182
    v_mul_f32 v183, v17, v183
    v_cvt_pk_bf16_f32 v80, v180, v181
    v_cvt_pk_bf16_f32 v81, v182, v183
    v_fma_f32 v188, -v16, v60, v188
    v_fma_f32 v189, -v16, v61, v189
    v_fma_f32 v190, -v16, v62, v190
    v_fma_f32 v191, -v16, v63, v191
    v_mul_f32 v188, v17, v188
    v_mul_f32 v189, v17, v189
    v_mul_f32 v190, v17, v190
    v_mul_f32 v191, v17, v191
    v_cvt_pk_bf16_f32 v74, v188, v189
    v_cvt_pk_bf16_f32 v75, v190, v191
    v_and_b32 v82, v10, v74
    v_and_b32 v83, v10, v75
    v_fma_f32 v184, -v16, v56, v184
    v_fma_f32 v185, -v16, v57, v185
    v_mfma_f32_16x16x32_bf16 v[110:113], v[80:83], v[64:67], v[36:39]
    v_fma_f32 v186, -v16, v58, v186
    v_fma_f32 v187, -v16, v59, v187
    v_mul_f32 v184, v18, v184
    v_mul_f32 v185, v18, v185
    v_mul_f32 v186, v18, v186
    v_mul_f32 v187, v18, v187
    v_cvt_pk_bf16_f32 v72, v184, v185
    v_cvt_pk_bf16_f32 v73, v186, v187
    v_max_f32 v110, v110, v114
    v_max_f32 v111, v111, v115
    v_mfma_f32_16x16x32_bf16 v[102:105], v[72:75], v[20:23], 0
    v_max_f32 v112, v112, v116
    v_max_f32 v113, v113, v117
    v_mfma_f32_16x16x32_bf16 v[106:109], v[72:75], v[24:27], v[28:31]
    v_max3_f32 v128, v110, v111, v112
    v_max_f32 v128, v128, v113
    v_mov_b32 v129, v128
    s_nop 1
    v_permlane32_swap_b32 v128, v129
    v_max_f32 v128, v128, v129
    v_mov_b32 v129, v128
    v_cvt_pk_bf16_f32 v86, v102, v103
    v_cvt_pk_bf16_f32 v87, v104, v105
    v_permlane16_swap_b32 v128, v129
    v_max_f32 v128, v128, v129
    v_mul_f32 v128, v128, v14
    v_fma_f32 v110, v110, v14, -v128
    v_fma_f32 v111, v111, v14, -v128
    v_fma_f32 v112, v112, v14, -v128
    v_fma_f32 v113, v113, v14, -v128
    v_exp_f32 v110, v110
    v_exp_f32 v111, v111
    v_exp_f32 v112, v112
    v_exp_f32 v113, v113
    v_cvt_pk_bf16_f32 v92, v106, v107
    v_cvt_pk_bf16_f32 v93, v108, v109
    v_cvt_pk_bf16_f32 v130, v110, v111
    v_cvt_pk_bf16_f32 v131, v112, v113
    v_and_b32 v96, v12, v130
    v_and_b32 v97, v13, v131
    v_xor_b32 v98, v96, v130
    v_xor_b32 v99, v97, v131
    v_fma_f32 v176, -v16, v48, v176
    v_fma_f32 v177, -v16, v49, v177
    v_mfma_f32_16x16x32_bf16 v[106:109], v[90:93], v[96:99], 0
    v_mfma_f32_16x16x32_bf16 v[102:105], v[84:87], v[96:99], 0
    v_fma_f32 v178, -v16, v50, v178
    v_fma_f32 v179, -v16, v51, v179
    v_cvt_pk_bf16_f32 v70, v176, v177
    v_cvt_pk_bf16_f32 v71, v178, v179
    s_nop 2
    v_rcp_f32 v128, v108
    s_nop 0
    v_mul_f32 v106, v128, v106
    v_mul_f32 v107, v128, v107
    v_mul_f32 v102, v128, v102
    v_mul_f32 v103, v128, v103
    v_mul_f32 v104, v128, v104
    v_mul_f32 v105, v128, v105
    v_cvt_pk_bf16_f32 v134, v106, v107
    v_cvt_pk_bf16_f32 v132, v102, v103
    v_cvt_pk_bf16_f32 v133, v104, v105
    buffer_store_dwordx2 v[132:133], v8, s[4:7], s71 offen
    buffer_store_dword v134, v9, s[4:7], s71 offen
    v_add_f32 v156, v156, v158
    v_add_f32 v157, v157, v159
    s_nop 1
    v_permlane32_swap_b32 v156, v157
    v_add_f32 v156, v156, v157
    v_mov_b32 v157, v156
    s_nop 1
    v_permlane16_swap_b32 v156, v157
    v_add_f32 v156, v156, v157
    v_mov_b32 v157, v156
    s_nop 1
    v_permlane32_swap_b32 v156, v157
    v_mul_f32 v16, s91, v156
    v_fma_f32 v156, v16, v16, -s92
    v_fma_f32 v157, v157, s91, -v156
    v_max_f32 v157, s92, v157
    v_rsq_f32 v17, v157
    s_nop 0
    v_mul_f32 v14, s93, v17
    v_cndmask_b32 v18, v17, 1.0, s[30:31]
    s_sub_u32 s68, s76, 163840
    s_sub_u32 s70, s77, 3072
    s_mov_b32 s74, 1
    s_add_u32 s71, s78, 20480
    s_mov_b32 s75, 3
    v_mov_b32 v122, 0
    v_mov_b32 v123, 0
    v_mov_b32 v124, 0
    v_mov_b32 v125, 0
    v_mov_b32 v11, 0xfffffffe
    s_mov_b32 exec_lo, 0xff
    s_mov_b32 exec_hi, 0x0
    v_mov_b32 v11, 0x0
    s_mov_b64 exec, -1
    s_mov_b32 s72, 73
    s_waitcnt vmcnt(0)
    v_sub_u32_e64 v19, 64, s74
    s_bitcmp1_b32 s20, 0
    s_cbranch_scc1 pub_13
pubr_14:
    buffer_store_dword v19, v7, s[4:7], s67 offen
    v_mov_b32 v102, v84
    v_mov_b32 v104, v90
    v_mov_b32 v103, v85
    v_mov_b32 v105, v91
    buffer_store_dwordx4 v[76:79], v5, s[4:7], s80 offen sc1
    buffer_store_dwordx4 v[102:105], v5, s[4:7], s80 offen offset:1024 sc1
    s_add_u32 s80, s80, 2048
    s_barrier
    ds_read_b128 v[140:143], v2 offset:20480
    ds_read_b128 v[144:147], v3 offset:20480
    ds_read_b128 v[148:151], v2 offset:22528
    ds_read_b128 v[152:155], v3 offset:22528
    s_waitcnt lgkmcnt(0)
p1loop_15:
    s_waitcnt lgkmcnt(2)
    v_mfma_f32_16x16x32_bf16 v[176:179], a[0:3], v[140:143], 0
    ds_read_b128 v[156:159], v2 offset:24576
    s_waitcnt vmcnt(2)
    v_max3_u32 v126, v122, v123, v124
    v_mfma_f32_16x16x32_bf16 v[180:183], a[4:7], v[140:143], 0
    v_max3_u32 v126, v126, v125, s20
    v_add_u32 v127, s72, v11
    v_mfma_f32_16x16x32_bf16 v[184:187], a[8:11], v[140:143], 0
    v_cmp_lt_u32 vcc, v127, v126
    v_mfma_f32_16x16x32_bf16 v[114:117], v[80:83], v[70:73], v[32:35]
    s_cbranch_vccnz slow_21
ret_22:
    v_fma_f32 v164, -v16, v52, v164
    v_fma_f32 v165, -v16, v53, v165
    v_mfma_f32_16x16x32_bf16 v[188:191], a[12:15], v[140:143], 0
    v_fma_f32 v166, -v16, v54, v166
    v_fma_f32 v167, -v16, v55, v167
    v_mfma_f32_16x16x32_bf16 v[176:179], a[16:19], v[144:147], v[176:179]
    s_mov_b32 m0, s56
    ds_read_b128 v[140:143], v3 offset:24576
    v_mul_f32 v164, v17, v164
    v_mfma_f32_16x16x32_bf16 v[180:183], a[20:23], v[144:147], v[180:183]
    buffer_load_dwordx4 v4, s[8:11], s68 offen offset:0 sc1 lds
    v_mfma_f32_16x16x32_bf16 v[184:187], a[24:27], v[144:147], v[184:187]
    s_mov_b32 m0, s57
    v_mul_f32 v165, v17, v165
    v_mul_f32 v166, v17, v166
    v_mfma_f32_16x16x32_bf16 v[188:191], a[28:31], v[144:147], v[188:191]
    s_waitcnt lgkmcnt(1)
    v_mul_f32 v167, v17, v167
    v_cvt_pk_bf16_f32 v76, v164, v165
    v_mfma_f32_16x16x32_bf16 v[176:179], a[32:35], v[148:151], v[176:179]
    ds_read_b128 v[144:147], v2 offset:26624
    v_cvt_pk_bf16_f32 v77, v166, v167
    v_mfma_f32_16x16x32_bf16 v[180:183], a[36:39], v[148:151], v[180:183]
    buffer_load_dwordx4 v4, s[8:11], s68 offen offset:128 sc1 lds
    v_mfma_f32_16x16x32_bf16 v[184:187], a[40:43], v[148:151], v[184:187]
    s_mov_b32 m0, s58
    v_fma_f32 v172, -v16, v60, v172
    v_fma_f32 v173, -v16, v61, v173
    v_mfma_f32_16x16x32_bf16 v[188:191], a[44:47], v[148:151], v[188:191]
    v_fma_f32 v174, -v16, v62, v174
    v_fma_f32 v175, -v16, v63, v175
    v_mfma_f32_16x16x32_bf16 v[176:179], a[48:51], v[152:155], v[176:179]
    ds_read_b128 v[148:151], v3 offset:26624
    v_mul_f32 v172, v17, v172
    v_mfma_f32_16x16x32_bf16 v[180:183], a[52:55], v[152:155], v[180:183]
    s_waitcnt vmcnt(2)
    buffer_load_dwordx4 v4, s[8:11], s68 offen offset:256 sc1 lds
    v_mfma_f32_16x16x32_bf16 v[184:187], a[56:59], v[152:155], v[184:187]
    s_mov_b32 m0, s59
    v_sub_u32_e64 v19, 64, s74
    v_mul_f32 v173, v17, v173
    v_mfma_f32_16x16x32_bf16 v[188:191], a[60:63], v[152:155], v[188:191]
    buffer_store_dword v19, v7, s[4:7], s67 offen
    v_mfma_f32_16x16x32_bf16 v[176:179], a[64:67], v[156:159], v[176:179]
    s_bitcmp1_b32 s84, s75
    ds_read_b128 v[152:155], v2 offset:28672
    v_mul_f32 v174, v17, v174
    v_mfma_f32_16x16x32_bf16 v[180:183], a[68:71], v[156:159], v[180:183]
    s_cbranch_scc1 ev_30
evr_31:
    buffer_load_dwordx4 v4, s[8:11], s68 offen offset:384 sc1 lds
    v_mfma_f32_16x16x32_bf16 v[184:187], a[72:75], v[156:159], v[184:187]
    s_mov_b32 m0, s60
    v_mul_f32 v175, v17, v175
    v_cvt_pk_bf16_f32 v68, v172, v173
    v_mfma_f32_16x16x32_bf16 v[188:191], a[76:79], v[156:159], v[188:191]
    s_waitcnt lgkmcnt(1)
    v_cvt_pk_bf16_f32 v69, v174, v175
    v_and_b32 v78, v10, v68
    v_mfma_f32_16x16x32_bf16 v[176:179], a[80:83], v[140:143], v[176:179]
    ds_read_b128 v[156:159], v3 offset:28672
    v_and_b32 v79, v10, v69
    v_mfma_f32_16x16x32_bf16 v[180:183], a[84:87], v[140:143], v[180:183]
    buffer_load_dwordx4 v4, s[8:11], s68 offen offset:512 sc1 lds
    v_mfma_f32_16x16x32_bf16 v[184:187], a[88:91], v[140:143], v[184:187]
    buffer_load_dwordx4 v[118:121], v5, s[4:7], s70 offen sc1
    v_mfma_f32_16x16x32_bf16 v[188:191], a[92:95], v[140:143], v[188:191]
    v_fma_f32 v168, -v16, v56, v168
    v_fma_f32 v169, -v16, v57, v169
    v_mfma_f32_16x16x32_bf16 v[176:179], a[96:99], v[144:147], v[176:179]
    s_add_u32 s26, s75, 1
    ds_read_b128 v[140:143], v2 offset:30720
    v_mfma_f32_16x16x32_bf16 v[110:113], v[76:79], v[70:73], v[36:39]
    s_cmp_eq_u32 s75, 17
    s_cbranch_scc1 alt_17
altr_18:
    v_fma_f32 v170, -v16, v58, v170
    v_mfma_f32_16x16x32_bf16 v[180:183], a[100:103], v[144:147], v[180:183]
    s_and_b32 s70, s26, 15
    v_fma_f32 v171, -v16, v59, v171
    v_mul_f32 v168, v18, v168
    v_mfma_f32_16x16x32_bf16 v[184:187], a[104:107], v[144:147], v[184:187]
    s_lshl_b32 s70, s70, 10
    v_mul_f32 v169, v18, v169
    v_mul_f32 v170, v18, v170
    v_mfma_f32_16x16x32_bf16 v[188:191], a[108:111], v[144:147], v[188:191]
    v_mul_f32 v171, v18, v171
    v_cvt_pk_bf16_f32 v66, v168, v169
    v_mfma_f32_16x16x32_bf16 v[176:179], a[112:115], v[148:151], v[176:179]
    s_sub_u32 s70, s77, s70
    ds_read_b128 v[144:147], v3 offset:30720
    v_cvt_pk_bf16_f32 v67, v170, v171
    v_mfma_f32_16x16x32_bf16 v[180:183], a[116:119], v[148:151], v[180:183]
    s_lshr_b32 s26, s26, 4
    v_max_f32 v110, v110, v114
    v_max_f32 v111, v111, v115
    v_mfma_f32_16x16x32_bf16 v[184:187], a[120:123], v[148:151], v[184:187]
    s_lshl_b32 s26, s26, 17
    v_mfma_f32_16x16x32_bf16 v[102:105], v[66:69], v[20:23], 0
    s_add_u32 s70, s70, s26
    v_max_f32 v112, v112, v116
    v_max_f32 v113, v113, v117
    v_mfma_f32_16x16x32_bf16 v[188:191], a[124:127], v[148:151], v[188:191]
    v_mfma_f32_16x16x32_bf16 v[106:109], v[66:69], v[24:27], v[28:31]
    s_sub_u32 s72, 75, s75
    v_max3_f32 v128, v110, v111, v112
    v_max_f32 v128, v128, v113
    s_waitcnt lgkmcnt(1)
    v_mfma_f32_16x16x32_bf16 v[176:179], a[128:131], v[152:155], v[176:179]
    s_add_u32 s26, s75, 2
    ds_read_b128 v[148:151], v2 offset:32768
    v_mov_b32 v129, v128
    v_mfma_f32_16x16x32_bf16 v[180:183], a[132:135], v[152:155], v[180:183]
    s_min_u32 s26, s26, 31
    v_permlane32_swap_b32 v128, v129
    v_mfma_f32_16x16x32_bf16 v[184:187], a[136:139], v[152:155], v[184:187]
    s_and_b32 s26, s26, 15
    v_max_f32 v128, v128, v129
    v_mov_b32 v129, v128
    v_mfma_f32_16x16x32_bf16 v[188:191], a[140:143], v[152:155], v[188:191]
    v_cvt_pk_bf16_f32 v84, v102, v103
    v_cvt_pk_bf16_f32 v85, v104, v105
    v_mfma_f32_16x16x32_bf16 v[176:179], a[144:147], v[156:159], v[176:179]
    s_mul_i32 s26, s26, 40960
    ds_read_b128 v[152:155], v3 offset:32768
    s_sub_u32 s68, s76, s26
    v_mfma_f32_16x16x32_bf16 v[180:183], a[148:151], v[156:159], v[180:183]
    s_cmp_ge_u32 s75, 14
    v_permlane16_swap_b32 v128, v129
    v_mfma_f32_16x16x32_bf16 v[184:187], a[152:155], v[156:159], v[184:187]
    s_cselect_b32 s8, s52, s32
    v_max_f32 v128, v128, v129
    v_mul_f32 v128, v128, v15
    v_mfma_f32_16x16x32_bf16 v[188:191], a[156:159], v[156:159], v[188:191]
    v_fma_f32 v110, v110, v15, -v128
    v_fma_f32 v111, v111, v15, -v128
    v_mfma_f32_16x16x32_bf16 v[176:179], a[160:163], v[140:143], v[176:179]
    s_cselect_b32 s9, s53, s33
    ds_read_b128 v[156:159], v2 offset:34816
    v_fma_f32 v112, v112, v15, -v128
    v_mfma_f32_16x16x32_bf16 v[180:183], a[164:167], v[140:143], v[180:183]
    v_fma_f32 v113, v113, v15, -v128
    v_mfma_f32_16x16x32_bf16 v[184:187], a[168:171], v[140:143], v[184:187]
    v_exp_f32 v110, v110
    v_mfma_f32_16x16x32_bf16 v[188:191], a[172:175], v[140:143], v[188:191]
    s_waitcnt lgkmcnt(1)
    v_exp_f32 v111, v111
    v_mfma_f32_16x16x32_bf16 v[176:179], a[176:179], v[144:147], v[176:179]
    ds_read_b128 v[140:143], v3 offset:34816
    v_mfma_f32_16x16x32_bf16 v[180:183], a[180:183], v[144:147], v[180:183]
    v_exp_f32 v112, v112
    v_mfma_f32_16x16x32_bf16 v[184:187], a[184:187], v[144:147], v[184:187]
    v_exp_f32 v113, v113
    v_mfma_f32_16x16x32_bf16 v[188:191], a[188:191], v[144:147], v[188:191]
    v_cvt_pk_bf16_f32 v90, v106, v107
    v_cvt_pk_bf16_f32 v91, v108, v109
    v_mfma_f32_16x16x32_bf16 v[176:179], a[192:195], v[148:151], v[176:179]
    ds_read_b128 v[144:147], v2 offset:36864
    v_cvt_pk_bf16_f32 v130, v110, v111
    v_mfma_f32_16x16x32_bf16 v[180:183], a[196:199], v[148:151], v[180:183]
    v_cvt_pk_bf16_f32 v131, v112, v113
    v_and_b32 v98, v12, v130
    v_mfma_f32_16x16x32_bf16 v[184:187], a[200:203], v[148:151], v[184:187]
    v_and_b32 v99, v13, v131
    v_xor_b32 v96, v98, v130
    v_mfma_f32_16x16x32_bf16 v[188:191], a[204:207], v[148:151], v[188:191]
    v_xor_b32 v97, v99, v131
    v_fma_f32 v160, -v16, v48, v160
    v_mfma_f32_16x16x32_bf16 v[176:179], a[208:211], v[152:155], v[176:179]
    ds_read_b128 v[148:151], v3 offset:36864
    v_fma_f32 v161, -v16, v49, v161
    v_mfma_f32_16x16x32_bf16 v[180:183], a[212:215], v[152:155], v[180:183]
    buffer_load_dwordx4 v[122:125], v6, s[4:7], s73 offen sc1
    v_mfma_f32_16x16x32_bf16 v[184:187], a[216:219], v[152:155], v[184:187]
    v_mfma_f32_16x16x32_bf16 v[106:109], v[90:93], v[96:99], 0
    v_mfma_f32_16x16x32_bf16 v[102:105], v[84:87], v[96:99], 0
    s_cmp_eq_u32 s75, 17
    s_cbranch_scc1 alt_19
altr_20:
    v_fma_f32 v162, -v16, v50, v162
    v_mfma_f32_16x16x32_bf16 v[188:191], a[220:223], v[152:155], v[188:191]
    s_waitcnt lgkmcnt(1)
    v_fma_f32 v163, -v16, v51, v163
    v_cvt_pk_bf16_f32 v64, v160, v161
    v_mfma_f32_16x16x32_bf16 v[176:179], a[224:227], v[156:159], v[176:179]
    ds_read_b128 v[152:155], v2 offset:38912
    v_cvt_pk_bf16_f32 v65, v162, v163
    v_mfma_f32_16x16x32_bf16 v[180:183], a[228:231], v[156:159], v[180:183]
    v_rcp_f32 v128, v108
    v_mfma_f32_16x16x32_bf16 v[184:187], a[232:235], v[156:159], v[184:187]
    v_mul_f32 v106, v128, v106
    v_mul_f32 v107, v128, v107
    v_mfma_f32_16x16x32_bf16 v[188:191], a[236:239], v[156:159], v[188:191]
    v_mul_f32 v102, v128, v102
    v_mul_f32 v103, v128, v103
    v_mfma_f32_16x16x32_bf16 v[176:179], a[240:243], v[140:143], v[176:179]
    ds_read_b128 v[156:159], v3 offset:38912
    v_mul_f32 v104, v128, v104
    v_mfma_f32_16x16x32_bf16 v[180:183], a[244:247], v[140:143], v[180:183]
    v_mul_f32 v105, v128, v105
    v_cvt_pk_bf16_f32 v134, v106, v107
    v_mfma_f32_16x16x32_bf16 v[184:187], a[248:251], v[140:143], v[184:187]
    v_cvt_pk_bf16_f32 v132, v102, v103
    v_cvt_pk_bf16_f32 v133, v104, v105
    v_mfma_f32_16x16x32_bf16 v[188:191], a[252:255], v[140:143], v[188:191]
    buffer_store_dwordx2 v[132:133], v8, s[4:7], s71 offen
    v_mfma_f32_16x16x32_bf16 v[176:179], v[192:195], v[144:147], v[176:179]
    buffer_store_dword v134, v9, s[4:7], s71 offen
    v_mfma_f32_16x16x32_bf16 v[180:183], v[196:199], v[144:147], v[180:183]
    s_sub_u32 s74, s75, 1
    s_waitcnt vmcnt(3)
    v_add_f32 v118, v118, v120
    v_add_f32 v119, v119, v121
    v_mfma_f32_16x16x32_bf16 v[184:187], v[200:203], v[144:147], v[184:187]
    s_and_b32 s25, s74, 7
    v_permlane32_swap_b32 v118, v119
    v_mfma_f32_16x16x32_bf16 v[188:191], v[204:207], v[144:147], v[188:191]
    s_waitcnt lgkmcnt(0)
    v_add_f32 v118, v118, v119
    v_mov_b32 v119, v118
    v_mfma_f32_16x16x32_bf16 v[176:179], v[208:211], v[148:151], v[176:179]
    s_mul_i32 s25, s25, 20480
    v_permlane16_swap_b32 v118, v119
    v_mfma_f32_16x16x32_bf16 v[180:183], v[212:215], v[148:151], v[180:183]
    s_waitcnt lgkmcnt(0)
    s_barrier
    v_mfma_f32_16x16x32_bf16 v[184:187], v[216:219], v[148:151], v[184:187]
    s_add_u32 s71, s25, s78
    ds_read_b128 v[140:143], v2 offset:0
    v_add_f32 v118, v118, v119
    v_mfma_f32_16x16x32_bf16 v[188:191], v[220:223], v[148:151], v[188:191]
    ds_read_b128 v[144:147], v3 offset:0
    v_mov_b32 v119, v118
    v_mfma_f32_16x16x32_bf16 v[176:179], v[224:227], v[152:155], v[176:179]
    s_add_u32 s75, s75, 1
    ds_read_b128 v[148:151], v2 offset:2048
    s_cmp_ge_u32 s75, 32
    v_mfma_f32_16x16x32_bf16 v[180:183], v[228:231], v[152:155], v[180:183]
    v_permlane32_swap_b32 v118, v119
    v_mfma_f32_16x16x32_bf16 v[184:187], v[232:235], v[152:155], v[184:187]
    v_mul_f32 v16, s91, v118
    v_fma_f32 v118, v16, v16, -s92
    v_mfma_f32_16x16x32_bf16 v[188:191], v[236:239], v[152:155], v[188:191]
    v_fma_f32 v119, v119, s91, -v118
    v_max_f32 v119, s92, v119
    v_mfma_f32_16x16x32_bf16 v[176:179], v[240:243], v[156:159], v[176:179]
    ds_read_b128 v[152:155], v3 offset:2048
    v_mfma_f32_16x16x32_bf16 v[180:183], v[244:247], v[156:159], v[180:183]
    v_rsq_f32 v17, v119
    v_mfma_f32_16x16x32_bf16 v[184:187], v[248:251], v[156:159], v[184:187]
    v_mul_f32 v15, s93, v17
    v_cndmask_b32 v18, v17, 1.0, s[30:31]
    v_mfma_f32_16x16x32_bf16 v[188:191], v[252:255], v[156:159], v[188:191]
    s_cbranch_scc1 p1exit_16
    s_waitcnt lgkmcnt(2)
    v_mfma_f32_16x16x32_bf16 v[160:163], a[0:3], v[140:143], 0
    ds_read_b128 v[156:159], v2 offset:4096
    s_waitcnt vmcnt(2)
    v_max3_u32 v126, v122, v123, v124
    v_mfma_f32_16x16x32_bf16 v[164:167], a[4:7], v[140:143], 0
    v_max3_u32 v126, v126, v125, s20
    v_add_u32 v127, s72, v11
    v_mfma_f32_16x16x32_bf16 v[168:171], a[8:11], v[140:143], 0
    v_cmp_lt_u32 vcc, v127, v126
    v_mfma_f32_16x16x32_bf16 v[114:117], v[76:79], v[64:67], v[32:35]
    s_cbranch_vccnz slow_34
ret_35:
    v_fma_f32 v180, -v16, v52, v180
    v_fma_f32 v181, -v16, v53, v181
    v_mfma_f32_16x16x32_bf16 v[172:175], a[12:15], v[140:143], 0
    v_fma_f32 v182, -v16, v54, v182
    v_fma_f32 v183, -v16, v55, v183
    v_mfma_f32_16x16x32_bf16 v[160:163], a[16:19], v[144:147], v[160:163]
    s_mov_b32 m0, s61
    ds_read_b128 v[140:143], v3 offset:4096
    v_mul_f32 v180, v17, v180
    v_mfma_f32_16x16x32_bf16 v[164:167], a[20:23], v[144:147], v[164:167]
    buffer_load_dwordx4 v4, s[8:11], s68 offen offset:0 sc1 lds
    v_mfma_f32_16x16x32_bf16 v[168:171], a[24:27], v[144:147], v[168:171]
    s_mov_b32 m0, s62
    v_mul_f32 v181, v17, v181
    v_mul_f32 v182, v17, v182
    v_mfma_f32_16x16x32_bf16 v[172:175], a[28:31], v[144:147], v[172:175]
    s_waitcnt lgkmcnt(1)
    v_mul_f32 v183, v17, v183
    v_cvt_pk_bf16_f32 v80, v180, v181
    v_mfma_f32_16x16x32_bf16 v[160:163], a[32:35], v[148:151], v[160:163]
    ds_read_b128 v[144:147], v2 offset:6144
    v_cvt_pk_bf16_f32 v81, v182, v183
    v_mfma_f32_16x16x32_bf16 v[164:167], a[36:39], v[148:151], v[164:167]
    buffer_load_dwordx4 v4, s[8:11], s68 offen offset:128 sc1 lds
    v_mfma_f32_16x16x32_bf16 v[168:171], a[40:43], v[148:151], v[168:171]
    s_mov_b32 m0, s63
    v_fma_f32 v188, -v16, v60, v188
    v_fma_f32 v189, -v16, v61, v189
    v_mfma_f32_16x16x32_bf16 v[172:175], a[44:47], v[148:151], v[172:175]
    v_fma_f32 v190, -v16, v62, v190
    v_fma_f32 v191, -v16, v63, v191
    v_mfma_f32_16x16x32_bf16 v[160:163], a[48:51], v[152:155], v[160:163]
    ds_read_b128 v[148:151], v3 offset:6144
    v_mul_f32 v188, v17, v188
    v_mfma_f32_16x16x32_bf16 v[164:167], a[52:55], v[152:155], v[164:167]
    s_waitcnt vmcnt(2)
    buffer_load_dwordx4 v4, s[8:11], s68 offen offset:256 sc1 lds
    v_mfma_f32_16x16x32_bf16 v[168:171], a[56:59], v[152:155], v[168:171]
    s_mov_b32 m0, s64
    v_sub_u32_e64 v19, 64, s74
    v_mul_f32 v189, v17, v189
    v_mfma_f32_16x16x32_bf16 v[172:175], a[60:63], v[152:155], v[172:175]
    buffer_store_dword v19, v7, s[4:7], s67 offen
    v_mfma_f32_16x16x32_bf16 v[160:163], a[64:67], v[156:159], v[160:163]
    s_bitcmp1_b32 s84, s75
    ds_read_b128 v[152:155], v2 offset:8192
    v_mul_f32 v190, v17, v190
    v_mfma_f32_16x16x32_bf16 v[164:167], a[68:71], v[156:159], v[164:167]
    s_cbranch_scc1 ev_43
evr_44:
    buffer_load_dwordx4 v4, s[8:11], s68 offen offset:384 sc1 lds
    v_mfma_f32_16x16x32_bf16 v[168:171], a[72:75], v[156:159], v[168:171]
    s_mov_b32 m0, s65
    v_mul_f32 v191, v17, v191
    v_cvt_pk_bf16_f32 v74, v188, v189
    v_mfma_f32_16x16x32_bf16 v[172:175], a[76:79], v[156:159], v[172:175]
    s_waitcnt lgkmcnt(1)
    v_cvt_pk_bf16_f32 v75, v190, v191
    v_and_b32 v82, v10, v74
    v_mfma_f32_16x16x32_bf16 v[160:163], a[80:83], v[140:143], v[160:163]
    ds_read_b128 v[156:159], v3 offset:8192
    v_and_b32 v83, v10, v75
    v_mfma_f32_16x16x32_bf16 v[164:167], a[84:87], v[140:143], v[164:167]
    buffer_load_dwordx4 v4, s[8:11], s68 offen offset:512 sc1 lds
    v_mfma_f32_16x16x32_bf16 v[168:171], a[88:91], v[140:143], v[168:171]
    buffer_load_dwordx4 v[118:121], v5, s[4:7], s70 offen sc1
    v_mfma_f32_16x16x32_bf16 v[172:175], a[92:95], v[140:143], v[172:175]
    v_fma_f32 v184, -v16, v56, v184
    v_fma_f32 v185, -v16, v57, v185
    v_mfma_f32_16x16x32_bf16 v[160:163], a[96:99], v[144:147], v[160:163]
    s_add_u32 s26, s75, 1
    ds_read_b128 v[140:143], v2 offset:10240
    v_mfma_f32_16x16x32_bf16 v[110:113], v[80:83], v[64:67], v[36:39]
    s_and_b32 s70, s26, 15
    v_fma_f32 v186, -v16, v58, v186
    v_fma_f32 v187, -v16, v59, v187
    v_mfma_f32_16x16x32_bf16 v[164:167], a[100:103], v[144:147], v[164:167]
    s_lshl_b32 s70, s70, 10
    v_mul_f32 v184, v18, v184
    v_mul_f32 v185, v18, v185
    v_mfma_f32_16x16x32_bf16 v[168:171], a[104:107], v[144:147], v[168:171]
    s_sub_u32 s70, s77, s70
    v_mul_f32 v186, v18, v186
    v_mul_f32 v187, v18, v187
    v_mfma_f32_16x16x32_bf16 v[172:175], a[108:111], v[144:147], v[172:175]
    v_cvt_pk_bf16_f32 v72, v184, v185
    v_cvt_pk_bf16_f32 v73, v186, v187
    v_mfma_f32_16x16x32_bf16 v[160:163], a[112:115], v[148:151], v[160:163]
    s_lshr_b32 s26, s26, 4
    ds_read_b128 v[144:147], v3 offset:10240
    v_max_f32 v110, v110, v114
    v_mfma_f32_16x16x32_bf16 v[164:167], a[116:119], v[148:151], v[164:167]
    s_lshl_b32 s26, s26, 17
    v_max_f32 v111, v111, v115
    v_mfma_f32_16x16x32_bf16 v[102:105], v[72:75], v[20:23], 0
    s_add_u32 s70, s70, s26
    v_max_f32 v112, v112, v116
    v_max_f32 v113, v113, v117
    v_mfma_f32_16x16x32_bf16 v[168:171], a[120:123], v[148:151], v[168:171]
    s_sub_u32 s72, 75, s75
    v_mfma_f32_16x16x32_bf16 v[106:109], v[72:75], v[24:27], v[28:31]
    s_add_u32 s26, s75, 2
    v_max3_f32 v128, v110, v111, v112
    v_max_f32 v128, v128, v113
    v_mfma_f32_16x16x32_bf16 v[172:175], a[124:127], v[148:151], v[172:175]
    s_waitcnt lgkmcnt(1)
    v_mov_b32 v129, v128
    s_min_u32 s26, s26, 31
    v_mfma_f32_16x16x32_bf16 v[160:163], a[128:131], v[152:155], v[160:163]
    s_and_b32 s26, s26, 15
    ds_read_b128 v[148:151], v2 offset:12288
    s_mul_i32 s26, s26, 40960
    v_mfma_f32_16x16x32_bf16 v[164:167], a[132:135], v[152:155], v[164:167]
    s_sub_u32 s68, s76, s26
    v_permlane32_swap_b32 v128, v129
    v_mfma_f32_16x16x32_bf16 v[168:171], a[136:139], v[152:155], v[168:171]
    s_cmp_ge_u32 s75, 14
    v_max_f32 v128, v128, v129
    v_mov_b32 v129, v128
    v_mfma_f32_16x16x32_bf16 v[172:175], a[140:143], v[152:155], v[172:175]
    v_cvt_pk_bf16_f32 v86, v102, v103
    v_cvt_pk_bf16_f32 v87, v104, v105
    v_mfma_f32_16x16x32_bf16 v[160:163], a[144:147], v[156:159], v[160:163]
    s_cselect_b32 s8, s52, s32
    ds_read_b128 v[152:155], v3 offset:12288
    s_cselect_b32 s9, s53, s33
    v_mfma_f32_16x16x32_bf16 v[164:167], a[148:151], v[156:159], v[164:167]
    v_permlane16_swap_b32 v128, v129
    v_mfma_f32_16x16x32_bf16 v[168:171], a[152:155], v[156:159], v[168:171]
    v_max_f32 v128, v128, v129
    v_mul_f32 v128, v128, v14
    v_mfma_f32_16x16x32_bf16 v[172:175], a[156:159], v[156:159], v[172:175]
    v_fma_f32 v110, v110, v14, -v128
    v_fma_f32 v111, v111, v14, -v128
    v_mfma_f32_16x16x32_bf16 v[160:163], a[160:163], v[140:143], v[160:163]
    ds_read_b128 v[156:159], v2 offset:14336
    v_fma_f32 v112, v112, v14, -v128
    v_mfma_f32_16x16x32_bf16 v[164:167], a[164:167], v[140:143], v[164:167]
    v_fma_f32 v113, v113, v14, -v128
    v_mfma_f32_16x16x32_bf16 v[168:171], a[168:171], v[140:143], v[168:171]
    v_exp_f32 v110, v110
    v_mfma_f32_16x16x32_bf16 v[172:175], a[172:175], v[140:143], v[172:175]
    s_waitcnt lgkmcnt(2)
    v_exp_f32 v111, v111
    v_mfma_f32_16x16x32_bf16 v[160:163], a[176:179], v[144:147], v[160:163]
    ds_read_b128 v[140:143], v3 offset:14336
    v_mfma_f32_16x16x32_bf16 v[164:167], a[180:183], v[144:147], v[164:167]
    v_exp_f32 v112, v112
    v_mfma_f32_16x16x32_bf16 v[168:171], a[184:187], v[144:147], v[168:171]
    v_exp_f32 v113, v113
    v_mfma_f32_16x16x32_bf16 v[172:175], a[188:191], v[144:147], v[172:175]
    v_cvt_pk_bf16_f32 v92, v106, v107
    v_cvt_pk_bf16_f32 v93, v108, v109
    v_mfma_f32_16x16x32_bf16 v[160:163], a[192:195], v[148:151], v[160:163]
    ds_read_b128 v[144:147], v2 offset:16384
    v_cvt_pk_bf16_f32 v130, v110, v111
    v_mfma_f32_16x16x32_bf16 v[164:167], a[196:199], v[148:151], v[164:167]
    v_cvt_pk_bf16_f32 v131, v112, v113
    v_and_b32 v96, v12, v130
    v_mfma_f32_16x16x32_bf16 v[168:171], a[200:203], v[148:151], v[168:171]
    v_and_b32 v97, v13, v131
    v_xor_b32 v98, v96, v130
    v_mfma_f32_16x16x32_bf16 v[172:175], a[204:207], v[148:151], v[172:175]
    s_waitcnt lgkmcnt(2)
    v_xor_b32 v99, v97, v131
    v_fma_f32 v176, -v16, v48, v176
    v_mfma_f32_16x16x32_bf16 v[160:163], a[208:211], v[152:155], v[160:163]
    ds_read_b128 v[148:151], v3 offset:16384
    v_fma_f32 v177, -v16, v49, v177
    v_mfma_f32_16x16x32_bf16 v[164:167], a[212:215], v[152:155], v[164:167]
    buffer_load_dwordx4 v[122:125], v6, s[4:7], s73 offen sc1
    v_mfma_f32_16x16x32_bf16 v[168:171], a[216:219], v[152:155], v[168:171]
    v_mfma_f32_16x16x32_bf16 v[106:109], v[90:93], v[96:99], 0
    v_mfma_f32_16x16x32_bf16 v[102:105], v[84:87], v[96:99], 0
    v_fma_f32 v178, -v16, v50, v178
    v_fma_f32 v179, -v16, v51, v179
    v_mfma_f32_16x16x32_bf16 v[172:175], a[220:223], v[152:155], v[172:175]
    v_cvt_pk_bf16_f32 v70, v176, v177
    v_cvt_pk_bf16_f32 v71, v178, v179
    v_mfma_f32_16x16x32_bf16 v[160:163], a[224:227], v[156:159], v[160:163]
    ds_read_b128 v[152:155], v2 offset:18432
    s_waitcnt vmcnt(1)
    v_add_f32 v118, v118, v120
    v_mfma_f32_16x16x32_bf16 v[164:167], a[228:231], v[156:159], v[164:167]
    v_rcp_f32 v128, v108
    v_mfma_f32_16x16x32_bf16 v[168:171], a[232:235], v[156:159], v[168:171]
    v_mul_f32 v106, v128, v106
    v_mul_f32 v107, v128, v107
    v_mfma_f32_16x16x32_bf16 v[172:175], a[236:239], v[156:159], v[172:175]
    s_waitcnt lgkmcnt(1)
    v_mul_f32 v102, v128, v102
    v_mul_f32 v103, v128, v103
    v_mfma_f32_16x16x32_bf16 v[160:163], a[240:243], v[140:143], v[160:163]
    ds_read_b128 v[156:159], v3 offset:18432
    v_mul_f32 v104, v128, v104
    v_mfma_f32_16x16x32_bf16 v[164:167], a[244:247], v[140:143], v[164:167]
    v_mul_f32 v105, v128, v105
    v_cvt_pk_bf16_f32 v134, v106, v107
    v_mfma_f32_16x16x32_bf16 v[168:171], a[248:251], v[140:143], v[168:171]
    v_cvt_pk_bf16_f32 v132, v102, v103
    v_cvt_pk_bf16_f32 v133, v104, v105
    v_mfma_f32_16x16x32_bf16 v[172:175], a[252:255], v[140:143], v[172:175]
    buffer_store_dwordx2 v[132:133], v8, s[4:7], s71 offen
    v_mfma_f32_16x16x32_bf16 v[160:163], v[192:195], v[144:147], v[160:163]
    buffer_store_dword v134, v9, s[4:7], s71 offen
    v_mfma_f32_16x16x32_bf16 v[164:167], v[196:199], v[144:147], v[164:167]
    s_sub_u32 s74, s75, 1
    v_add_f32 v119, v119, v121
    s_and_b32 s25, s74, 7
    v_mfma_f32_16x16x32_bf16 v[168:171], v[200:203], v[144:147], v[168:171]
    s_mul_i32 s25, s25, 20480
    v_permlane32_swap_b32 v118, v119
    v_mfma_f32_16x16x32_bf16 v[172:175], v[204:207], v[144:147], v[172:175]
    v_add_f32 v118, v118, v119
    v_mov_b32 v119, v118
    v_mfma_f32_16x16x32_bf16 v[160:163], v[208:211], v[148:151], v[160:163]
    s_add_u32 s71, s25, s78
    v_permlane16_swap_b32 v118, v119
    v_mfma_f32_16x16x32_bf16 v[164:167], v[212:215], v[148:151], v[164:167]
    s_waitcnt lgkmcnt(0)
    s_barrier
    v_mfma_f32_16x16x32_bf16 v[168:171], v[216:219], v[148:151], v[168:171]
    s_add_u32 s75, s75, 1
    ds_read_b128 v[140:143], v2 offset:20480
    v_add_f32 v118, v118, v119
    v_mfma_f32_16x16x32_bf16 v[172:175], v[220:223], v[148:151], v[172:175]
    ds_read_b128 v[144:147], v3 offset:20480
    v_mov_b32 v119, v118
    v_mfma_f32_16x16x32_bf16 v[160:163], v[224:227], v[152:155], v[160:163]
    ds_read_b128 v[148:151], v2 offset:22528
    v_mfma_f32_16x16x32_bf16 v[164:167], v[228:231], v[152:155], v[164:167]
    v_permlane32_swap_b32 v118, v119
    v_mfma_f32_16x16x32_bf16 v[168:171], v[232:235], v[152:155], v[168:171]
    v_mul_f32 v16, s91, v118
    v_fma_f32 v118, v16, v16, -s92
    v_mfma_f32_16x16x32_bf16 v[172:175], v[236:239], v[152:155], v[172:175]
    v_fma_f32 v119, v119, s91, -v118
    v_max_f32 v119, s92, v119
    v_mfma_f32_16x16x32_bf16 v[160:163], v[240:243], v[156:159], v[160:163]
    ds_read_b128 v[152:155], v3 offset:22528
    v_mfma_f32_16x16x32_bf16 v[164:167], v[244:247], v[156:159], v[164:167]
    v_rsq_f32 v17, v119
    v_mfma_f32_16x16x32_bf16 v[168:171], v[248:251], v[156:159], v[168:171]
    v_mul_f32 v14, s93, v17
    v_cndmask_b32 v18, v17, 1.0, s[30:31]
    v_mfma_f32_16x16x32_bf16 v[172:175], v[252:255], v[156:159], v[172:175]
    s_branch p1loop_15
ev_43:
    s_bitcmp1_b32 s75, 3
    s_cbranch_scc1 ev2_45
    v_mov_b32 v102, v84
    v_mov_b32 v104, v90
    v_mov_b32 v103, v85
    v_mov_b32 v105, v91
    buffer_store_dwordx4 v[76:79], v5, s[4:7], s80 offen sc1
    buffer_store_dwordx4 v[102:105], v5, s[4:7], s80 offen offset:1024 sc1
    s_add_u32 s80, s80, 2048
    s_branch evr_44
ev2_45:
    v_readfirstlane_b32 s25, v135
    s_and_b32 s29, s88, s90
    s_cmp_lt_u32 s25, s29
    s_cbranch_scc1 evs_46
evd_47:
    buffer_load_dwordx4 v[44:47], v5, s[4:7], s81 offen sc1
    buffer_load_dwordx2 v[88:89], v5, s[4:7], s81 offen offset:1024 sc1
    buffer_load_dwordx2 v[94:95], v5, s[4:7], s81 offen offset:1032 sc1
    s_add_u32 s81, s81, 2048
    s_add_u32 s88, s88, 1
    s_branch evr_44
ev_30:
    s_bitcmp1_b32 s75, 3
    s_cbranch_scc1 ev2_32
    v_mov_b32 v130, s88
    buffer_store_dword v130, v7, s[4:7], s82 offen sc1
    s_branch evr_31
ev2_32:
    s_cmp_eq_u32 s75, 9
    s_cbranch_scc1 evx_33
    buffer_load_dword v135, v7, s[4:7], s83 offen sc1
    s_branch evr_31
alt_17:
    s_nop 1
    v_mfma_f32_16x16x32_bf16 v[110:113], v[44:47], v[70:73], v[40:43]
    s_nop 6
    s_branch altr_18
alt_19:
    s_nop 1
    v_mov_b32 v100, v96
    v_mov_b32 v101, v97
    s_nop 1
    v_mfma_f32_16x16x32_bf16 v[106:109], v[92:95], v[98:101], 0
    v_mfma_f32_16x16x32_bf16 v[102:105], v[86:89], v[98:101], 0
    s_nop 6
    s_branch altr_20
p1exit_16:
    s_nop 3
    v_mfma_f32_16x16x32_bf16 v[114:117], v[76:79], v[64:67], v[32:35]
    s_nop 0
    v_fma_f32 v180, -v16, v52, v180
    v_fma_f32 v181, -v16, v53, v181
    v_fma_f32 v182, -v16, v54, v182
    v_fma_f32 v183, -v16, v55, v183
    v_mul_f32 v180, v17, v180
    v_mul_f32 v181, v17, v181
    v_mul_f32 v182, v17, v182
    v_mul_f32 v183, v17, v183
    v_cvt_pk_bf16_f32 v80, v180, v181
    v_cvt_pk_bf16_f32 v81, v182, v183
    v_fma_f32 v188, -v16, v60, v188
    v_fma_f32 v189, -v16, v61, v189
    v_fma_f32 v190, -v16, v62, v190
    v_fma_f32 v191, -v16, v63, v191
    v_mul_f32 v188, v17, v188
    v_mul_f32 v189, v17, v189
    v_mul_f32 v190, v17, v190
    v_mul_f32 v191, v17, v191
    v_cvt_pk_bf16_f32 v74, v188, v189
    v_cvt_pk_bf16_f32 v75, v190, v191
    v_and_b32 v82, v10, v74
    v_and_b32 v83, v10, v75
    v_fma_f32 v184, -v16, v56, v184
    v_fma_f32 v185, -v16, v57, v185
    v_mfma_f32_16x16x32_bf16 v[110:113], v[80:83], v[64:67], v[36:39]
    s_waitcnt vmcnt(0) lgkmcnt(0)
    v_sub_u32_e64 v19, 64, s74
    s_bitcmp1_b32 s20, 0
    s_cbranch_scc1 pub_48
pubr_49:
    buffer_store_dword v19, v7, s[4:7], s67 offen
    s_mov_b32 s72, 43
    v_max3_u32 v126, v122, v123, v124
    v_max_u32 v126, v126, v125
    v_add_u32 v127, s72, v11
    v_cmp_lt_u32 vcc, v127, v126
    s_nop 1
    s_cbranch_vccz fg_50
    s_mov_b32 s29, 0
spin_51:
    buffer_load_dwordx4 v[122:125], v6, s[4:7], s73 offen sc1
    s_waitcnt vmcnt(0)
    v_max3_u32 v126, v122, v123, v124
    v_max_u32 v126, v126, v125
    v_add_u32 v127, s72, v11
    v_cmp_lt_u32 vcc, v127, v126
    s_nop 1
    s_cbranch_vccz spind_52
    s_sleep 3
    s_add_u32 s29, s29, 1
    s_cmp_lt_u32 s29, 20000
    s_cbranch_scc1 spin_51
    s_mov_b32 s29, 4
    s_branch L_fail
spind_52:
fg_50:
    v_fma_f32 v186, -v16, v58, v186
    v_fma_f32 v187, -v16, v59, v187
    v_mul_f32 v184, v18, v184
    v_mul_f32 v185, v18, v185
    v_mul_f32 v186, v18, v186
    v_mul_f32 v187, v18, v187
    v_cvt_pk_bf16_f32 v72, v184, v185
    v_cvt_pk_bf16_f32 v73, v186, v187
    v_max_f32 v110, v110, v114
    v_max_f32 v111, v111, v115
    v_mfma_f32_16x16x32_bf16 v[102:105], v[72:75], v[20:23], 0
    v_max_f32 v112, v112, v116
    v_max_f32 v113, v113, v117
    v_mfma_f32_16x16x32_bf16 v[106:109], v[72:75], v[24:27], v[28:31]
    v_max3_f32 v128, v110, v111, v112
    v_max_f32 v128, v128, v113
    v_mov_b32 v129, v128
    s_nop 1
    v_permlane32_swap_b32 v128, v129
    v_max_f32 v128, v128, v129
    v_mov_b32 v129, v128
    v_cvt_pk_bf16_f32 v86, v102, v103
    v_cvt_pk_bf16_f32 v87, v104, v105
    v_permlane16_swap_b32 v128, v129
    v_max_f32 v128, v128, v129
    v_mul_f32 v128, v128, v14
    v_fma_f32 v110, v110, v14, -v128
    v_fma_f32 v111, v111, v14, -v128
    v_fma_f32 v112, v112, v14, -v128
    v_fma_f32 v113, v113, v14, -v128
    v_exp_f32 v110, v110
    v_exp_f32 v111, v111
    v_exp_f32 v112, v112
    v_exp_f32 v113, v113
    v_cvt_pk_bf16_f32 v92, v106, v107
    v_cvt_pk_bf16_f32 v93, v108, v109
    v_cvt_pk_bf16_f32 v130, v110, v111
    v_cvt_pk_bf16_f32 v131, v112, v113
    v_and_b32 v96, v12, v130
    v_and_b32 v97, v13, v131
    v_xor_b32 v98, v96, v130
    v_xor_b32 v99, v97, v131
    v_fma_f32 v176, -v16, v48, v176
    v_fma_f32 v177, -v16, v49, v177
    v_mfma_f32_16x16x32_bf16 v[106:109], v[90:93], v[96:99], 0
    v_mfma_f32_16x16x32_bf16 v[102:105], v[84:87], v[96:99], 0
    v_fma_f32 v178, -v16, v50, v178
    v_fma_f32 v179, -v16, v51, v179
    v_cvt_pk_bf16_f32 v70, v176, v177
    v_cvt_pk_bf16_f32 v71, v178, v179
    s_nop 2
    v_rcp_f32 v128, v108
    s_nop 0
    v_mul_f32 v106, v128, v106
    v_mul_f32 v107, v128, v107
    v_mul_f32 v102, v128, v102
    v_mul_f32 v103, v128, v103
    v_mul_f32 v104, v128, v104
    v_mul_f32 v105, v128, v105
    v_cvt_pk_bf16_f32 v134, v106, v107
    v_cvt_pk_bf16_f32 v132, v102, v103
    v_cvt_pk_bf16_f32 v133, v104, v105
    buffer_store_dwordx2 v[132:133], v8, s[4:7], s71 offen
    buffer_store_dword v134, v9, s[4:7], s71 offen
    s_add_u32 s71, s78, 143360
    s_mov_b32 s74, 31
    v_mfma_f32_16x16x32_bf16 v[114:117], v[80:83], v[70:73], v[32:35]
    v_mfma_f32_16x16x32_bf16 v[110:113], v[44:47], v[70:73], v[40:43]
    s_nop 7
    v_max_f32 v110, v110, v114
    v_max_f32 v111, v111, v115
    v_max_f32 v112, v112, v116
    v_max_f32 v113, v113, v117
    v_max3_f32 v128, v110, v111, v112
    v_max_f32 v128, v128, v113
    v_mov_b32 v129, v128
    s_nop 1
    v_permlane32_swap_b32 v128, v129
    v_max_f32 v128, v128, v129
    v_mov_b32 v129, v128
    s_nop 1
    v_permlane16_swap_b32 v128, v129
    v_max_f32 v128, v128, v129
    v_mul_f32 v128, v128, v15
    v_fma_f32 v110, v110, v15, -v128
    v_fma_f32 v111, v111, v15, -v128
    v_fma_f32 v112, v112, v15, -v128
    v_fma_f32 v113, v113, v15, -v128
    v_exp_f32 v110, v110
    v_exp_f32 v111, v111
    v_exp_f32 v112, v112
    v_exp_f32 v113, v113
    v_cvt_pk_bf16_f32 v130, v110, v111
    v_cvt_pk_bf16_f32 v131, v112, v113
    v_and_b32 v98, v12, v130
    v_and_b32 v99, v13, v131
    v_xor_b32 v96, v98, v130
    v_xor_b32 v97, v99, v131
    v_mov_b32 v100, v96
    s_waitcnt vmcnt(0)
    v_sub_u32_e64 v19, 64, s74
    s_bitcmp1_b32 s20, 0
    s_cbranch_scc1 pub_53
pubr_54:
    buffer_store_dword v19, v7, s[4:7], s67 offen
    v_mov_b32 v101, v97
    s_nop 1
    v_mfma_f32_16x16x32_bf16 v[106:109], v[92:95], v[98:101], 0
    v_mfma_f32_16x16x32_bf16 v[102:105], v[86:89], v[98:101], 0
    s_nop 6
    v_rcp_f32 v128, v108
    s_nop 0
    v_mul_f32 v106, v128, v106
    v_mul_f32 v107, v128, v107
    v_mul_f32 v102, v128, v102
    v_mul_f32 v103, v128, v103
    v_mul_f32 v104, v128, v104
    v_mul_f32 v105, v128, v105
    v_cvt_pk_bf16_f32 v134, v106, v107
    v_cvt_pk_bf16_f32 v132, v102, v103
    v_cvt_pk_bf16_f32 v133, v104, v105
    buffer_store_dwordx2 v[132:133], v8, s[4:7], s71 offen
    buffer_store_dword v134, v9, s[4:7], s71 offen
    s_mov_b32 s74, 32
    s_waitcnt vmcnt(0)
    v_sub_u32_e64 v19, 64, s74
    s_bitcmp1_b32 s20, 0
    s_cbranch_scc1 pub_55
pubr_56:
    buffer_store_dword v19, v7, s[4:7], s67 offen
    s_endpgm
evs_46:
    buffer_load_dword v135, v7, s[4:7], s83 offen sc1
    s_waitcnt vmcnt(0)
    v_readfirstlane_b32 s25, v135
    s_nop 0
    s_cmp_ge_u32 s25, s88
    s_cbranch_scc1 evd_47
    s_sleep 2
    s_add_u32 s29, s29, 1
    s_cmp_lt_u32 s29, 20000
    s_cbranch_scc1 evs_46
    s_mov_b32 s29, 3
    s_branch L_fail
evx_33:
    v_mul_u32_u24 v130, 26, v1
    v_lshrrev_b32 v130, 8, v130
    v_mul_u32_u24 v130, 1280, v130
    v_lshl_add_u32 v130, v1, 7, v130
    s_mul_i32 s25, s85, 20480
    s_add_u32 s25, s25, s76
    s_add_u32 s25, s25, 0x186a000
    s_mov_b32 exec_hi, 0xff
    buffer_load_dword v136, v130, s[4:7], s25 offen sc1
    s_add_u32 s25, s25, 10240
    buffer_load_dword v136, v130, s[4:7], s25 offen sc1
    s_mov_b64 exec, 15
    v_lshlrev_b32 v130, 7, v1
    s_lshl_b32 s25, s85, 9
    s_add_u32 s25, s25, s77
    s_add_u32 s25, s25, 0x1c400
    buffer_load_dword v136, v130, s[4:7], s25 offen sc1
    s_mov_b64 exec, -1
    s_branch evr_31
pub_13:
    s_nop 1
    s_waitcnt vmcnt(0)
    buffer_wbl2 sc1
    s_waitcnt vmcnt(0)
    buffer_store_dword v19, v7, s[4:7], s66 offen sc1
    s_branch pubr_14
pub_23:
    s_nop 1
    s_waitcnt vmcnt(0)
    buffer_wbl2 sc1
    s_waitcnt vmcnt(0)
    buffer_store_dword v19, v7, s[4:7], s66 offen sc1
    s_branch pubr_24
slow_21:
    s_cselect_b32 s28, 1, 0
    s_waitcnt vmcnt(0)
    v_sub_u32_e64 v19, 64, s74
    s_bitcmp1_b32 s20, 0
    s_cbranch_scc1 pub_23
pubr_24:
    buffer_store_dword v19, v7, s[4:7], s67 offen
    s_mov_b32 s29, 0
spin_25:
    buffer_load_dwordx4 v[122:125], v6, s[4:7], s73 offen sc1
    s_waitcnt vmcnt(0)
    v_max3_u32 v126, v122, v123, v124
    v_max_u32 v126, v126, v125
    v_add_u32 v127, s72, v11
    v_cmp_lt_u32 vcc, v127, v126
    s_nop 1
    s_cbranch_vccz spind_26
    s_sleep 3
    s_add_u32 s29, s29, 1
    s_cmp_lt_u32 s29, 20000
    s_cbranch_scc1 spin_25
    s_mov_b32 s29, 2
    s_branch L_fail
spind_26:
    s_bitcmp1_b32 s20, 0
    s_cbranch_scc0 acq_27
    buffer_inv sc1
    s_waitcnt vmcnt(0)
acq_27:
    s_cmp_lg_u32 s28, 0
    s_branch ret_22
pub_36:
    s_nop 1
    s_waitcnt vmcnt(0)
    buffer_wbl2 sc1
    s_waitcnt vmcnt(0)
    buffer_store_dword v19, v7, s[4:7], s66 offen sc1
    s_branch pubr_37
slow_34:
    s_cselect_b32 s28, 1, 0
    s_waitcnt vmcnt(0)
    v_sub_u32_e64 v19, 64, s74
    s_bitcmp1_b32 s20, 0
    s_cbranch_scc1 pub_36
pubr_37:
    buffer_store_dword v19, v7, s[4:7], s67 offen
    s_mov_b32 s29, 0
spin_38:
    buffer_load_dwordx4 v[122:125], v6, s[4:7], s73 offen sc1
    s_waitcnt vmcnt(0)
    v_max3_u32 v126, v122, v123, v124
    v_max_u32 v126, v126, v125
    v_add_u32 v127, s72, v11
    v_cmp_lt_u32 vcc, v127, v126
    s_nop 1
    s_cbranch_vccz spind_39
    s_sleep 3
    s_add_u32 s29, s29, 1
    s_cmp_lt_u32 s29, 20000
    s_cbranch_scc1 spin_38
    s_mov_b32 s29, 2
    s_branch L_fail
spind_39:
    s_bitcmp1_b32 s20, 0
    s_cbranch_scc0 acq_40
    buffer_inv sc1
    s_waitcnt vmcnt(0)
acq_40:
    s_cmp_lg_u32 s28, 0
    s_branch ret_35
pub_48:
    s_nop 1
    s_waitcnt vmcnt(0)
    buffer_wbl2 sc1
    s_waitcnt vmcnt(0)
    buffer_store_dword v19, v7, s[4:7], s66 offen sc1
    s_branch pubr_49
pub_53:
    s_nop 1
    s_waitcnt vmcnt(0)
    buffer_wbl2 sc1
    s_waitcnt vmcnt(0)
    buffer_store_dword v19, v7, s[4:7], s66 offen sc1
    s_branch pubr_54
pub_55:
    s_nop 1
    s_waitcnt vmcnt(0)
    buffer_wbl2 sc1
    s_waitcnt vmcnt(0)
    buffer_store_dword v19, v7, s[4:7], s66 offen sc1
    s_branch pubr_56
E_p1:
    s_endpgm
L_rest:
    v_lshlrev_b32 v131, 7, v1
    s_cmp_lt_u32 s22, 16
    s_cbranch_scc1 L_p4
    s_cmp_ge_u32 s22, 19
    s_cbranch_scc1 L_pf
    s_lshr_b32 s25, s2, 3
    s_lshl_b32 s25, s25, 2
    s_add_u32 s25, s25, s23
    s_cmp_lg_u32 s25, 64
    s_cbranch_scc1 nol_57
    v_mov_b32 v6, 65
    v_mov_b32 v7, 65
    v_mov_b32 v8, 65
    v_mov_b32 v9, 65
    v_writelane_b32 v6, 0, 19
    v_writelane_b32 v7, 0, 19
    v_writelane_b32 v8, 0, 18
    v_writelane_b32 v9, 0, 18
    v_mov_b32 v10, 0
    v_lshlrev_b32 v11, 7, v1
    s_mov_b32 exec_hi, 1
    buffer_store_dwordx4 v[6:9], v11, s[4:7], s54 offen sc1
    s_mov_b32 exec_hi, 0
    s_add_u32 s25, s21, 0x8000
    buffer_store_dword v10, v11, s[4:7], s25 offen sc1
    s_add_u32 s25, s21, 0x10000
    buffer_store_dword v10, v11, s[4:7], s25 offen sc1
    s_mov_b32 exec_hi, -1
    v_lshlrev_b32 v11, 26, v1
    v_mov_b32 v10, 1
    s_lshl_b32 s25, s24, 5
    s_waitcnt vmcnt(0)
    buffer_store_dword v10, v11, s[16:19], s25 offen sc1
nol_57:
    s_branch L_pfd
L_pf:
    s_sub_u32 s27, s22, 19
    s_mul_i32 s27, s27, 4
    s_add_u32 s27, s27, s23
    s_mov_b32 s12, s40
    s_mov_b32 s13, s41
    s_mov_b32 s14, 0x21c000
    s_mov_b32 s15, 0x20000
    s_mov_b32 s8, s42
    s_mov_b32 s9, s43
    s_mov_b32 s10, 0x21c000
    s_mov_b32 s11, 0x20000
    v_mul_u32_u24 v4, 3456, v1
    s_mul_i32 s25, s27, 221184
    buffer_load_dword v136, v4, s[12:15], s25 offen
    s_sub_u32 s25, s25, 4423680
    s_cselect_b32 s25, 0x2000000, s25
    buffer_load_dword v136, v4, s[8:11], s25 offen
    s_mov_b32 s12, s34
    s_mov_b32 s13, s35
    s_mov_b32 s14, 0x258000
    s_mov_b32 s15, 0x20000
    s_mov_b32 s8, s36
    s_mov_b32 s9, s37
    s_mov_b32 s10, 0xc8000
    s_mov_b32 s11, 0x20000
    s_add_u32 s25, s27, 40
    s_lshl_b32 s25, s25, 13
    s_add_u32 s26, s27, 0
    s_lshl_b32 s26, s26, 13
    buffer_load_dword v136, v131, s[12:15], s25 offen
    s_add_u32 s25, s25, 425984
    buffer_load_dword v136, v131, s[8:11], s26 offen
    s_add_u32 s26, s26, 425984
    buffer_load_dword v136, v131, s[12:15], s25 offen
    s_add_u32 s25, s25, 425984
    buffer_load_dword v136, v131, s[12:15], s25 offen
    s_add_u32 s25, s25, 425984
    buffer_load_dword v136, v131, s[8:11], s26 offen
    s_add_u32 s26, s26, 425984
    buffer_load_dword v136, v131, s[12:15], s25 offen
    s_add_u32 s25, s25, 425984
    buffer_load_dword v136, v131, s[12:15], s25 offen
    s_add_u32 s25, s25, 425984
    v_lshlrev_b32 v4, 4, v1
    s_mul_i32 s25, s27, 6144
    s_mul_i32 s26, s24, 0x180000
    s_add_u32 s25, s25, s26
    s_add_u32 s25, s25, 0x100000
    buffer_store_dwordx4 v[8:11], v4, s[4:7], s25 offen offset:0 sc1
    buffer_store_dwordx4 v[8:11], v4, s[4:7], s25 offen offset:1024 sc1
    buffer_store_dwordx4 v[8:11], v4, s[4:7], s25 offen offset:2048 sc1
    buffer_store_dwordx4 v[8:11], v4, s[4:7], s25 offen offset:3072 sc1
    s_add_u32 s25, s25, 4096
    buffer_store_dwordx4 v[8:11], v4, s[4:7], s25 offen offset:0 sc1
    buffer_store_dwordx4 v[8:11], v4, s[4:7], s25 offen offset:1024 sc1
L_pfd:
    s_sub_u32 s25, s22, 16
    s_lshl_b32 s25, s25, 2
    s_add_u32 s25, s25, s23
    s_cmp_ge_u32 s25, 10
    s_cbranch_scc1 L_p3
    s_branch L_p2
L_p4:
    s_sub_u32 s22, s22, 8
    s_mov_b32 s8, s32
    s_mov_b32 s9, s33
    s_mov_b32 s10, 0x280000
    s_mov_b32 s11, 0x20000
    v_lshrrev_b32 v22, 4, v1
    v_and_b32 v23, 15, v1
    v_cmp_gt_u32 vcc, 10, v23
    s_nop 1
    v_cndmask_b32 v11, 0, -1, vcc
    v_not_b32 v25, v11
    v_and_b32 v25, 0x80000000, v25
    v_mul_u32_u24 v24, 2560, v22
    v_lshl_add_u32 v24, v23, 4, v24
    s_mul_i32 s25, s23, 10240
    s_mul_i32 s26, s22, 160
    s_add_u32 s25, s25, s26
    v_add_u32 v24, s25, v24
    v_or_b32 v8, v24, v25
    s_and_b32 s25, s24, 3
    s_lshl_b32 s25, s25, 9
    s_lshr_b32 s26, s24, 2
    s_add_u32 s25, s25, s26
    s_add_u32 s25, s25, 480
    s_mul_i32 s67, s25, 1280
    s_mov_b32 s25, s67
    buffer_load_dwordx4 v[176:179], v8, s[8:11], s25 offen
    s_sub_u32 s25, s25, 40960
    buffer_load_dwordx4 v[180:183], v8, s[8:11], s25 offen
    s_sub_u32 s25, s25, 40960
    buffer_load_dwordx4 v[184:187], v8, s[8:11], s25 offen
    s_sub_u32 s25, s25, 40960
    buffer_load_dwordx4 v[188:191], v8, s[8:11], s25 offen
    s_sub_u32 s25, s25, 40960
    buffer_load_dwordx4 v[192:195], v8, s[8:11], s25 offen
    s_sub_u32 s25, s25, 40960
    buffer_load_dwordx4 v[196:199], v8, s[8:11], s25 offen
    s_sub_u32 s25, s25, 40960
    buffer_load_dwordx4 v[200:203], v8, s[8:11], s25 offen
    s_sub_u32 s25, s25, 40960
    buffer_load_dwordx4 v[204:207], v8, s[8:11], s25 offen
    s_sub_u32 s25, s25, 40960
    buffer_load_dwordx4 v[208:211], v8, s[8:11], s25 offen
    s_sub_u32 s25, s25, 40960
    buffer_load_dwordx4 v[212:215], v8, s[8:11], s25 offen
    s_sub_u32 s25, s25, 40960
    buffer_load_dwordx4 v[216:219], v8, s[8:11], s25 offen
    s_sub_u32 s25, s25, 40960
    buffer_load_dwordx4 v[220:223], v8, s[8:11], s25 offen
    s_sub_u32 s25, s25, 40960
    buffer_load_dwordx4 v[224:227], v8, s[8:11], s25 offen
    s_sub_u32 s25, s25, 40960
    buffer_load_dwordx4 v[228:231], v8, s[8:11], s25 offen
    s_sub_u32 s25, s25, 40960
    buffer_load_dwordx4 v[232:235], v8, s[8:11], s25 offen
    s_sub_u32 s25, s25, 40960
    buffer_load_dwordx4 v[236:239], v8, s[8:11], s25 offen
    s_mov_b32 s12, s44
    s_mov_b32 s13, s45
    s_mov_b32 s14, 0x21c000
    s_mov_b32 s15, 0x20000
    s_mul_i32 s58, s23, 13
    s_min_u32 s25, s23, 1
    s_add_u32 s58, s58, s25
    s_mul_i32 s26, s58, 40960
    s_mul_i32 s25, s22, 160
    s_add_u32 s26, s26, s25
    v_add_u32 v28, 0, v1
    v_mul_u32_u24 v29, 6554, v28
    v_lshrrev_b32 v29, 16, v29
    v_mul_u32_u24 v29, 1120, v29
    v_lshl_add_u32 v29, v28, 4, v29
    v_add_u32 v140, s26, v29
    v_add_u32 v28, 64, v1
    v_mul_u32_u24 v29, 6554, v28
    v_lshrrev_b32 v29, 16, v29
    v_mul_u32_u24 v29, 1120, v29
    v_lshl_add_u32 v29, v28, 4, v29
    v_add_u32 v141, s26, v29
    v_add_u32 v28, 128, v1
    v_mul_u32_u24 v29, 6554, v28
    v_lshrrev_b32 v29, 16, v29
    v_mul_u32_u24 v29, 1120, v29
    v_lshl_add_u32 v29, v28, 4, v29
    v_add_u32 v142, s26, v29
    v_add_u32 v28, 192, v1
    v_mul_u32_u24 v29, 6554, v28
    v_lshrrev_b32 v29, 16, v29
    v_mul_u32_u24 v29, 1120, v29
    v_lshl_add_u32 v29, v28, 4, v29
    v_add_u32 v143, s26, v29
    v_add_u32 v28, 256, v1
    v_mul_u32_u24 v29, 6554, v28
    v_lshrrev_b32 v29, 16, v29
    v_mul_u32_u24 v29, 1120, v29
    v_lshl_add_u32 v29, v28, 4, v29
    v_add_u32 v144, s26, v29
    s_mul_i32 s82, s23, 36864
    v_lshrrev_b32 v28, 4, v1
    v_bfe_u32 v29, v1, 2, 2
    v_and_b32 v30, 3, v1
    v_lshl_add_u32 v28, v28, 3, v29
    v_mul_u32_u24 v28, 160, v28
    v_lshl_add_u32 v28, v30, 3, v28
    v_add_u32 v146, s82, v28
    s_mul_i32 s25, s22, 2560
    s_lshl_b32 s26, s23, 6
    s_add_u32 s25, s25, s26
    v_lshrrev_b32 v24, 2, v1
    v_lshlrev_b32 v24, 8, v24
    v_and_b32 v9, 3, v1
    v_lshl_add_u32 v24, v9, 4, v24
    v_add_u32 v9, s25, v24
    v_mov_b32 v24, 0x0
    s_mov_b32 exec_lo, 0x0
    s_mov_b32 exec_hi, 0xffffff00
    v_mov_b32 v24, 0x80000000
    s_mov_b64 exec, -1
    v_or_b32 v9, v9, v24
    s_lshl_b32 s79, s23, 10
    s_add_u32 s79, s79, 43008
    v_lshlrev_b32 v24, 6, v23
    v_lshl_add_u32 v24, v22, 4, v24
    v_add_u32 v56, s79, v24
    s_lshr_b32 s25, s22, 1
    s_lshl_b32 s25, s25, 8
    s_add_u32 s25, s25, s26
    s_and_b32 s26, s22, 1
    s_lshl_b32 s26, s26, 3
    s_add_u32 s25, s25, s26
    v_mov_b32 v25, 0x80000000
    s_mov_b32 exec_lo, 0x80008000
    s_mov_b32 exec_hi, 0x80008000
    v_mov_b32 v25, 0x0
    s_mov_b64 exec, -1
    v_lshlrev_b32 v24, 4, v22
    v_add_u32 v24, s25, v24
    v_or_b32 v10, v24, v25
    s_lshl_b32 s25, s23, 2
    v_add_u32 v24, s25, v22
    v_min_u32 v25, 9, v23
    v_mul_u32_u24 v24, 336, v24
    v_lshl_add_u32 v7, v25, 5, v24
    v_mul_u32_u24 v24, 336, v23
    v_lshl_add_u32 v24, v22, 4, v24
    s_mul_i32 s25, s23, 5376
    v_add_u32 v6, s25, v24
    s_lshl_b32 s68, s24, 14
    s_add_u32 s68, s68, 0x43c00
    v_mov_b32 v4, 0x80000000
    s_mov_b32 exec_lo, 0x1
    s_mov_b32 exec_hi, 0x0
    v_mov_b32 v4, 0x0
    s_mov_b64 exec, -1
    v_mov_b32 v147, 0x3f803f80
    s_mov_b32 s27, s68
    s_waitcnt vmcnt(0)
    s_cmp_lg_u32 s23, 0
    s_cbranch_scc1 an1_58
    v_mov_b32 v13, s24
    v_lshlrev_b32 v13, 5, v13
    s_mov_b64 exec, 3
    buffer_load_dword v12, v13, s[16:19], 0 offen sc1
    s_mov_b64 exec, -1
an1_58:
    v_dot2_f32_bf16 v148, v176, v147, 0
    v_dot2_f32_bf16 v149, v176, v176, 0
    v_dot2_f32_bf16 v150, v180, v147, 0
    v_dot2_f32_bf16 v151, v180, v180, 0
    v_dot2_f32_bf16 v148, v177, v147, v148
    v_dot2_f32_bf16 v149, v177, v177, v149
    v_dot2_f32_bf16 v150, v181, v147, v150
    v_dot2_f32_bf16 v151, v181, v181, v151
    v_dot2_f32_bf16 v148, v178, v147, v148
    v_dot2_f32_bf16 v149, v178, v178, v149
    v_dot2_f32_bf16 v150, v182, v147, v150
    v_dot2_f32_bf16 v151, v182, v182, v151
    v_dot2_f32_bf16 v148, v179, v147, v148
    v_dot2_f32_bf16 v149, v179, v179, v149
    v_dot2_f32_bf16 v150, v183, v147, v150
    v_dot2_f32_bf16 v151, v183, v183, v151
    v_add_f32_dpp v148, v148, v148 row_shr:1 row_mask:0xf bank_mask:0xf
    v_add_f32_dpp v149, v149, v149 row_shr:1 row_mask:0xf bank_mask:0xf
    v_add_f32_dpp v150, v150, v150 row_shr:1 row_mask:0xf bank_mask:0xf
    v_add_f32_dpp v151, v151, v151 row_shr:1 row_mask:0xf bank_mask:0xf
    v_add_f32_dpp v148, v148, v148 row_shr:2 row_mask:0xf bank_mask:0xf
    v_add_f32_dpp v149, v149, v149 row_shr:2 row_mask:0xf bank_mask:0xf
    v_add_f32_dpp v150, v150, v150 row_shr:2 row_mask:0xf bank_mask:0xf
    v_add_f32_dpp v151, v151, v151 row_shr:2 row_mask:0xf bank_mask:0xf
    v_add_f32_dpp v148, v148, v148 row_shr:4 row_mask:0xf bank_mask:0xf
    v_add_f32_dpp v149, v149, v149 row_shr:4 row_mask:0xf bank_mask:0xf
    v_add_f32_dpp v150, v150, v150 row_shr:4 row_mask:0xf bank_mask:0xf
    v_add_f32_dpp v151, v151, v151 row_shr:4 row_mask:0xf bank_mask:0xf
    v_add_f32_dpp v148, v148, v148 row_shr:8 row_mask:0xf bank_mask:0xf
    v_add_f32_dpp v149, v149, v149 row_shr:8 row_mask:0xf bank_mask:0xf
    v_add_f32_dpp v150, v150, v150 row_shr:8 row_mask:0xf bank_mask:0xf
    v_add_f32_dpp v151, v151, v151 row_shr:8 row_mask:0xf bank_mask:0xf
    buffer_store_dwordx2 v[148:149], v10, s[4:7], s27 offen sc1
    s_sub_u32 s27, s27, 1024
    buffer_store_dwordx2 v[150:151], v10, s[4:7], s27 offen sc1
    s_sub_u32 s27, s27, 1024
    v_dot2_f32_bf16 v152, v184, v147, 0
    v_dot2_f32_bf16 v153, v184, v184, 0
    v_dot2_f32_bf16 v154, v188, v147, 0
    v_dot2_f32_bf16 v155, v188, v188, 0
    v_dot2_f32_bf16 v152, v185, v147, v152
    v_dot2_f32_bf16 v153, v185, v185, v153
    v_dot2_f32_bf16 v154, v189, v147, v154
    v_dot2_f32_bf16 v155, v189, v189, v155
    v_dot2_f32_bf16 v152, v186, v147, v152
    v_dot2_f32_bf16 v153, v186, v186, v153
    v_dot2_f32_bf16 v154, v190, v147, v154
    v_dot2_f32_bf16 v155, v190, v190, v155
    v_dot2_f32_bf16 v152, v187, v147, v152
    v_dot2_f32_bf16 v153, v187, v187, v153
    v_dot2_f32_bf16 v154, v191, v147, v154
    v_dot2_f32_bf16 v155, v191, v191, v155
    v_add_f32_dpp v152, v152, v152 row_shr:1 row_mask:0xf bank_mask:0xf
    v_add_f32_dpp v153, v153, v153 row_shr:1 row_mask:0xf bank_mask:0xf
    v_add_f32_dpp v154, v154, v154 row_shr:1 row_mask:0xf bank_mask:0xf
    v_add_f32_dpp v155, v155, v155 row_shr:1 row_mask:0xf bank_mask:0xf
    v_add_f32_dpp v152, v152, v152 row_shr:2 row_mask:0xf bank_mask:0xf
    v_add_f32_dpp v153, v153, v153 row_shr:2 row_mask:0xf bank_mask:0xf
    v_add_f32_dpp v154, v154, v154 row_shr:2 row_mask:0xf bank_mask:0xf
    v_add_f32_dpp v155, v155, v155 row_shr:2 row_mask:0xf bank_mask:0xf
    v_add_f32_dpp v152, v152, v152 row_shr:4 row_mask:0xf bank_mask:0xf
    v_add_f32_dpp v153, v153, v153 row_shr:4 row_mask:0xf bank_mask:0xf
    v_add_f32_dpp v154, v154, v154 row_shr:4 row_mask:0xf bank_mask:0xf
    v_add_f32_dpp v155, v155, v155 row_shr:4 row_mask:0xf bank_mask:0xf
    v_add_f32_dpp v152, v152, v152 row_shr:8 row_mask:0xf bank_mask:0xf
    v_add_f32_dpp v153, v153, v153 row_shr:8 row_mask:0xf bank_mask:0xf
    v_add_f32_dpp v154, v154, v154 row_shr:8 row_mask:0xf bank_mask:0xf
    v_add_f32_dpp v155, v155, v155 row_shr:8 row_mask:0xf bank_mask:0xf
    buffer_store_dwordx2 v[152:153], v10, s[4:7], s27 offen sc1
    s_sub_u32 s27, s27, 1024
    buffer_store_dwordx2 v[154:155], v10, s[4:7], s27 offen sc1
    s_sub_u32 s27, s27, 1024
    v_dot2_f32_bf16 v156, v192, v147, 0
    v_dot2_f32_bf16 v157, v192, v192, 0
    v_dot2_f32_bf16 v158, v196, v147, 0
    v_dot2_f32_bf16 v159, v196, v196, 0
    v_dot2_f32_bf16 v156, v193, v147, v156
    v_dot2_f32_bf16 v157, v193, v193, v157
    v_dot2_f32_bf16 v158, v197, v147, v158
    v_dot2_f32_bf16 v159, v197, v197, v159
    v_dot2_f32_bf16 v156, v194, v147, v156
    v_dot2_f32_bf16 v157, v194, v194, v157
    v_dot2_f32_bf16 v158, v198, v147, v158
    v_dot2_f32_bf16 v159, v198, v198, v159
    v_dot2_f32_bf16 v156, v195, v147, v156
    v_dot2_f32_bf16 v157, v195, v195, v157
    v_dot2_f32_bf16 v158, v199, v147, v158
    v_dot2_f32_bf16 v159, v199, v199, v159
    v_add_f32_dpp v156, v156, v156 row_shr:1 row_mask:0xf bank_mask:0xf
    v_add_f32_dpp v157, v157, v157 row_shr:1 row_mask:0xf bank_mask:0xf
    v_add_f32_dpp v158, v158, v158 row_shr:1 row_mask:0xf bank_mask:0xf
    v_add_f32_dpp v159, v159, v159 row_shr:1 row_mask:0xf bank_mask:0xf
    v_add_f32_dpp v156, v156, v156 row_shr:2 row_mask:0xf bank_mask:0xf
    v_add_f32_dpp v157, v157, v157 row_shr:2 row_mask:0xf bank_mask:0xf
    v_add_f32_dpp v158, v158, v158 row_shr:2 row_mask:0xf bank_mask:0xf
    v_add_f32_dpp v159, v159, v159 row_shr:2 row_mask:0xf bank_mask:0xf
    v_add_f32_dpp v156, v156, v156 row_shr:4 row_mask:0xf bank_mask:0xf
    v_add_f32_dpp v157, v157, v157 row_shr:4 row_mask:0xf bank_mask:0xf
    v_add_f32_dpp v158, v158, v158 row_shr:4 row_mask:0xf bank_mask:0xf
    v_add_f32_dpp v159, v159, v159 row_shr:4 row_mask:0xf bank_mask:0xf
    v_add_f32_dpp v156, v156, v156 row_shr:8 row_mask:0xf bank_mask:0xf
    v_add_f32_dpp v157, v157, v157 row_shr:8 row_mask:0xf bank_mask:0xf
    v_add_f32_dpp v158, v158, v158 row_shr:8 row_mask:0xf bank_mask:0xf
    v_add_f32_dpp v159, v159, v159 row_shr:8 row_mask:0xf bank_mask:0xf
    buffer_store_dwordx2 v[156:157], v10, s[4:7], s27 offen sc1
    s_sub_u32 s27, s27, 1024
    buffer_store_dwordx2 v[158:159], v10, s[4:7], s27 offen sc1
    s_sub_u32 s27, s27, 1024
    v_dot2_f32_bf16 v160, v200, v147, 0
    v_dot2_f32_bf16 v161, v200, v200, 0
    v_dot2_f32_bf16 v162, v204, v147, 0
    v_dot2_f32_bf16 v163, v204, v204, 0
    v_dot2_f32_bf16 v160, v201, v147, v160
    v_dot2_f32_bf16 v161, v201, v201, v161
    v_dot2_f32_bf16 v162, v205, v147, v162
    v_dot2_f32_bf16 v163, v205, v205, v163
    v_dot2_f32_bf16 v160, v202, v147, v160
    v_dot2_f32_bf16 v161, v202, v202, v161
    v_dot2_f32_bf16 v162, v206, v147, v162
    v_dot2_f32_bf16 v163, v206, v206, v163
    v_dot2_f32_bf16 v160, v203, v147, v160
    v_dot2_f32_bf16 v161, v203, v203, v161
    v_dot2_f32_bf16 v162, v207, v147, v162
    v_dot2_f32_bf16 v163, v207, v207, v163
    v_add_f32_dpp v160, v160, v160 row_shr:1 row_mask:0xf bank_mask:0xf
    v_add_f32_dpp v161, v161, v161 row_shr:1 row_mask:0xf bank_mask:0xf
    v_add_f32_dpp v162, v162, v162 row_shr:1 row_mask:0xf bank_mask:0xf
    v_add_f32_dpp v163, v163, v163 row_shr:1 row_mask:0xf bank_mask:0xf
    v_add_f32_dpp v160, v160, v160 row_shr:2 row_mask:0xf bank_mask:0xf
    v_add_f32_dpp v161, v161, v161 row_shr:2 row_mask:0xf bank_mask:0xf
    v_add_f32_dpp v162, v162, v162 row_shr:2 row_mask:0xf bank_mask:0xf
    v_add_f32_dpp v163, v163, v163 row_shr:2 row_mask:0xf bank_mask:0xf
    v_add_f32_dpp v160, v160, v160 row_shr:4 row_mask:0xf bank_mask:0xf
    v_add_f32_dpp v161, v161, v161 row_shr:4 row_mask:0xf bank_mask:0xf
    v_add_f32_dpp v162, v162, v162 row_shr:4 row_mask:0xf bank_mask:0xf
    v_add_f32_dpp v163, v163, v163 row_shr:4 row_mask:0xf bank_mask:0xf
    v_add_f32_dpp v160, v160, v160 row_shr:8 row_mask:0xf bank_mask:0xf
    v_add_f32_dpp v161, v161, v161 row_shr:8 row_mask:0xf bank_mask:0xf
    v_add_f32_dpp v162, v162, v162 row_shr:8 row_mask:0xf bank_mask:0xf
    v_add_f32_dpp v163, v163, v163 row_shr:8 row_mask:0xf bank_mask:0xf
    buffer_store_dwordx2 v[160:161], v10, s[4:7], s27 offen sc1
    s_sub_u32 s27, s27, 1024
    buffer_store_dwordx2 v[162:163], v10, s[4:7], s27 offen sc1
    s_sub_u32 s27, s27, 1024
    v_dot2_f32_bf16 v148, v208, v147, 0
    v_dot2_f32_bf16 v149, v208, v208, 0
    v_dot2_f32_bf16 v150, v212, v147, 0
    v_dot2_f32_bf16 v151, v212, v212, 0
    v_dot2_f32_bf16 v148, v209, v147, v148
    v_dot2_f32_bf16 v149, v209, v209, v149
    v_dot2_f32_bf16 v150, v213, v147, v150
    v_dot2_f32_bf16 v151, v213, v213, v151
    v_dot2_f32_bf16 v148, v210, v147, v148
    v_dot2_f32_bf16 v149, v210, v210, v149
    v_dot2_f32_bf16 v150, v214, v147, v150
    v_dot2_f32_bf16 v151, v214, v214, v151
    v_dot2_f32_bf16 v148, v211, v147, v148
    v_dot2_f32_bf16 v149, v211, v211, v149
    v_dot2_f32_bf16 v150, v215, v147, v150
    v_dot2_f32_bf16 v151, v215, v215, v151
    v_add_f32_dpp v148, v148, v148 row_shr:1 row_mask:0xf bank_mask:0xf
    v_add_f32_dpp v149, v149, v149 row_shr:1 row_mask:0xf bank_mask:0xf
    v_add_f32_dpp v150, v150, v150 row_shr:1 row_mask:0xf bank_mask:0xf
    v_add_f32_dpp v151, v151, v151 row_shr:1 row_mask:0xf bank_mask:0xf
    v_add_f32_dpp v148, v148, v148 row_shr:2 row_mask:0xf bank_mask:0xf
    v_add_f32_dpp v149, v149, v149 row_shr:2 row_mask:0xf bank_mask:0xf
    v_add_f32_dpp v150, v150, v150 row_shr:2 row_mask:0xf bank_mask:0xf
    v_add_f32_dpp v151, v151, v151 row_shr:2 row_mask:0xf bank_mask:0xf
    v_add_f32_dpp v148, v148, v148 row_shr:4 row_mask:0xf bank_mask:0xf
    v_add_f32_dpp v149, v149, v149 row_shr:4 row_mask:0xf bank_mask:0xf
    v_add_f32_dpp v150, v150, v150 row_shr:4 row_mask:0xf bank_mask:0xf
    v_add_f32_dpp v151, v151, v151 row_shr:4 row_mask:0xf bank_mask:0xf
    v_add_f32_dpp v148, v148, v148 row_shr:8 row_mask:0xf bank_mask:0xf
    v_add_f32_dpp v149, v149, v149 row_shr:8 row_mask:0xf bank_mask:0xf
    v_add_f32_dpp v150, v150, v150 row_shr:8 row_mask:0xf bank_mask:0xf
    v_add_f32_dpp v151, v151, v151 row_shr:8 row_mask:0xf bank_mask:0xf
    buffer_store_dwordx2 v[148:149], v10, s[4:7], s27 offen sc1
    s_sub_u32 s27, s27, 1024
    buffer_store_dwordx2 v[150:151], v10, s[4:7], s27 offen sc1
    s_sub_u32 s27, s27, 1024
    v_dot2_f32_bf16 v152, v216, v147, 0
    v_dot2_f32_bf16 v153, v216, v216, 0
    v_dot2_f32_bf16 v154, v220, v147, 0
    v_dot2_f32_bf16 v155, v220, v220, 0
    v_dot2_f32_bf16 v152, v217, v147, v152
    v_dot2_f32_bf16 v153, v217, v217, v153
    v_dot2_f32_bf16 v154, v221, v147, v154
    v_dot2_f32_bf16 v155, v221, v221, v155
    v_dot2_f32_bf16 v152, v218, v147, v152
    v_dot2_f32_bf16 v153, v218, v218, v153
    v_dot2_f32_bf16 v154, v222, v147, v154
    v_dot2_f32_bf16 v155, v222, v222, v155
    v_dot2_f32_bf16 v152, v219, v147, v152
    v_dot2_f32_bf16 v153, v219, v219, v153
    v_dot2_f32_bf16 v154, v223, v147, v154
    v_dot2_f32_bf16 v155, v223, v223, v155
    v_add_f32_dpp v152, v152, v152 row_shr:1 row_mask:0xf bank_mask:0xf
    v_add_f32_dpp v153, v153, v153 row_shr:1 row_mask:0xf bank_mask:0xf
    v_add_f32_dpp v154, v154, v154 row_shr:1 row_mask:0xf bank_mask:0xf
    v_add_f32_dpp v155, v155, v155 row_shr:1 row_mask:0xf bank_mask:0xf
    v_add_f32_dpp v152, v152, v152 row_shr:2 row_mask:0xf bank_mask:0xf
    v_add_f32_dpp v153, v153, v153 row_shr:2 row_mask:0xf bank_mask:0xf
    v_add_f32_dpp v154, v154, v154 row_shr:2 row_mask:0xf bank_mask:0xf
    v_add_f32_dpp v155, v155, v155 row_shr:2 row_mask:0xf bank_mask:0xf
    v_add_f32_dpp v152, v152, v152 row_shr:4 row_mask:0xf bank_mask:0xf
    v_add_f32_dpp v153, v153, v153 row_shr:4 row_mask:0xf bank_mask:0xf
    v_add_f32_dpp v154, v154, v154 row_shr:4 row_mask:0xf bank_mask:0xf
    v_add_f32_dpp v155, v155, v155 row_shr:4 row_mask:0xf bank_mask:0xf
    v_add_f32_dpp v152, v152, v152 row_shr:8 row_mask:0xf bank_mask:0xf
    v_add_f32_dpp v153, v153, v153 row_shr:8 row_mask:0xf bank_mask:0xf
    v_add_f32_dpp v154, v154, v154 row_shr:8 row_mask:0xf bank_mask:0xf
    v_add_f32_dpp v155, v155, v155 row_shr:8 row_mask:0xf bank_mask:0xf
    buffer_store_dwordx2 v[152:153], v10, s[4:7], s27 offen sc1
    s_sub_u32 s27, s27, 1024
    buffer_store_dwordx2 v[154:155], v10, s[4:7], s27 offen sc1
    s_sub_u32 s27, s27, 1024
    v_dot2_f32_bf16 v156, v224, v147, 0
    v_dot2_f32_bf16 v157, v224, v224, 0
    v_dot2_f32_bf16 v158, v228, v147, 0
    v_dot2_f32_bf16 v159, v228, v228, 0
    v_dot2_f32_bf16 v156, v225, v147, v156
    v_dot2_f32_bf16 v157, v225, v225, v157
    v_dot2_f32_bf16 v158, v229, v147, v158
    v_dot2_f32_bf16 v159, v229, v229, v159
    v_dot2_f32_bf16 v156, v226, v147, v156
    v_dot2_f32_bf16 v157, v226, v226, v157
    v_dot2_f32_bf16 v158, v230, v147, v158
    v_dot2_f32_bf16 v159, v230, v230, v159
    v_dot2_f32_bf16 v156, v227, v147, v156
    v_dot2_f32_bf16 v157, v227, v227, v157
    v_dot2_f32_bf16 v158, v231, v147, v158
    v_dot2_f32_bf16 v159, v231, v231, v159
    v_add_f32_dpp v156, v156, v156 row_shr:1 row_mask:0xf bank_mask:0xf
    v_add_f32_dpp v157, v157, v157 row_shr:1 row_mask:0xf bank_mask:0xf
    v_add_f32_dpp v158, v158, v158 row_shr:1 row_mask:0xf bank_mask:0xf
    v_add_f32_dpp v159, v159, v159 row_shr:1 row_mask:0xf bank_mask:0xf
    v_add_f32_dpp v156, v156, v156 row_shr:2 row_mask:0xf bank_mask:0xf
    v_add_f32_dpp v157, v157, v157 row_shr:2 row_mask:0xf bank_mask:0xf
    v_add_f32_dpp v158, v158, v158 row_shr:2 row_mask:0xf bank_mask:0xf
    v_add_f32_dpp v159, v159, v159 row_shr:2 row_mask:0xf bank_mask:0xf
    v_add_f32_dpp v156, v156, v156 row_shr:4 row_mask:0xf bank_mask:0xf
    v_add_f32_dpp v157, v157, v157 row_shr:4 row_mask:0xf bank_mask:0xf
    v_add_f32_dpp v158, v158, v158 row_shr:4 row_mask:0xf bank_mask:0xf
    v_add_f32_dpp v159, v159, v159 row_shr:4 row_mask:0xf bank_mask:0xf
    v_add_f32_dpp v156, v156, v156 row_shr:8 row_mask:0xf bank_mask:0xf
    v_add_f32_dpp v157, v157, v157 row_shr:8 row_mask:0xf bank_mask:0xf
    v_add_f32_dpp v158, v158, v158 row_shr:8 row_mask:0xf bank_mask:0xf
    v_add_f32_dpp v159, v159, v159 row_shr:8 row_mask:0xf bank_mask:0xf
    buffer_store_dwordx2 v[156:157], v10, s[4:7], s27 offen sc1
    s_sub_u32 s27, s27, 1024
    buffer_store_dwordx2 v[158:159], v10, s[4:7], s27 offen sc1
    s_sub_u32 s27, s27, 1024
    v_dot2_f32_bf16 v160, v232, v147, 0
    v_dot2_f32_bf16 v161, v232, v232, 0
    v_dot2_f32_bf16 v162, v236, v147, 0
    v_dot2_f32_bf16 v163, v236, v236, 0
    v_dot2_f32_bf16 v160, v233, v147, v160
    v_dot2_f32_bf16 v161, v233, v233, v161
    v_dot2_f32_bf16 v162, v237, v147, v162
    v_dot2_f32_bf16 v163, v237, v237, v163
    v_dot2_f32_bf16 v160, v234, v147, v160
    v_dot2_f32_bf16 v161, v234, v234, v161
    v_dot2_f32_bf16 v162, v238, v147, v162
    v_dot2_f32_bf16 v163, v238, v238, v163
    v_dot2_f32_bf16 v160, v235, v147, v160
    v_dot2_f32_bf16 v161, v235, v235, v161
    v_dot2_f32_bf16 v162, v239, v147, v162
    v_dot2_f32_bf16 v163, v239, v239, v163
    v_add_f32_dpp v160, v160, v160 row_shr:1 row_mask:0xf bank_mask:0xf
    v_add_f32_dpp v161, v161, v161 row_shr:1 row_mask:0xf bank_mask:0xf
    v_add_f32_dpp v162, v162, v162 row_shr:1 row_mask:0xf bank_mask:0xf
    v_add_f32_dpp v163, v163, v163 row_shr:1 row_mask:0xf bank_mask:0xf
    v_add_f32_dpp v160, v160, v160 row_shr:2 row_mask:0xf bank_mask:0xf
    v_add_f32_dpp v161, v161, v161 row_shr:2 row_mask:0xf bank_mask:0xf
    v_add_f32_dpp v162, v162, v162 row_shr:2 row_mask:0xf bank_mask:0xf
    v_add_f32_dpp v163, v163, v163 row_shr:2 row_mask:0xf bank_mask:0xf
    v_add_f32_dpp v160, v160, v160 row_shr:4 row_mask:0xf bank_mask:0xf
    v_add_f32_dpp v161, v161, v161 row_shr:4 row_mask:0xf bank_mask:0xf
    v_add_f32_dpp v162, v162, v162 row_shr:4 row_mask:0xf bank_mask:0xf
    v_add_f32_dpp v163, v163, v163 row_shr:4 row_mask:0xf bank_mask:0xf
    v_add_f32_dpp v160, v160, v160 row_shr:8 row_mask:0xf bank_mask:0xf
    v_add_f32_dpp v161, v161, v161 row_shr:8 row_mask:0xf bank_mask:0xf
    v_add_f32_dpp v162, v162, v162 row_shr:8 row_mask:0xf bank_mask:0xf
    v_add_f32_dpp v163, v163, v163 row_shr:8 row_mask:0xf bank_mask:0xf
    buffer_store_dwordx2 v[160:161], v10, s[4:7], s27 offen sc1
    s_sub_u32 s27, s27, 1024
    buffer_store_dwordx2 v[162:163], v10, s[4:7], s27 offen sc1
    s_sub_u32 s27, s27, 1024
    s_waitcnt vmcnt(0)
    s_cmp_lg_u32 s23, 0
    s_cbranch_scc1 an2_59
    s_mov_b32 s29, 0
    s_branch gse_62
gs_60:
    v_mov_b32 v13, s24
    v_lshlrev_b32 v13, 5, v13
    s_mov_b64 exec, 3
    buffer_load_dword v12, v13, s[16:19], 0 offen sc1
    s_mov_b64 exec, -1
    s_waitcnt vmcnt(0)
gse_62:
    s_mov_b64 exec, 3
    v_cmp_eq_u32 vcc, 0, v12
    s_mov_b64 exec, -1
    s_nop 1
    s_cbranch_vccz gsd_61
    s_sleep 2
    s_add_u32 s29, s29, 1
    s_cmp_lt_u32 s29, 20000
    s_cbranch_scc1 gs_60
    s_mov_b32 s29, 99
    s_branch L_fail
gsd_61:
    s_cmp_lg_u32 s23, 0
    s_cbranch_scc1 ann_63
    s_getreg_b32 s25, hwreg(HW_REG_XCC_ID, 0, 4)
    s_add_u32 s25, s25, 1
    v_mov_b32 v12, s25
    v_lshlrev_b32 v13, 26, v1
    s_lshr_b32 s26, s2, 3
    s_lshl_b32 s26, s26, 7
    s_add_u32 s26, s26, s21
    s_add_u32 s26, s26, 0x8000
    buffer_store_dword v12, v13, s[4:7], s26 offen sc1
ann_63:
an2_59:
    s_barrier
    s_add_u32 s26, s22, 8
    s_lshl_b32 s26, s26, 7
    s_add_u32 s26, s26, s54
    s_lshl_b32 s25, s23, 2
    s_add_u32 s26, s26, s25
    v_mov_b32 v5, 62
    buffer_store_dword v5, v4, s[4:7], s26 offen sc1
    s_lshl_b32 s25, s22, 2
    s_add_u32 s25, s25, s23
    s_lshl_b32 s25, s25, 3
    s_add_u32 s25, s25, s24
    s_mul_i32 s25, s25, 8704
    s_add_u32 s26, s25, 8192
    s_mov_b32 s8, s40
    s_mov_b32 s9, s41
    s_mov_b32 s10, 0x21c000
    s_mov_b32 s11, 0x20000
    buffer_load_dword v136, v131, s[8:11], s25 offen
    s_mov_b64 exec, 15
    buffer_load_dword v136, v131, s[8:11], s26 offen
    s_mov_b64 exec, -1
    s_mov_b32 s8, s42
    s_mov_b32 s9, s43
    s_mov_b32 s10, 0x21c000
    s_mov_b32 s11, 0x20000
    buffer_load_dword v136, v131, s[8:11], s25 offen
    s_mov_b64 exec, 15
    buffer_load_dword v136, v131, s[8:11], s26 offen
    s_mov_b64 exec, -1
    s_mov_b32 s8, s44
    s_mov_b32 s9, s45
    s_mov_b32 s10, 0x21c000
    s_mov_b32 s11, 0x20000
    buffer_load_dword v136, v131, s[8:11], s25 offen
    s_mov_b64 exec, 15
    buffer_load_dword v136, v131, s[8:11], s26 offen
    s_mov_b64 exec, -1
    s_mov_b32 s8, s52
    s_mov_b32 s9, s53
    s_mov_b32 s10, 0x280000
    s_mov_b32 s11, 0x20000
    s_mov_b32 s25, 0
    s_add_u32 m0, s82, 0
    s_nop 0
    buffer_load_dwordx4 v140, s[12:15], s25 offen lds
    s_add_u32 m0, s82, 1024
    s_nop 0
    buffer_load_dwordx4 v141, s[12:15], s25 offen lds
    s_add_u32 m0, s82, 2048
    s_nop 0
    buffer_load_dwordx4 v142, s[12:15], s25 offen lds
    s_add_u32 m0, s82, 3072
    s_nop 0
    buffer_load_dwordx4 v143, s[12:15], s25 offen lds
    s_add_u32 m0, s82, 4096
    s_nop 0
    buffer_load_dwordx4 v144, s[12:15], s25 offen lds
    s_mov_b32 s25, 40960
    s_add_u32 m0, s82, 5120
    s_nop 0
    buffer_load_dwordx4 v140, s[12:15], s25 offen lds
    s_add_u32 m0, s82, 6144
    s_nop 0
    buffer_load_dwordx4 v141, s[12:15], s25 offen lds
    s_add_u32 m0, s82, 7168
    s_nop 0
    buffer_load_dwordx4 v142, s[12:15], s25 offen lds
    s_add_u32 m0, s82, 8192
    s_nop 0
    buffer_load_dwordx4 v143, s[12:15], s25 offen lds
    s_add_u32 m0, s82, 9216
    s_nop 0
    buffer_load_dwordx4 v144, s[12:15], s25 offen lds
    s_waitcnt vmcnt(5)
    ds_read_b64_tr_b16 a[0:1], v146 offset:0
    ds_read_b64_tr_b16 a[2:3], v146 offset:640
    ds_read_b64_tr_b16 a[4:5], v146 offset:32
    ds_read_b64_tr_b16 a[6:7], v146 offset:672
    ds_read_b64_tr_b16 a[8:9], v146 offset:64
    ds_read_b64_tr_b16 a[10:11], v146 offset:704
    ds_read_b64_tr_b16 a[12:13], v146 offset:96
    ds_read_b64_tr_b16 a[14:15], v146 offset:736
    ds_read_b64_tr_b16 a[16:17], v146 offset:128
    ds_read_b64_tr_b16 a[18:19], v146 offset:768
    s_mov_b32 s25, 81920
    s_add_u32 m0, s82, 10240
    s_nop 0
    buffer_load_dwordx4 v140, s[12:15], s25 offen lds
    s_add_u32 m0, s82, 11264
    s_nop 0
    buffer_load_dwordx4 v141, s[12:15], s25 offen lds
    s_add_u32 m0, s82, 12288
    s_nop 0
    buffer_load_dwordx4 v142, s[12:15], s25 offen lds
    s_add_u32 m0, s82, 13312
    s_nop 0
    buffer_load_dwordx4 v143, s[12:15], s25 offen lds
    s_add_u32 m0, s82, 14336
    s_nop 0
    buffer_load_dwordx4 v144, s[12:15], s25 offen lds
    s_mov_b32 s8, s52
    s_mov_b32 s9, s53
    s_waitcnt lgkmcnt(0)
    s_waitcnt vmcnt(5)
    ds_read_b64_tr_b16 a[20:21], v146 offset:5120
    ds_read_b64_tr_b16 a[22:23], v146 offset:5760
    ds_read_b64_tr_b16 a[24:25], v146 offset:5152
    ds_read_b64_tr_b16 a[26:27], v146 offset:5792
    ds_read_b64_tr_b16 a[28:29], v146 offset:5184
    ds_read_b64_tr_b16 a[30:31], v146 offset:5824
    ds_read_b64_tr_b16 a[32:33], v146 offset:5216
    ds_read_b64_tr_b16 a[34:35], v146 offset:5856
    ds_read_b64_tr_b16 a[36:37], v146 offset:5248
    ds_read_b64_tr_b16 a[38:39], v146 offset:5888
    s_mov_b32 s25, 122880
    s_add_u32 m0, s82, 15360
    s_nop 0
    buffer_load_dwordx4 v140, s[12:15], s25 offen lds
    s_add_u32 m0, s82, 16384
    s_nop 0
    buffer_load_dwordx4 v141, s[12:15], s25 offen lds
    s_add_u32 m0, s82, 17408
    s_nop 0
    buffer_load_dwordx4 v142, s[12:15], s25 offen lds
    s_add_u32 m0, s82, 18432
    s_nop 0
    buffer_load_dwordx4 v143, s[12:15], s25 offen lds
    s_add_u32 m0, s82, 19456
    s_nop 0
    buffer_load_dwordx4 v144, s[12:15], s25 offen lds
    s_waitcnt lgkmcnt(0)
    s_waitcnt vmcnt(5)
    ds_read_b64_tr_b16 a[40:41], v146 offset:10240
    ds_read_b64_tr_b16 a[42:43], v146 offset:10880
    ds_read_b64_tr_b16 a[44:45], v146 offset:10272
    ds_read_b64_tr_b16 a[46:47], v146 offset:10912
    ds_read_b64_tr_b16 a[48:49], v146 offset:10304
    ds_read_b64_tr_b16 a[50:51], v146 offset:10944
    ds_read_b64_tr_b16 a[52:53], v146 offset:10336
    ds_read_b64_tr_b16 a[54:55], v146 offset:10976
    ds_read_b64_tr_b16 a[56:57], v146 offset:10368
    ds_read_b64_tr_b16 a[58:59], v146 offset:11008
    s_mov_b32 s25, 163840
    s_add_u32 m0, s82, 20480
    s_nop 0
    buffer_load_dwordx4 v140, s[12:15], s25 offen lds
    s_add_u32 m0, s82, 21504
    s_nop 0
    buffer_load_dwordx4 v141, s[12:15], s25 offen lds
    s_add_u32 m0, s82, 22528
    s_nop 0
    buffer_load_dwordx4 v142, s[12:15], s25 offen lds
    s_add_u32 m0, s82, 23552
    s_nop 0
    buffer_load_dwordx4 v143, s[12:15], s25 offen lds
    s_add_u32 m0, s82, 24576
    s_nop 0
    buffer_load_dwordx4 v144, s[12:15], s25 offen lds
    s_min_u32 s26, s23, 1
    s_mul_i32 s25, s24, 16384
    s_mul_i32 s26, s26, 8192
    s_add_u32 s25, s25, s26
    s_add_u32 s25, s25, 0x60000
    buffer_load_dword v136, v131, s[4:7], s25 offen sc1
    s_waitcnt lgkmcnt(0)
    s_waitcnt vmcnt(6)
    ds_read_b64_tr_b16 a[60:61], v146 offset:15360
    ds_read_b64_tr_b16 a[62:63], v146 offset:16000
    ds_read_b64_tr_b16 a[64:65], v146 offset:15392
    ds_read_b64_tr_b16 a[66:67], v146 offset:16032
    ds_read_b64_tr_b16 a[68:69], v146 offset:15424
    ds_read_b64_tr_b16 a[70:71], v146 offset:16064
    ds_read_b64_tr_b16 a[72:73], v146 offset:15456
    ds_read_b64_tr_b16 a[74:75], v146 offset:16096
    ds_read_b64_tr_b16 a[76:77], v146 offset:15488
    ds_read_b64_tr_b16 a[78:79], v146 offset:16128
    s_mov_b32 s25, 204800
    s_add_u32 m0, s82, 25600
    s_nop 0
    buffer_load_dwordx4 v140, s[12:15], s25 offen lds
    s_add_u32 m0, s82, 26624
    s_nop 0
    buffer_load_dwordx4 v141, s[12:15], s25 offen lds
    s_add_u32 m0, s82, 27648
    s_nop 0
    buffer_load_dwordx4 v142, s[12:15], s25 offen lds
    s_add_u32 m0, s82, 28672
    s_nop 0
    buffer_load_dwordx4 v143, s[12:15], s25 offen lds
    s_add_u32 m0, s82, 29696
    s_nop 0
    buffer_load_dwordx4 v144, s[12:15], s25 offen lds
    s_waitcnt lgkmcnt(0)
    s_waitcnt vmcnt(6)
    ds_read_b64_tr_b16 a[80:81], v146 offset:20480
    ds_read_b64_tr_b16 a[82:83], v146 offset:21120
    ds_read_b64_tr_b16 a[84:85], v146 offset:20512
    ds_read_b64_tr_b16 a[86:87], v146 offset:21152
    ds_read_b64_tr_b16 a[88:89], v146 offset:20544
    ds_read_b64_tr_b16 a[90:91], v146 offset:21184
    ds_read_b64_tr_b16 a[92:93], v146 offset:20576
    ds_read_b64_tr_b16 a[94:95], v146 offset:21216
    ds_read_b64_tr_b16 a[96:97], v146 offset:20608
    ds_read_b64_tr_b16 a[98:99], v146 offset:21248
    s_mov_b32 s25, 245760
    s_add_u32 m0, s82, 0
    s_nop 0
    buffer_load_dwordx4 v140, s[12:15], s25 offen lds
    s_add_u32 m0, s82, 1024
    s_nop 0
    buffer_load_dwordx4 v141, s[12:15], s25 offen lds
    s_add_u32 m0, s82, 2048
    s_nop 0
    buffer_load_dwordx4 v142, s[12:15], s25 offen lds
    s_add_u32 m0, s82, 3072
    s_nop 0
    buffer_load_dwordx4 v143, s[12:15], s25 offen lds
    s_add_u32 m0, s82, 4096
    s_nop 0
    buffer_load_dwordx4 v144, s[12:15], s25 offen lds
    s_waitcnt lgkmcnt(0)
    s_waitcnt vmcnt(5)
    ds_read_b64_tr_b16 a[100:101], v146 offset:25600
    ds_read_b64_tr_b16 a[102:103], v146 offset:26240
    ds_read_b64_tr_b16 a[104:105], v146 offset:25632
    ds_read_b64_tr_b16 a[106:107], v146 offset:26272
    ds_read_b64_tr_b16 a[108:109], v146 offset:25664
    ds_read_b64_tr_b16 a[110:111], v146 offset:26304
    ds_read_b64_tr_b16 a[112:113], v146 offset:25696
    ds_read_b64_tr_b16 a[114:115], v146 offset:26336
    ds_read_b64_tr_b16 a[116:117], v146 offset:25728
    ds_read_b64_tr_b16 a[118:119], v146 offset:26368
    s_mov_b32 s25, 286720
    s_add_u32 m0, s82, 5120
    s_nop 0
    buffer_load_dwordx4 v140, s[12:15], s25 offen lds
    s_add_u32 m0, s82, 6144
    s_nop 0
    buffer_load_dwordx4 v141, s[12:15], s25 offen lds
    s_add_u32 m0, s82, 7168
    s_nop 0
    buffer_load_dwordx4 v142, s[12:15], s25 offen lds
    s_add_u32 m0, s82, 8192
    s_nop 0
    buffer_load_dwordx4 v143, s[12:15], s25 offen lds
    s_add_u32 m0, s82, 9216
    s_nop 0
    buffer_load_dwordx4 v144, s[12:15], s25 offen lds
    s_waitcnt lgkmcnt(0)
    s_waitcnt vmcnt(5)
    ds_read_b64_tr_b16 a[120:121], v146 offset:0
    ds_read_b64_tr_b16 a[122:123], v146 offset:640
    ds_read_b64_tr_b16 a[124:125], v146 offset:32
    ds_read_b64_tr_b16 a[126:127], v146 offset:672
    ds_read_b64_tr_b16 a[128:129], v146 offset:64
    ds_read_b64_tr_b16 a[130:131], v146 offset:704
    ds_read_b64_tr_b16 a[132:133], v146 offset:96
    ds_read_b64_tr_b16 a[134:135], v146 offset:736
    ds_read_b64_tr_b16 a[136:137], v146 offset:128
    ds_read_b64_tr_b16 a[138:139], v146 offset:768
    s_mov_b32 s25, 327680
    s_add_u32 m0, s82, 10240
    s_nop 0
    buffer_load_dwordx4 v140, s[12:15], s25 offen lds
    s_add_u32 m0, s82, 11264
    s_nop 0
    buffer_load_dwordx4 v141, s[12:15], s25 offen lds
    s_add_u32 m0, s82, 12288
    s_nop 0
    buffer_load_dwordx4 v142, s[12:15], s25 offen lds
    s_add_u32 m0, s82, 13312
    s_nop 0
    buffer_load_dwordx4 v143, s[12:15], s25 offen lds
    s_add_u32 m0, s82, 14336
    s_nop 0
    buffer_load_dwordx4 v144, s[12:15], s25 offen lds
    v_lshlrev_b32 v14, 7, v1
    s_add_u32 s26, s21, 0x8000
    s_mov_b32 exec_hi, 0
    buffer_load_dword v12, v14, s[4:7], s26 offen sc1
    s_mov_b32 exec_hi, -1
    s_waitcnt lgkmcnt(0)
    s_waitcnt vmcnt(6)
    ds_read_b64_tr_b16 a[140:141], v146 offset:5120
    ds_read_b64_tr_b16 a[142:143], v146 offset:5760
    ds_read_b64_tr_b16 a[144:145], v146 offset:5152
    ds_read_b64_tr_b16 a[146:147], v146 offset:5792
    ds_read_b64_tr_b16 a[148:149], v146 offset:5184
    ds_read_b64_tr_b16 a[150:151], v146 offset:5824
    ds_read_b64_tr_b16 a[152:153], v146 offset:5216
    ds_read_b64_tr_b16 a[154:155], v146 offset:5856
    ds_read_b64_tr_b16 a[156:157], v146 offset:5248
    ds_read_b64_tr_b16 a[158:159], v146 offset:5888
    s_mov_b32 s25, 368640
    s_add_u32 m0, s82, 15360
    s_nop 0
    buffer_load_dwordx4 v140, s[12:15], s25 offen lds
    s_add_u32 m0, s82, 16384
    s_nop 0
    buffer_load_dwordx4 v141, s[12:15], s25 offen lds
    s_add_u32 m0, s82, 17408
    s_nop 0
    buffer_load_dwordx4 v142, s[12:15], s25 offen lds
    s_add_u32 m0, s82, 18432
    s_nop 0
    buffer_load_dwordx4 v143, s[12:15], s25 offen lds
    s_add_u32 m0, s82, 19456
    s_nop 0
    buffer_load_dwordx4 v144, s[12:15], s25 offen lds
    s_waitcnt lgkmcnt(0)
    s_waitcnt vmcnt(6)
    ds_read_b64_tr_b16 a[160:161], v146 offset:10240
    ds_read_b64_tr_b16 a[162:163], v146 offset:10880
    ds_read_b64_tr_b16 a[164:165], v146 offset:10272
    ds_read_b64_tr_b16 a[166:167], v146 offset:10912
    ds_read_b64_tr_b16 a[168:169], v146 offset:10304
    ds_read_b64_tr_b16 a[170:171], v146 offset:10944
    ds_read_b64_tr_b16 a[172:173], v146 offset:10336
    ds_read_b64_tr_b16 a[174:175], v146 offset:10976
    ds_read_b64_tr_b16 a[176:177], v146 offset:10368
    ds_read_b64_tr_b16 a[178:179], v146 offset:11008
    s_mov_b32 s25, 409600
    s_add_u32 m0, s82, 20480
    s_nop 0
    buffer_load_dwordx4 v140, s[12:15], s25 offen lds
    s_add_u32 m0, s82, 21504
    s_nop 0
    buffer_load_dwordx4 v141, s[12:15], s25 offen lds
    s_add_u32 m0, s82, 22528
    s_nop 0
    buffer_load_dwordx4 v142, s[12:15], s25 offen lds
    s_add_u32 m0, s82, 23552
    s_nop 0
    buffer_load_dwordx4 v143, s[12:15], s25 offen lds
    s_add_u32 m0, s82, 24576
    s_nop 0
    buffer_load_dwordx4 v144, s[12:15], s25 offen lds
    s_waitcnt lgkmcnt(0)
    s_waitcnt vmcnt(5)
    ds_read_b64_tr_b16 a[180:181], v146 offset:15360
    ds_read_b64_tr_b16 a[182:183], v146 offset:16000
    ds_read_b64_tr_b16 a[184:185], v146 offset:15392
    ds_read_b64_tr_b16 a[186:187], v146 offset:16032
    ds_read_b64_tr_b16 a[188:189], v146 offset:15424
    ds_read_b64_tr_b16 a[190:191], v146 offset:16064
    ds_read_b64_tr_b16 a[192:193], v146 offset:15456
    ds_read_b64_tr_b16 a[194:195], v146 offset:16096
    ds_read_b64_tr_b16 a[196:197], v146 offset:15488
    ds_read_b64_tr_b16 a[198:199], v146 offset:16128
    s_mov_b32 s25, 450560
    s_add_u32 m0, s82, 25600
    s_nop 0
    buffer_load_dwordx4 v140, s[12:15], s25 offen lds
    s_add_u32 m0, s82, 26624
    s_nop 0
    buffer_load_dwordx4 v141, s[12:15], s25 offen lds
    s_add_u32 m0, s82, 27648
    s_nop 0
    buffer_load_dwordx4 v142, s[12:15], s25 offen lds
    s_add_u32 m0, s82, 28672
    s_nop 0
    buffer_load_dwordx4 v143, s[12:15], s25 offen lds
    s_add_u32 m0, s82, 29696
    s_nop 0
    buffer_load_dwordx4 v144, s[12:15], s25 offen lds
    s_waitcnt lgkmcnt(0)
    s_waitcnt vmcnt(5)
    ds_read_b64_tr_b16 a[200:201], v146 offset:20480
    ds_read_b64_tr_b16 a[202:203], v146 offset:21120
    ds_read_b64_tr_b16 a[204:205], v146 offset:20512
    ds_read_b64_tr_b16 a[206:207], v146 offset:21152
    ds_read_b64_tr_b16 a[208:209], v146 offset:20544
    ds_read_b64_tr_b16 a[210:211], v146 offset:21184
    ds_read_b64_tr_b16 a[212:213], v146 offset:20576
    ds_read_b64_tr_b16 a[214:215], v146 offset:21216
    ds_read_b64_tr_b16 a[216:217], v146 offset:20608
    ds_read_b64_tr_b16 a[218:219], v146 offset:21248
    s_mov_b32 s25, 491520
    s_add_u32 m0, s82, 0
    s_nop 0
    buffer_load_dwordx4 v140, s[12:15], s25 offen lds
    s_add_u32 m0, s82, 1024
    s_nop 0
    buffer_load_dwordx4 v141, s[12:15], s25 offen lds
    s_add_u32 m0, s82, 2048
    s_nop 0
    buffer_load_dwordx4 v142, s[12:15], s25 offen lds
    s_add_u32 m0, s82, 3072
    s_nop 0
    buffer_load_dwordx4 v143, s[12:15], s25 offen lds
    s_add_u32 m0, s82, 4096
    s_nop 0
    buffer_load_dwordx4 v144, s[12:15], s25 offen lds
    v_mov_b32 v15, v12
    s_mov_b32 s29, 0
    s_branch gse_66
gs_64:
    v_lshlrev_b32 v14, 7, v1
    s_add_u32 s26, s21, 0x8000
    s_mov_b32 exec_hi, 0
    buffer_load_dword v12, v14, s[4:7], s26 offen sc1
    s_mov_b32 exec_hi, -1
    s_waitcnt vmcnt(0)
gse_66:
    s_mov_b32 exec_hi, 0
    v_cmp_eq_u32 vcc, 0, v12
    s_mov_b32 exec_hi, -1
    s_nop 1
    s_cbranch_vccz gsd_65
    s_sleep 2
    s_add_u32 s29, s29, 1
    s_cmp_lt_u32 s29, 20000
    s_cbranch_scc1 gs_64
    s_mov_b32 s29, 98
    s_branch L_fail
gsd_65:
    s_getreg_b32 s25, hwreg(HW_REG_XCC_ID, 0, 4)
    s_add_u32 s25, s25, 1
    s_mov_b32 exec_hi, 0
    v_cmp_ne_u32 vcc, s25, v12
    s_mov_b32 exec_hi, -1
    s_nop 0
    s_cmp_eq_u64 vcc, 0
    s_cselect_b32 s20, 0, 0xff
    s_lshr_b32 s26, s2, 3
    s_add_u32 s26, s26, 0
    s_lshl_b32 s26, s26, 7
    s_add_u32 s26, s26, s54
    s_lshl_b32 s25, s23, 2
    s_add_u32 s56, s26, s25
    s_cmp_eq_u32 s20, 0
    s_cselect_b32 s57, s56, 0x2000000
    s_waitcnt lgkmcnt(0)
    s_waitcnt vmcnt(5)
    ds_read_b64_tr_b16 a[220:221], v146 offset:25600
    ds_read_b64_tr_b16 a[222:223], v146 offset:26240
    ds_read_b64_tr_b16 a[224:225], v146 offset:25632
    ds_read_b64_tr_b16 a[226:227], v146 offset:26272
    ds_read_b64_tr_b16 a[228:229], v146 offset:25664
    ds_read_b64_tr_b16 a[230:231], v146 offset:26304
    ds_read_b64_tr_b16 a[232:233], v146 offset:25696
    ds_read_b64_tr_b16 a[234:235], v146 offset:26336
    ds_read_b64_tr_b16 a[236:237], v146 offset:25728
    ds_read_b64_tr_b16 a[238:239], v146 offset:26368
    s_mov_b32 s25, 532480
    s_add_u32 m0, s82, 5120
    s_nop 0
    buffer_load_dwordx4 v140, s[12:15], s25 offen lds
    s_add_u32 m0, s82, 6144
    s_nop 0
    buffer_load_dwordx4 v141, s[12:15], s25 offen lds
    s_add_u32 m0, s82, 7168
    s_nop 0
    buffer_load_dwordx4 v142, s[12:15], s25 offen lds
    s_add_u32 m0, s82, 8192
    s_nop 0
    buffer_load_dwordx4 v143, s[12:15], s25 offen lds
    s_add_u32 m0, s82, 9216
    s_nop 0
    buffer_load_dwordx4 v144, s[12:15], s25 offen lds
    s_waitcnt lgkmcnt(0)
    s_waitcnt vmcnt(5)
    ds_read_b64_tr_b16 a[240:241], v146 offset:0
    ds_read_b64_tr_b16 a[242:243], v146 offset:640
    ds_read_b64_tr_b16 a[244:245], v146 offset:32
    ds_read_b64_tr_b16 a[246:247], v146 offset:672
    ds_read_b64_tr_b16 a[248:249], v146 offset:64
    ds_read_b64_tr_b16 a[250:251], v146 offset:704
    ds_read_b64_tr_b16 a[252:253], v146 offset:96
    ds_read_b64_tr_b16 a[254:255], v146 offset:736
    ds_read_b64_tr_b16 v[232:233], v146 offset:128
    ds_read_b64_tr_b16 v[234:235], v146 offset:768
    s_waitcnt lgkmcnt(0)
    s_waitcnt vmcnt(0)
    ds_read_b64_tr_b16 v[236:237], v146 offset:5120
    ds_read_b64_tr_b16 v[238:239], v146 offset:5760
    ds_read_b64_tr_b16 v[240:241], v146 offset:5152
    ds_read_b64_tr_b16 v[242:243], v146 offset:5792
    ds_read_b64_tr_b16 v[244:245], v146 offset:5184
    ds_read_b64_tr_b16 v[246:247], v146 offset:5824
    ds_read_b64_tr_b16 v[248:249], v146 offset:5216
    ds_read_b64_tr_b16 v[250:251], v146 offset:5856
    ds_read_b64_tr_b16 v[252:253], v146 offset:5248
    ds_read_b64_tr_b16 v[254:255], v146 offset:5888
    s_waitcnt lgkmcnt(0)
    s_barrier
    s_mov_b32 s61, 0
    s_mov_b32 s55, 0
Dp4:
    s_lshl_b32 s73, s22, 2
    s_add_u32 s73, s73, s23
    s_mul_i32 s25, s24, 0x180000
    s_add_u32 s25, s25, 0x14e000
    s_add_u32 s26, s73, 0
    s_cmp_lt_u32 s26, 25
    s_cselect_b32 s26, s26, 0x1000
    s_lshl_b32 s26, s26, 13
    s_add_u32 s26, s26, s25
    buffer_load_dword v136, v131, s[4:7], s26 offen sc1
    v_mul_u32_u24 v18, 26, v1
    v_lshrrev_b32 v18, 8, v18
    v_mul_u32_u24 v18, 1280, v18
    v_lshl_add_u32 v18, v1, 7, v18
    s_mul_i32 s25, s73, 20480
    s_add_u32 s25, s25, s67
    s_sub_u32 s25, s25, 614400
    s_mov_b32 exec_hi, 0xff
    buffer_load_dword v136, v18, s[8:11], s25 offen sc1
    s_add_u32 s25, s25, 10240
    buffer_load_dword v136, v18, s[8:11], s25 offen sc1
    s_add_u32 s25, s25, 10240
    s_mov_b32 exec_hi, -1
RE_p4:
    s_cmp_lt_u32 s23, 2
    s_cbranch_scc1 p4z_67
    v_accvgpr_write_b32 a0, 0
    v_accvgpr_write_b32 a1, 0
    v_accvgpr_write_b32 a2, 0
    v_accvgpr_write_b32 a3, 0
    v_accvgpr_write_b32 a4, 0
    v_accvgpr_write_b32 a5, 0
    v_accvgpr_write_b32 a6, 0
    v_accvgpr_write_b32 a7, 0
    v_accvgpr_write_b32 a8, 0
    v_accvgpr_write_b32 a9, 0
    v_accvgpr_write_b32 a10, 0
    v_accvgpr_write_b32 a11, 0
    v_accvgpr_write_b32 a12, 0
    v_accvgpr_write_b32 a13, 0
    v_accvgpr_write_b32 a14, 0
    v_accvgpr_write_b32 a15, 0
    v_accvgpr_write_b32 a16, 0
    v_accvgpr_write_b32 a17, 0
    v_accvgpr_write_b32 a18, 0
    v_accvgpr_write_b32 a19, 0
p4z_67:
S_p4:
    v_lshlrev_b32 v2, 4, v1
    s_barrier
    s_mul_i32 s25, s24, 1572864
    s_lshl_b32 s26, s58, 10
    s_add_u32 s25, s25, s26
    s_add_u32 s59, s25, 0x180000
    s_mov_b32 s71, s59
    s_mul_i32 s25, s24, 1572864
    s_add_u32 s62, s25, 0x130000
    s_mov_b32 s72, s62
    s_add_u32 s65, s54, 2432
    s_add_u32 s25, s58, 2
    s_lshr_b32 s25, s25, 2
    v_add_u32 v22, s25, v1
    v_min_u32 v22, 13, v22
    v_lshlrev_b32 v3, 7, v22
    v_mov_b32 v23, 0x80000000
    s_mov_b32 exec_lo, 0x1f
    s_mov_b32 exec_hi, 0x0
    v_mov_b32 v23, 0x0
    s_mov_b64 exec, -1
    v_or_b32 v3, v3, v23
    s_mov_b32 s8, s52
    s_mov_b32 s9, s53
    s_mov_b32 s66, 0
    s_mov_b32 s64, 63
    s_mov_b32 s29, 0
spin_68:
    buffer_load_dwordx4 v[12:15], v3, s[4:7], s65 offen sc1
    s_waitcnt vmcnt(0)
    v_max3_u32 v16, v12, v13, v14
    v_max_u32 v16, v16, v15
    v_cmp_lt_u32 vcc, s64, v16
    s_nop 1
    s_cbranch_vccz spind_69
    s_sleep 3
    s_add_u32 s29, s29, 1
    s_cmp_lt_u32 s29, 20000
    s_cbranch_scc1 spin_68
    s_mov_b32 s29, 41
    s_branch L_fail
spind_69:
    s_bitcmp1_b32 s20, 0
    s_cbranch_scc0 acq_70
    buffer_inv sc1
    s_waitcnt vmcnt(0)
acq_70:
    s_mov_b32 m0, s79
    s_mov_b32 s60, s59
    s_add_u32 s74, s60, 4096
    s_add_u32 s75, s60, 8192
    s_add_u32 s76, s60, 12288
    buffer_load_dwordx4 v[72:75], v2, s[4:7], s60 offen offset:0 sc1
    buffer_load_dwordx4 v[76:79], v2, s[4:7], s60 offen offset:1024 sc1
    buffer_load_dwordx4 v[80:83], v2, s[4:7], s60 offen offset:2048 sc1
    buffer_load_dwordx4 v[84:87], v2, s[4:7], s60 offen offset:3072 sc1
    buffer_load_dwordx4 v[88:91], v2, s[4:7], s74 offen offset:0 sc1
    s_add_u32 s59, s59, 55296
    s_mov_b32 s64, 62
    buffer_load_dwordx4 v[12:15], v3, s[4:7], s65 offen sc1
    s_mov_b32 s69, 2
    s_mov_b32 s63, 0x2000000
    s_mov_b32 s61, 0x2000000
    s_mov_b32 s77, 0x2000000
    s_waitcnt vmcnt(0)
p4loop_71:
    s_waitcnt vmcnt(6)
    v_mfma_f32_16x16x32_bf16 v[36:39], a[0:3], v[72:75], 0
    v_mfma_f32_16x16x32_bf16 v[40:43], a[4:7], v[72:75], 0
    buffer_load_dwordx4 v[92:95], v2, s[4:7], s74 offen offset:1024 sc1
    v_mfma_f32_16x16x32_bf16 v[44:47], a[8:11], v[72:75], 0
    ds_write_b128 v6, v[152:155] offset:21504
    v_mfma_f32_16x16x32_bf16 v[48:51], a[12:15], v[72:75], 0
    s_waitcnt lgkmcnt(1)
    v_lshlrev_b32 v28, 16, v18
    v_and_b32 v29, 0xffff0000, v18
    v_mfma_f32_16x16x32_bf16 v[52:55], a[16:19], v[72:75], 0
    s_waitcnt vmcnt(6)
    ds_write_b128 v6, v[156:159] offset:21568
    v_mfma_f32_16x16x32_bf16 v[36:39], a[20:23], v[76:79], v[36:39]
    v_lshlrev_b32 v30, 16, v19
    v_and_b32 v31, 0xffff0000, v19
    v_mfma_f32_16x16x32_bf16 v[40:43], a[24:27], v[76:79], v[40:43]
    buffer_load_dwordx4 v[96:99], v2, s[4:7], s74 offen offset:2048 sc1
    v_mfma_f32_16x16x32_bf16 v[44:47], a[28:31], v[76:79], v[44:47]
    ds_write_b128 v6, v[160:163] offset:21632
    v_mfma_f32_16x16x32_bf16 v[48:51], a[32:35], v[76:79], v[48:51]
    v_lshlrev_b32 v32, 16, v20
    v_and_b32 v33, 0xffff0000, v20
    v_mfma_f32_16x16x32_bf16 v[52:55], a[36:39], v[76:79], v[52:55]
    s_waitcnt vmcnt(6)
    v_lshlrev_b32 v34, 16, v21
    v_and_b32 v35, 0xffff0000, v21
    v_mfma_f32_16x16x32_bf16 v[36:39], a[40:43], v[80:83], v[36:39]
    ds_write_b128 v6, v[164:167] offset:21696
    v_mfma_f32_16x16x32_bf16 v[40:43], a[44:47], v[80:83], v[40:43]
    s_add_u32 s26, s66, 2
    buffer_load_dwordx4 v[100:103], v2, s[4:7], s74 offen offset:3072 sc1
    v_mfma_f32_16x16x32_bf16 v[44:47], a[48:51], v[80:83], v[44:47]
    s_mul_i32 s97, s26, 171
    buffer_load_dwordx4 v9, s[4:7], s62 offen sc1 lds
    v_mfma_f32_16x16x32_bf16 v[48:51], a[52:55], v[80:83], v[48:51]
    s_lshr_b32 s97, s97, 10
    ds_write_b128 v6, v[168:171] offset:21760
    v_mfma_f32_16x16x32_bf16 v[52:55], a[56:59], v[80:83], v[52:55]
    s_mul_i32 s97, s97, 6
    s_sub_u32 s26, s26, s97
    s_waitcnt vmcnt(7)
    v_mfma_f32_16x16x32_bf16 v[36:39], a[60:63], v[84:87], v[36:39]
    s_mul_i32 s26, s26, 55296
    s_add_u32 s80, s71, s26
    s_add_u32 s25, s66, 1
    v_mfma_f32_16x16x32_bf16 v[40:43], a[64:67], v[84:87], v[40:43]
    s_and_b32 s25, s25, 15
    buffer_load_dwordx4 v[104:107], v2, s[4:7], s75 offen offset:0 sc1
    v_mfma_f32_16x16x32_bf16 v[44:47], a[68:71], v[84:87], v[44:47]
    s_waitcnt lgkmcnt(0)
    s_barrier
    ds_read_b128 v[176:179], v7 offset:21504
    v_mfma_f32_16x16x32_bf16 v[48:51], a[72:75], v[84:87], v[48:51]
    s_mul_i32 s25, s25, 20480
    ds_read_b128 v[180:183], v7 offset:21520
    ds_read_b128 v[184:187], v7 offset:26880
    v_mfma_f32_16x16x32_bf16 v[52:55], a[76:79], v[84:87], v[52:55]
    s_waitcnt vmcnt(7)
    buffer_load_dwordx4 v[12:15], v3, s[4:7], s65 offen sc1
    v_mfma_f32_16x16x32_bf16 v[36:39], a[80:83], v[88:91], v[36:39]
    s_add_u32 s62, s72, s25
    ds_read_b128 v[188:191], v7 offset:26896
    ds_read_b128 v[192:195], v7 offset:32256
    v_mfma_f32_16x16x32_bf16 v[40:43], a[84:87], v[88:91], v[40:43]
    s_and_b32 s25, s66, 15
    buffer_load_dwordx4 v[108:111], v2, s[4:7], s75 offen offset:1024 sc1
    v_mfma_f32_16x16x32_bf16 v[44:47], a[88:91], v[88:91], v[44:47]
    s_mul_i32 s27, s25, 40960
    ds_read_b128 v[196:199], v7 offset:32272
    ds_read_b128 v[200:203], v7 offset:37632
    v_mfma_f32_16x16x32_bf16 v[48:51], a[92:95], v[88:91], v[48:51]
    s_sub_u32 s81, s67, s27
    ds_read_b128 v[204:207], v7 offset:37648
    s_lshl_b32 s27, s25, 10
    v_mfma_f32_16x16x32_bf16 v[52:55], a[96:99], v[88:91], v[52:55]
    s_sub_u32 s27, s68, s27
    s_add_u32 s27, s27, 0x20000
    s_waitcnt vmcnt(6)
    v_mfma_f32_16x16x32_bf16 v[36:39], a[100:103], v[92:95], v[36:39]
    v_mfma_f32_16x16x32_bf16 v[40:43], a[104:107], v[92:95], v[40:43]
    buffer_load_dwordx4 v[112:115], v2, s[4:7], s75 offen offset:2048 sc1
    v_mfma_f32_16x16x32_bf16 v[44:47], a[108:111], v[92:95], v[44:47]
    s_waitcnt lgkmcnt(4)
    v_add_f32 v28, v28, v176
    v_add_f32 v29, v29, v177
    v_mfma_f32_16x16x32_bf16 v[48:51], a[112:115], v[92:95], v[48:51]
    v_add_f32 v30, v30, v178
    v_add_f32 v31, v31, v179
    v_mfma_f32_16x16x32_bf16 v[52:55], a[116:119], v[92:95], v[52:55]
    s_waitcnt vmcnt(6)
    v_add_f32 v32, v32, v180
    v_add_f32 v33, v33, v181
    v_mfma_f32_16x16x32_bf16 v[36:39], a[120:123], v[96:99], v[36:39]
    v_add_f32 v34, v34, v182
    v_add_f32 v35, v35, v183
    v_mfma_f32_16x16x32_bf16 v[40:43], a[124:127], v[96:99], v[40:43]
    buffer_load_dwordx4 v[116:119], v2, s[4:7], s75 offen offset:3072 sc1
    v_mfma_f32_16x16x32_bf16 v[44:47], a[128:131], v[96:99], v[44:47]
    v_add_f32 v28, v28, v184
    v_add_f32 v29, v29, v185
    v_mfma_f32_16x16x32_bf16 v[48:51], a[132:135], v[96:99], v[48:51]
    v_add_f32 v30, v30, v186
    v_add_f32 v31, v31, v187
    v_mfma_f32_16x16x32_bf16 v[52:55], a[136:139], v[96:99], v[52:55]
    s_waitcnt vmcnt(6)
    v_add_f32 v32, v32, v188
    v_add_f32 v33, v33, v189
    v_mfma_f32_16x16x32_bf16 v[36:39], a[140:143], v[100:103], v[36:39]
    v_add_f32 v34, v34, v190
    v_add_f32 v35, v35, v191
    v_mfma_f32_16x16x32_bf16 v[40:43], a[144:147], v[100:103], v[40:43]
    buffer_load_dwordx4 v[120:123], v2, s[4:7], s76 offen offset:0 sc1
    v_mfma_f32_16x16x32_bf16 v[44:47], a[148:151], v[100:103], v[44:47]
    s_waitcnt lgkmcnt(0)
    v_add_f32 v28, v28, v192
    v_add_f32 v29, v29, v193
    v_mfma_f32_16x16x32_bf16 v[48:51], a[152:155], v[100:103], v[48:51]
    v_add_f32 v30, v30, v194
    v_add_f32 v31, v31, v195
    v_mfma_f32_16x16x32_bf16 v[52:55], a[156:159], v[100:103], v[52:55]
    s_waitcnt vmcnt(5)
    v_add_f32 v32, v32, v196
    v_add_f32 v33, v33, v197
    v_mfma_f32_16x16x32_bf16 v[36:39], a[160:163], v[104:107], v[36:39]
    v_add_f32 v34, v34, v198
    v_add_f32 v35, v35, v199
    v_mfma_f32_16x16x32_bf16 v[40:43], a[164:167], v[104:107], v[40:43]
    buffer_load_dwordx4 v[124:127], v2, s[4:7], s76 offen offset:1024 sc1
    v_mfma_f32_16x16x32_bf16 v[44:47], a[168:171], v[104:107], v[44:47]
    s_add_u32 s70, s66, 2
    v_add_f32 v28, v28, v200
    v_add_f32 v29, v29, v201
    v_mfma_f32_16x16x32_bf16 v[48:51], a[172:175], v[104:107], v[48:51]
    s_mov_b32 s60, s59
    v_add_f32 v30, v30, v202
    v_add_f32 v31, v31, v203
    v_mfma_f32_16x16x32_bf16 v[52:55], a[176:179], v[104:107], v[52:55]
    s_waitcnt vmcnt(4)
    v_add_f32 v32, v32, v204
    v_add_f32 v33, v33, v205
    v_mfma_f32_16x16x32_bf16 v[36:39], a[180:183], v[108:111], v[36:39]
    s_add_u32 s74, s60, 4096
    v_add_f32 v34, v34, v206
    v_add_f32 v35, v35, v207
    v_mfma_f32_16x16x32_bf16 v[40:43], a[184:187], v[108:111], v[40:43]
    s_add_u32 s75, s60, 8192
    v_cvt_pk_bf16_f32 v22, v28, v29
    v_cvt_pk_bf16_f32 v23, v30, v31
    v_mfma_f32_16x16x32_bf16 v[44:47], a[188:191], v[108:111], v[44:47]
    s_add_u32 s76, s60, 12288
    v_max3_u32 v16, v12, v13, v14
    v_max3_u32 v16, v16, v15, s20
    v_mfma_f32_16x16x32_bf16 v[48:51], a[192:195], v[108:111], v[48:51]
    v_cmp_lt_u32 vcc, s64, v16
    v_cvt_pk_bf16_f32 v24, v32, v33
    v_mfma_f32_16x16x32_bf16 v[52:55], a[196:199], v[108:111], v[52:55]
    s_waitcnt vmcnt(3)
    v_cvt_pk_bf16_f32 v25, v34, v35
    v_mfma_f32_16x16x32_bf16 v[36:39], a[200:203], v[112:115], v[36:39]
    buffer_store_dwordx4 v[22:25], v8, s[8:11], s61 offen
    v_mfma_f32_16x16x32_bf16 v[40:43], a[204:207], v[112:115], v[40:43]
    s_cbranch_vccnz slow_72
ret_73:
    buffer_load_dwordx4 v[72:75], v2, s[4:7], s60 offen offset:0 sc1
    v_mfma_f32_16x16x32_bf16 v[44:47], a[208:211], v[112:115], v[44:47]
    s_cmp_ge_u32 s66, 16
    buffer_load_dwordx4 v[76:79], v2, s[4:7], s60 offen offset:1024 sc1
    v_mfma_f32_16x16x32_bf16 v[48:51], a[212:215], v[112:115], v[48:51]
    s_cselect_b32 s27, 0x2000000, s27
    v_add_f32 v26, v28, v29
    v_mul_f32 v27, v28, v28
    v_mfma_f32_16x16x32_bf16 v[52:55], a[216:219], v[112:115], v[52:55]
    s_waitcnt vmcnt(5)
    v_fmac_f32 v27, v29, v29
    v_add_f32 v26, v26, v30
    v_mfma_f32_16x16x32_bf16 v[36:39], a[220:223], v[116:119], v[36:39]
    ds_read_b128 v[18:21], v56
    v_fmac_f32 v27, v30, v30
    v_mfma_f32_16x16x32_bf16 v[40:43], a[224:227], v[116:119], v[40:43]
    s_mov_b32 s61, s81
    buffer_load_dwordx4 v[80:83], v2, s[4:7], s60 offen offset:2048 sc1
    v_mfma_f32_16x16x32_bf16 v[44:47], a[228:231], v[116:119], v[44:47]
    s_mov_b32 s59, s80
    v_add_f32 v26, v26, v31
    v_fmac_f32 v27, v31, v31
    v_mfma_f32_16x16x32_bf16 v[48:51], a[232:235], v[116:119], v[48:51]
    s_cmp_lt_u32 s66, 30
    v_add_f32 v26, v26, v32
    v_fmac_f32 v27, v32, v32
    v_mfma_f32_16x16x32_bf16 v[52:55], a[236:239], v[116:119], v[52:55]
    s_waitcnt vmcnt(5)
    v_add_f32 v26, v26, v33
    v_fmac_f32 v27, v33, v33
    v_mfma_f32_16x16x32_bf16 v[36:39], a[240:243], v[120:123], v[36:39]
    s_subb_u32 s64, s64, 0
    v_add_f32 v26, v26, v34
    v_fmac_f32 v27, v34, v34
    v_mfma_f32_16x16x32_bf16 v[40:43], a[244:247], v[120:123], v[40:43]
    s_add_u32 s66, s66, 1
    buffer_load_dwordx4 v[84:87], v2, s[4:7], s60 offen offset:3072 sc1
    v_mfma_f32_16x16x32_bf16 v[44:47], a[248:251], v[120:123], v[44:47]
    v_add_f32 v26, v26, v35
    v_fmac_f32 v27, v35, v35
    v_mfma_f32_16x16x32_bf16 v[48:51], a[252:255], v[120:123], v[48:51]
    v_and_b32 v26, v11, v26
    v_and_b32 v27, v11, v27
    v_mfma_f32_16x16x32_bf16 v[52:55], v[232:235], v[120:123], v[52:55]
    s_waitcnt vmcnt(5)
    v_add_f32_dpp v26, v26, v26 row_shr:1 row_mask:0xf bank_mask:0xf
    v_add_f32_dpp v27, v27, v27 row_shr:1 row_mask:0xf bank_mask:0xf
    v_mfma_f32_16x16x32_bf16 v[36:39], v[236:239], v[124:127], v[36:39]
    v_add_f32_dpp v26, v26, v26 row_shr:2 row_mask:0xf bank_mask:0xf
    v_add_f32_dpp v27, v27, v27 row_shr:2 row_mask:0xf bank_mask:0xf
    v_mfma_f32_16x16x32_bf16 v[40:43], v[240:243], v[124:127], v[40:43]
    buffer_load_dwordx4 v[88:91], v2, s[4:7], s74 offen offset:0 sc1
    v_mfma_f32_16x16x32_bf16 v[44:47], v[244:247], v[124:127], v[44:47]
    s_waitcnt vmcnt(5)
    v_sub_u32_e64 v5, 64, s70
    v_add_f32_dpp v26, v26, v26 row_shr:4 row_mask:0xf bank_mask:0xf
    v_mfma_f32_16x16x32_bf16 v[48:51], v[248:251], v[124:127], v[48:51]
    buffer_store_dword v5, v4, s[4:7], s57 offen
    v_mfma_f32_16x16x32_bf16 v[52:55], v[252:255], v[124:127], v[52:55]
    s_waitcnt vmcnt(5)
    v_add_f32_dpp v27, v27, v27 row_shr:4 row_mask:0xf bank_mask:0xf
    v_add_f32_dpp v26, v26, v26 row_shr:8 row_mask:0xf bank_mask:0xf
    s_nop 0
    v_add_f32_dpp v27, v27, v27 row_shr:8 row_mask:0xf bank_mask:0xf
    buffer_store_dwordx2 v[26:27], v10, s[4:7], s63 offen
    s_mov_b32 s63, s27
    v_mfma_f32_16x16x32_bf16 v[152:155], a[0:3], v[72:75], 0
    v_mfma_f32_16x16x32_bf16 v[156:159], a[4:7], v[72:75], 0
    buffer_load_dwordx4 v[92:95], v2, s[4:7], s74 offen offset:1024 sc1
    v_mfma_f32_16x16x32_bf16 v[160:163], a[8:11], v[72:75], 0
    ds_write_b128 v6, v[36:39] offset:0
    v_mfma_f32_16x16x32_bf16 v[164:167], a[12:15], v[72:75], 0
    s_waitcnt lgkmcnt(1)
    v_lshlrev_b32 v28, 16, v18
    v_and_b32 v29, 0xffff0000, v18
    v_mfma_f32_16x16x32_bf16 v[168:171], a[16:19], v[72:75], 0
    s_waitcnt vmcnt(6)
    ds_write_b128 v6, v[40:43] offset:64
    v_mfma_f32_16x16x32_bf16 v[152:155], a[20:23], v[76:79], v[152:155]
    v_lshlrev_b32 v30, 16, v19
    v_and_b32 v31, 0xffff0000, v19
    v_mfma_f32_16x16x32_bf16 v[156:159], a[24:27], v[76:79], v[156:159]
    buffer_load_dwordx4 v[96:99], v2, s[4:7], s74 offen offset:2048 sc1
    v_mfma_f32_16x16x32_bf16 v[160:163], a[28:31], v[76:79], v[160:163]
    ds_write_b128 v6, v[44:47] offset:128
    v_mfma_f32_16x16x32_bf16 v[164:167], a[32:35], v[76:79], v[164:167]
    v_lshlrev_b32 v32, 16, v20
    v_and_b32 v33, 0xffff0000, v20
    v_mfma_f32_16x16x32_bf16 v[168:171], a[36:39], v[76:79], v[168:171]
    s_waitcnt vmcnt(6)
    v_lshlrev_b32 v34, 16, v21
    v_and_b32 v35, 0xffff0000, v21
    v_mfma_f32_16x16x32_bf16 v[152:155], a[40:43], v[80:83], v[152:155]
    ds_write_b128 v6, v[48:51] offset:192
    v_mfma_f32_16x16x32_bf16 v[156:159], a[44:47], v[80:83], v[156:159]
    s_add_u32 s26, s66, 2
    buffer_load_dwordx4 v[100:103], v2, s[4:7], s74 offen offset:3072 sc1
    v_mfma_f32_16x16x32_bf16 v[160:163], a[48:51], v[80:83], v[160:163]
    s_mul_i32 s97, s26, 171
    buffer_load_dwordx4 v9, s[4:7], s62 offen sc1 lds
    v_mfma_f32_16x16x32_bf16 v[164:167], a[52:55], v[80:83], v[164:167]
    s_lshr_b32 s97, s97, 10
    ds_write_b128 v6, v[52:55] offset:256
    v_mfma_f32_16x16x32_bf16 v[168:171], a[56:59], v[80:83], v[168:171]
    s_mul_i32 s97, s97, 6
    s_sub_u32 s26, s26, s97
    s_waitcnt vmcnt(7)
    v_mfma_f32_16x16x32_bf16 v[152:155], a[60:63], v[84:87], v[152:155]
    s_mul_i32 s26, s26, 55296
    s_add_u32 s80, s71, s26
    s_add_u32 s25, s66, 1
    v_mfma_f32_16x16x32_bf16 v[156:159], a[64:67], v[84:87], v[156:159]
    s_and_b32 s25, s25, 15
    buffer_load_dwordx4 v[104:107], v2, s[4:7], s75 offen offset:0 sc1
    v_mfma_f32_16x16x32_bf16 v[160:163], a[68:71], v[84:87], v[160:163]
    s_waitcnt lgkmcnt(0)
    s_barrier
    ds_read_b128 v[176:179], v7 offset:0
    v_mfma_f32_16x16x32_bf16 v[164:167], a[72:75], v[84:87], v[164:167]
    s_mul_i32 s25, s25, 20480
    ds_read_b128 v[180:183], v7 offset:16
    ds_read_b128 v[184:187], v7 offset:5376
    v_mfma_f32_16x16x32_bf16 v[168:171], a[76:79], v[84:87], v[168:171]
    s_waitcnt vmcnt(7)
    buffer_load_dwordx4 v[12:15], v3, s[4:7], s65 offen sc1
    v_mfma_f32_16x16x32_bf16 v[152:155], a[80:83], v[88:91], v[152:155]
    s_add_u32 s62, s72, s25
    ds_read_b128 v[188:191], v7 offset:5392
    ds_read_b128 v[192:195], v7 offset:10752
    v_mfma_f32_16x16x32_bf16 v[156:159], a[84:87], v[88:91], v[156:159]
    s_and_b32 s25, s66, 15
    buffer_load_dwordx4 v[108:111], v2, s[4:7], s75 offen offset:1024 sc1
    v_mfma_f32_16x16x32_bf16 v[160:163], a[88:91], v[88:91], v[160:163]
    s_mul_i32 s27, s25, 40960
    ds_read_b128 v[196:199], v7 offset:10768
    ds_read_b128 v[200:203], v7 offset:16128
    v_mfma_f32_16x16x32_bf16 v[164:167], a[92:95], v[88:91], v[164:167]
    s_sub_u32 s81, s67, s27
    ds_read_b128 v[204:207], v7 offset:16144
    s_lshl_b32 s27, s25, 10
    v_mfma_f32_16x16x32_bf16 v[168:171], a[96:99], v[88:91], v[168:171]
    s_sub_u32 s27, s68, s27
    s_add_u32 s27, s27, 0x20000
    s_waitcnt vmcnt(6)
    v_mfma_f32_16x16x32_bf16 v[152:155], a[100:103], v[92:95], v[152:155]
    v_mfma_f32_16x16x32_bf16 v[156:159], a[104:107], v[92:95], v[156:159]
    buffer_load_dwordx4 v[112:115], v2, s[4:7], s75 offen offset:2048 sc1
    v_mfma_f32_16x16x32_bf16 v[160:163], a[108:111], v[92:95], v[160:163]
    s_waitcnt lgkmcnt(4)
    v_add_f32 v28, v28, v176
    v_add_f32 v29, v29, v177
    v_mfma_f32_16x16x32_bf16 v[164:167], a[112:115], v[92:95], v[164:167]
    v_add_f32 v30, v30, v178
    v_add_f32 v31, v31, v179
    v_mfma_f32_16x16x32_bf16 v[168:171], a[116:119], v[92:95], v[168:171]
    s_waitcnt vmcnt(6)
    v_add_f32 v32, v32, v180
    v_add_f32 v33, v33, v181
    v_mfma_f32_16x16x32_bf16 v[152:155], a[120:123], v[96:99], v[152:155]
    v_add_f32 v34, v34, v182
    v_add_f32 v35, v35, v183
    v_mfma_f32_16x16x32_bf16 v[156:159], a[124:127], v[96:99], v[156:159]
    buffer_load_dwordx4 v[116:119], v2, s[4:7], s75 offen offset:3072 sc1
    v_mfma_f32_16x16x32_bf16 v[160:163], a[128:131], v[96:99], v[160:163]
    v_add_f32 v28, v28, v184
    v_add_f32 v29, v29, v185
    v_mfma_f32_16x16x32_bf16 v[164:167], a[132:135], v[96:99], v[164:167]
    v_add_f32 v30, v30, v186
    v_add_f32 v31, v31, v187
    v_mfma_f32_16x16x32_bf16 v[168:171], a[136:139], v[96:99], v[168:171]
    s_waitcnt vmcnt(6)
    v_add_f32 v32, v32, v188
    v_add_f32 v33, v33, v189
    v_mfma_f32_16x16x32_bf16 v[152:155], a[140:143], v[100:103], v[152:155]
    v_add_f32 v34, v34, v190
    v_add_f32 v35, v35, v191
    v_mfma_f32_16x16x32_bf16 v[156:159], a[144:147], v[100:103], v[156:159]
    buffer_load_dwordx4 v[120:123], v2, s[4:7], s76 offen offset:0 sc1
    v_mfma_f32_16x16x32_bf16 v[160:163], a[148:151], v[100:103], v[160:163]
    s_waitcnt lgkmcnt(0)
    v_add_f32 v28, v28, v192
    v_add_f32 v29, v29, v193
    v_mfma_f32_16x16x32_bf16 v[164:167], a[152:155], v[100:103], v[164:167]
    v_add_f32 v30, v30, v194
    v_add_f32 v31, v31, v195
    v_mfma_f32_16x16x32_bf16 v[168:171], a[156:159], v[100:103], v[168:171]
    s_waitcnt vmcnt(5)
    v_add_f32 v32, v32, v196
    v_add_f32 v33, v33, v197
    v_mfma_f32_16x16x32_bf16 v[152:155], a[160:163], v[104:107], v[152:155]
    v_add_f32 v34, v34, v198
    v_add_f32 v35, v35, v199
    v_mfma_f32_16x16x32_bf16 v[156:159], a[164:167], v[104:107], v[156:159]
    buffer_load_dwordx4 v[124:127], v2, s[4:7], s76 offen offset:1024 sc1
    v_mfma_f32_16x16x32_bf16 v[160:163], a[168:171], v[104:107], v[160:163]
    s_add_u32 s70, s66, 2
    v_add_f32 v28, v28, v200
    v_add_f32 v29, v29, v201
    v_mfma_f32_16x16x32_bf16 v[164:167], a[172:175], v[104:107], v[164:167]
    s_mov_b32 s60, s59
    v_add_f32 v30, v30, v202
    v_add_f32 v31, v31, v203
    v_mfma_f32_16x16x32_bf16 v[168:171], a[176:179], v[104:107], v[168:171]
    s_waitcnt vmcnt(4)
    v_add_f32 v32, v32, v204
    v_add_f32 v33, v33, v205
    v_mfma_f32_16x16x32_bf16 v[152:155], a[180:183], v[108:111], v[152:155]
    s_add_u32 s74, s60, 4096
    v_add_f32 v34, v34, v206
    v_add_f32 v35, v35, v207
    v_mfma_f32_16x16x32_bf16 v[156:159], a[184:187], v[108:111], v[156:159]
    s_add_u32 s75, s60, 8192
    v_cvt_pk_bf16_f32 v22, v28, v29
    v_cvt_pk_bf16_f32 v23, v30, v31
    v_mfma_f32_16x16x32_bf16 v[160:163], a[188:191], v[108:111], v[160:163]
    s_add_u32 s76, s60, 12288
    v_max3_u32 v16, v12, v13, v14
    v_max3_u32 v16, v16, v15, s20
    v_mfma_f32_16x16x32_bf16 v[164:167], a[192:195], v[108:111], v[164:167]
    v_cmp_lt_u32 vcc, s64, v16
    v_cvt_pk_bf16_f32 v24, v32, v33
    v_mfma_f32_16x16x32_bf16 v[168:171], a[196:199], v[108:111], v[168:171]
    s_waitcnt vmcnt(3)
    v_cvt_pk_bf16_f32 v25, v34, v35
    v_mfma_f32_16x16x32_bf16 v[152:155], a[200:203], v[112:115], v[152:155]
    buffer_store_dwordx4 v[22:25], v8, s[8:11], s61 offen
    v_mfma_f32_16x16x32_bf16 v[156:159], a[204:207], v[112:115], v[156:159]
    s_cbranch_vccnz slow_81
ret_82:
    buffer_load_dwordx4 v[72:75], v2, s[4:7], s60 offen offset:0 sc1
    v_mfma_f32_16x16x32_bf16 v[160:163], a[208:211], v[112:115], v[160:163]
    s_cmp_ge_u32 s66, 16
    buffer_load_dwordx4 v[76:79], v2, s[4:7], s60 offen offset:1024 sc1
    v_mfma_f32_16x16x32_bf16 v[164:167], a[212:215], v[112:115], v[164:167]
    s_cselect_b32 s27, 0x2000000, s27
    v_add_f32 v26, v28, v29
    v_mul_f32 v27, v28, v28
    v_mfma_f32_16x16x32_bf16 v[168:171], a[216:219], v[112:115], v[168:171]
    s_waitcnt vmcnt(5)
    v_fmac_f32 v27, v29, v29
    v_add_f32 v26, v26, v30
    v_mfma_f32_16x16x32_bf16 v[152:155], a[220:223], v[116:119], v[152:155]
    ds_read_b128 v[18:21], v56
    v_fmac_f32 v27, v30, v30
    v_mfma_f32_16x16x32_bf16 v[156:159], a[224:227], v[116:119], v[156:159]
    s_mov_b32 s61, s81
    buffer_load_dwordx4 v[80:83], v2, s[4:7], s60 offen offset:2048 sc1
    v_mfma_f32_16x16x32_bf16 v[160:163], a[228:231], v[116:119], v[160:163]
    s_mov_b32 s59, s80
    v_add_f32 v26, v26, v31
    v_fmac_f32 v27, v31, v31
    v_mfma_f32_16x16x32_bf16 v[164:167], a[232:235], v[116:119], v[164:167]
    s_cmp_lt_u32 s66, 30
    v_add_f32 v26, v26, v32
    v_fmac_f32 v27, v32, v32
    v_mfma_f32_16x16x32_bf16 v[168:171], a[236:239], v[116:119], v[168:171]
    s_waitcnt vmcnt(5)
    v_add_f32 v26, v26, v33
    v_fmac_f32 v27, v33, v33
    v_mfma_f32_16x16x32_bf16 v[152:155], a[240:243], v[120:123], v[152:155]
    s_subb_u32 s64, s64, 0
    v_add_f32 v26, v26, v34
    v_fmac_f32 v27, v34, v34
    v_mfma_f32_16x16x32_bf16 v[156:159], a[244:247], v[120:123], v[156:159]
    s_add_u32 s66, s66, 1
    buffer_load_dwordx4 v[84:87], v2, s[4:7], s60 offen offset:3072 sc1
    v_mfma_f32_16x16x32_bf16 v[160:163], a[248:251], v[120:123], v[160:163]
    s_cmp_lt_u32 s66, 32
    v_add_f32 v26, v26, v35
    v_fmac_f32 v27, v35, v35
    v_mfma_f32_16x16x32_bf16 v[164:167], a[252:255], v[120:123], v[164:167]
    v_and_b32 v26, v11, v26
    v_and_b32 v27, v11, v27
    v_mfma_f32_16x16x32_bf16 v[168:171], v[232:235], v[120:123], v[168:171]
    s_waitcnt vmcnt(5)
    v_add_f32_dpp v26, v26, v26 row_shr:1 row_mask:0xf bank_mask:0xf
    v_add_f32_dpp v27, v27, v27 row_shr:1 row_mask:0xf bank_mask:0xf
    v_mfma_f32_16x16x32_bf16 v[152:155], v[236:239], v[124:127], v[152:155]
    v_add_f32_dpp v26, v26, v26 row_shr:2 row_mask:0xf bank_mask:0xf
    v_add_f32_dpp v27, v27, v27 row_shr:2 row_mask:0xf bank_mask:0xf
    v_mfma_f32_16x16x32_bf16 v[156:159], v[240:243], v[124:127], v[156:159]
    buffer_load_dwordx4 v[88:91], v2, s[4:7], s74 offen offset:0 sc1
    v_mfma_f32_16x16x32_bf16 v[160:163], v[244:247], v[124:127], v[160:163]
    s_waitcnt vmcnt(5)
    v_sub_u32_e64 v5, 64, s70
    v_add_f32_dpp v26, v26, v26 row_shr:4 row_mask:0xf bank_mask:0xf
    v_mfma_f32_16x16x32_bf16 v[164:167], v[248:251], v[124:127], v[164:167]
    buffer_store_dword v5, v4, s[4:7], s57 offen
    v_mfma_f32_16x16x32_bf16 v[168:171], v[252:255], v[124:127], v[168:171]
    v_add_f32_dpp v27, v27, v27 row_shr:4 row_mask:0xf bank_mask:0xf
    v_add_f32_dpp v26, v26, v26 row_shr:8 row_mask:0xf bank_mask:0xf
    s_nop 0
    v_add_f32_dpp v27, v27, v27 row_shr:8 row_mask:0xf bank_mask:0xf
    buffer_store_dwordx2 v[26:27], v10, s[4:7], s63 offen
    s_mov_b32 s63, s27
    s_cbranch_scc1 p4loop_71
F_p4:
    s_nop 7
    ds_write_b128 v6, v[152:155] offset:21504
    ds_write_b128 v6, v[156:159] offset:21568
    ds_write_b128 v6, v[160:163] offset:21632
    ds_write_b128 v6, v[164:167] offset:21696
    ds_write_b128 v6, v[168:171] offset:21760
    s_waitcnt lgkmcnt(5)
    v_lshlrev_b32 v28, 16, v18
    v_and_b32 v29, 0xffff0000, v18
    v_lshlrev_b32 v30, 16, v19
    v_and_b32 v31, 0xffff0000, v19
    v_lshlrev_b32 v32, 16, v20
    v_and_b32 v33, 0xffff0000, v20
    v_lshlrev_b32 v34, 16, v21
    v_and_b32 v35, 0xffff0000, v21
    s_waitcnt lgkmcnt(0)
    s_barrier
    ds_read_b128 v[176:179], v7 offset:21504
    ds_read_b128 v[180:183], v7 offset:21520
    ds_read_b128 v[184:187], v7 offset:26880
    ds_read_b128 v[188:191], v7 offset:26896
    ds_read_b128 v[192:195], v7 offset:32256
    ds_read_b128 v[196:199], v7 offset:32272
    ds_read_b128 v[200:203], v7 offset:37632
    ds_read_b128 v[204:207], v7 offset:37648
    s_waitcnt lgkmcnt(7)
    v_add_f32 v28, v28, v176
    v_add_f32 v29, v29, v177
    v_add_f32 v30, v30, v178
    v_add_f32 v31, v31, v179
    s_waitcnt lgkmcnt(6)
    v_add_f32 v32, v32, v180
    v_add_f32 v33, v33, v181
    v_add_f32 v34, v34, v182
    v_add_f32 v35, v35, v183
    s_waitcnt lgkmcnt(5)
    v_add_f32 v28, v28, v184
    v_add_f32 v29, v29, v185
    v_add_f32 v30, v30, v186
    v_add_f32 v31, v31, v187
    s_waitcnt lgkmcnt(4)
    v_add_f32 v32, v32, v188
    v_add_f32 v33, v33, v189
    v_add_f32 v34, v34, v190
    v_add_f32 v35, v35, v191
    s_waitcnt lgkmcnt(3)
    v_add_f32 v28, v28, v192
    v_add_f32 v29, v29, v193
    v_add_f32 v30, v30, v194
    v_add_f32 v31, v31, v195
    s_waitcnt lgkmcnt(2)
    v_add_f32 v32, v32, v196
    v_add_f32 v33, v33, v197
    v_add_f32 v34, v34, v198
    v_add_f32 v35, v35, v199
    s_waitcnt lgkmcnt(1)
    v_add_f32 v28, v28, v200
    v_add_f32 v29, v29, v201
    v_add_f32 v30, v30, v202
    v_add_f32 v31, v31, v203
    s_waitcnt lgkmcnt(0)
    v_add_f32 v32, v32, v204
    v_add_f32 v33, v33, v205
    v_add_f32 v34, v34, v206
    v_add_f32 v35, v35, v207
    v_cvt_pk_bf16_f32 v22, v28, v29
    v_cvt_pk_bf16_f32 v23, v30, v31
    v_cvt_pk_bf16_f32 v24, v32, v33
    v_cvt_pk_bf16_f32 v25, v34, v35
    buffer_store_dwordx4 v[22:25], v8, s[8:11], s61 offen
    s_cmp_lg_u32 s55, 0
    s_cbranch_scc1 Dp4
    s_endpgm
pub_74:
    s_nop 1
    s_waitcnt vmcnt(0)
    buffer_wbl2 sc1
    s_waitcnt vmcnt(0)
    buffer_store_dword v5, v4, s[4:7], s56 offen sc1
    s_branch pubr_75
slow_72:
    s_cselect_b32 s28, 1, 0
    s_waitcnt vmcnt(0)
    v_sub_u32_e64 v5, 64, s70
    s_bitcmp1_b32 s20, 0
    s_cbranch_scc1 pub_74
pubr_75:
    buffer_store_dword v5, v4, s[4:7], s57 offen
    s_mov_b32 s29, 0
spin_76:
    buffer_load_dwordx4 v[12:15], v3, s[4:7], s65 offen sc1
    s_waitcnt vmcnt(0)
    v_max3_u32 v16, v12, v13, v14
    v_max_u32 v16, v16, v15
    v_cmp_lt_u32 vcc, s64, v16
    s_nop 1
    s_cbranch_vccz spind_77
    s_sleep 3
    s_add_u32 s29, s29, 1
    s_cmp_lt_u32 s29, 20000
    s_cbranch_scc1 spin_76
    s_mov_b32 s29, 42
    s_branch L_fail
spind_77:
    s_bitcmp1_b32 s20, 0
    s_cbranch_scc0 acq_78
    buffer_inv sc1
    s_waitcnt vmcnt(0)
acq_78:
    s_cmp_lg_u32 s28, 0
    s_branch ret_73
pub_83:
    s_nop 1
    s_waitcnt vmcnt(0)
    buffer_wbl2 sc1
    s_waitcnt vmcnt(0)
    buffer_store_dword v5, v4, s[4:7], s56 offen sc1
    s_branch pubr_84
slow_81:
    s_cselect_b32 s28, 1, 0
    s_waitcnt vmcnt(0)
    v_sub_u32_e64 v5, 64, s70
    s_bitcmp1_b32 s20, 0
    s_cbranch_scc1 pub_83
pubr_84:
    buffer_store_dword v5, v4, s[4:7], s57 offen
    s_mov_b32 s29, 0
spin_85:
    buffer_load_dwordx4 v[12:15], v3, s[4:7], s65 offen sc1
    s_waitcnt vmcnt(0)
    v_max3_u32 v16, v12, v13, v14
    v_max_u32 v16, v16, v15
    v_cmp_lt_u32 vcc, s64, v16
    s_nop 1
    s_cbranch_vccz spind_86
    s_sleep 3
    s_add_u32 s29, s29, 1
    s_cmp_lt_u32 s29, 20000
    s_cbranch_scc1 spin_85
    s_mov_b32 s29, 42
    s_branch L_fail
spind_86:
    s_bitcmp1_b32 s20, 0
    s_cbranch_scc0 acq_87
    buffer_inv sc1
    s_waitcnt vmcnt(0)
acq_87:
    s_cmp_lg_u32 s28, 0
    s_branch ret_82
E_p4:
    s_endpgm
L_p2:
    s_mov_b32 s74, s25
    s_and_b32 s62, s23, 1
    s_mov_b32 s12, s36
    s_mov_b32 s13, s37
    s_mov_b32 s14, 0xc8000
    s_mov_b32 s15, 0x20000
    s_mov_b32 s8, s32
    s_mov_b32 s9, s33
    s_mov_b32 s10, 0x280000
    s_mov_b32 s11, 0x20000
    v_lshrrev_b32 v44, 3, v1
    v_bfe_u32 v45, v1, 4, 1
    v_lshlrev_b32 v45, 2, v45
    v_xor_b32 v45, v1, v45
    v_and_b32 v45, 7, v45
    v_lshlrev_b32 v45, 4, v45
    v_mul_u32_u24 v46, 1280, v44
    v_add_u32 v46, v46, v45
    s_lshr_b32 s28, s74, 1
    s_lshl_b32 s26, s28, 8
    s_mul_i32 s25, s62, 25600
    s_add_u32 s25, s25, s26
    v_add_u32 v48, s25, v46
    v_lshrrev_b32 v47, 5, v1
    v_mul_u32_u24 v47, 20480, v47
    v_add_u32 v46, v46, v47
    s_mul_i32 s25, s62, 102400
    s_add_u32 s25, s25, s26
    s_add_u32 s25, s25, 20480
    v_add_u32 v49, s25, v46
    s_lshr_b32 s28, s23, 1
    s_lshl_b32 s28, s28, 13
    s_add_u32 s28, s28, 65536
    s_lshl_b32 s27, s62, 11
    s_add_u32 s27, s27, s28
    s_mov_b32 s25, 0
    s_add_u32 m0, s27, 0
    s_nop 0
    buffer_load_dwordx4 v48, s[12:15], s25 offen offset:0 lds
    s_add_u32 m0, s27, 3968
    s_nop 0
    buffer_load_dwordx4 v48, s[12:15], s25 offen offset:128 lds
    s_mov_b32 s25, 10240
    s_add_u32 m0, s27, 1024
    s_nop 0
    buffer_load_dwordx4 v48, s[12:15], s25 offen offset:0 lds
    s_add_u32 m0, s27, 4992
    s_nop 0
    buffer_load_dwordx4 v48, s[12:15], s25 offen offset:128 lds
    s_mov_b32 s25, 51200
    s_add_u32 m0, s27, 16384
    s_nop 0
    buffer_load_dwordx4 v48, s[12:15], s25 offen offset:0 lds
    s_add_u32 m0, s27, 20352
    s_nop 0
    buffer_load_dwordx4 v48, s[12:15], s25 offen offset:128 lds
    s_mov_b32 s25, 61440
    s_add_u32 m0, s27, 17408
    s_nop 0
    buffer_load_dwordx4 v48, s[12:15], s25 offen offset:0 lds
    s_add_u32 m0, s27, 21376
    s_nop 0
    buffer_load_dwordx4 v48, s[12:15], s25 offen offset:128 lds
    s_mov_b32 s25, 102400
    s_add_u32 m0, s27, 32768
    s_nop 0
    buffer_load_dwordx4 v48, s[12:15], s25 offen offset:0 lds
    s_add_u32 m0, s27, 36736
    s_nop 0
    buffer_load_dwordx4 v48, s[12:15], s25 offen offset:128 lds
    s_mov_b32 s25, 112640
    s_add_u32 m0, s27, 33792
    s_nop 0
    buffer_load_dwordx4 v48, s[12:15], s25 offen offset:0 lds
    s_add_u32 m0, s27, 37760
    s_nop 0
    buffer_load_dwordx4 v48, s[12:15], s25 offen offset:128 lds
    v_lshrrev_b32 v44, 4, v1
    v_bfe_u32 v45, v1, 2, 2
    v_and_b32 v46, 3, v1
    v_bfe_u32 v47, v1, 3, 1
    v_lshlrev_b32 v44, 10, v44
    v_lshl_add_u32 v44, v45, 7, v44
    v_lshl_add_u32 v44, v46, 4, v44
    v_lshl_add_u32 v44, v47, 6, v44
    s_lshl_b32 s25, s62, 12
    s_add_u32 s25, s25, s28
    v_add_u32 v50, s25, v44
    v_xor_b32 v51, 64, v50
    v_mov_b32 v52, 0x3f803f80
    v_mov_b32 v53, 0x3f803f80
    v_mov_b32 v54, 0x3f803f80
    v_mov_b32 v55, 0x3f803f80
    v_lshlrev_b32 v2, 4, v1
    v_add_u32 v3, 4096, v2
    v_mov_b32 v21, 0x80000000
    s_mov_b32 exec_lo, 0x1
    s_mov_b32 exec_hi, 0x0
    v_mov_b32 v21, 0x0
    s_mov_b64 exec, -1
    v_add_u32 v4, 10240, v2
    v_add_u32 v5, 14336, v2
    s_mul_i32 s26, s23, 5120
    s_mul_i32 s25, s62, 5120
    s_cmp_eq_u32 s22, 18
    s_cselect_b32 s26, s25, s26
    s_cselect_b32 s63, 0, 0
    s_mov_b32 s66, s26
    s_lshl_b32 s25, s23, 2
    s_add_u32 s25, s25, 139264
    v_mov_b32 v13, s25
    s_xor_b32 s25, s25, 4
    s_cmp_eq_u32 s22, 18
    s_cselect_b32 s25, s25, 139264
    v_mov_b32 v14, s25
    v_mov_b32 v15, 0
    ds_write_b32 v13, v15
    s_mov_b32 s73, 0
    s_mul_i32 s25, s24, 1572864
    s_add_u32 s75, s25, s26
    s_add_u32 s75, s75, 0x100000
    s_mov_b32 s88, s75
    s_add_u32 s87, s25, 0x128000
    v_lshlrev_b32 v20, 7, v1
    v_mov_b32 v44, 0x80000000
    s_mov_b32 exec_lo, 0xff
    s_mov_b32 exec_hi, 0x0
    v_mov_b32 v44, 0x0
    s_mov_b64 exec, -1
    v_or_b32 v20, v20, v44
    v_mov_b32 v23, 0xf
    s_mov_b32 exec_lo, 0xff
    s_mov_b32 exec_hi, 0x0
    v_mov_b32 v23, 0x0
    s_mov_b64 exec, -1
    s_add_u32 s79, s54, 0
    s_lshl_b32 s26, s74, 11
    s_add_u32 s25, s25, s26
    s_add_u32 s86, s25, 0x130000
    v_lshrrev_b32 v44, 4, v1
    v_and_b32 v45, 15, v1
    v_lshlrev_b32 v44, 8, v44
    v_lshl_add_u32 v44, v45, 3, v44
    v_add_u32 v12, 16384, v44
    v_lshrrev_b32 v44, 3, v1
    v_lshrrev_b32 v45, 1, v44
    v_xor_b32 v45, v1, v45
    v_and_b32 v45, 7, v45
    v_mul_u32_u24 v44, 2560, v44
    v_lshl_add_u32 v44, v45, 4, v44
    s_lshl_b32 s25, s74, 7
    v_add_u32 v56, s25, v44
    v_xor_b32 v57, 64, v56
    v_add_u32 v57, 20480, v57
    s_lshl_b32 s25, s23, 11
    s_add_u32 s56, s25, 122880
    s_add_u32 s57, s56, 1024
    s_add_u32 s58, s56, 8192
    s_add_u32 s59, s56, 9216
    v_and_b32 v44, 15, v1
    v_lshrrev_b32 v45, 1, v44
    v_lshrrev_b32 v46, 4, v1
    v_xor_b32 v45, v45, v46
    v_lshlrev_b32 v44, 7, v44
    v_lshl_add_u32 v44, v45, 4, v44
    v_add_u32 v58, s56, v44
    v_xor_b32 v59, 64, v58
    s_and_b32 s25, s24, 3
    s_lshl_b32 s25, s25, 9
    s_lshr_b32 s26, s24, 2
    s_add_u32 s25, s25, s26
    s_add_u32 s25, s25, 480
    s_mul_i32 s83, s25, 1280
    s_cmp_lt_u32 s74, 8
    s_cselect_b32 s25, 4, 3
    s_cselect_b32 s26, 3, 7
    s_and_b32 s28, s74, 1
    s_lshl_b32 s26, s28, s26
    s_lshr_b32 s28, s74, 1
    s_lshl_b32 s28, s28, 8
    s_add_u32 s26, s26, s28
    v_and_b32 v44, 15, v1
    v_lshlrev_b32 v44, s25, v44
    v_lshrrev_b32 v45, 5, v1
    v_lshl_add_u32 v44, v45, 2, v44
    v_bfe_u32 v45, v1, 4, 1
    v_lshl_add_u32 v44, v45, 31, v44
    v_add_u32 v68, s26, v44
    s_mov_b32 s77, 0
    s_mov_b32 s81, 0
    s_mov_b32 s80, 0
    s_waitcnt vmcnt(8)
    s_barrier
    ds_read_b64_tr_b16 a[0:1], v50 offset:0
    ds_read_b64_tr_b16 a[2:3], v50 offset:512
    ds_read_b64_tr_b16 a[4:5], v50 offset:8
    ds_read_b64_tr_b16 a[6:7], v50 offset:520
    ds_read_b64_tr_b16 a[8:9], v51 offset:0
    ds_read_b64_tr_b16 a[10:11], v51 offset:512
    ds_read_b64_tr_b16 a[12:13], v51 offset:8
    ds_read_b64_tr_b16 a[14:15], v51 offset:520
    s_mov_b32 s25, 153600
    s_add_u32 m0, s27, 49152
    s_nop 0
    buffer_load_dwordx4 v48, s[12:15], s25 offen offset:0 lds
    s_add_u32 m0, s27, 53120
    s_nop 0
    buffer_load_dwordx4 v48, s[12:15], s25 offen offset:128 lds
    s_mov_b32 s25, 163840
    s_add_u32 m0, s27, 50176
    s_nop 0
    buffer_load_dwordx4 v48, s[12:15], s25 offen offset:0 lds
    s_add_u32 m0, s27, 54144
    s_nop 0
    buffer_load_dwordx4 v48, s[12:15], s25 offen offset:128 lds
    s_waitcnt lgkmcnt(0)
    s_waitcnt vmcnt(8)
    s_barrier
    ds_read_b64_tr_b16 a[16:17], v50 offset:16384
    ds_read_b64_tr_b16 a[18:19], v50 offset:16896
    ds_read_b64_tr_b16 a[20:21], v50 offset:16392
    ds_read_b64_tr_b16 a[22:23], v50 offset:16904
    ds_read_b64_tr_b16 a[24:25], v51 offset:16384
    ds_read_b64_tr_b16 a[26:27], v51 offset:16896
    ds_read_b64_tr_b16 a[28:29], v51 offset:16392
    ds_read_b64_tr_b16 a[30:31], v51 offset:16904
    s_cmp_lg_u32 s23, 0
    s_cbranch_scc1 an1_90
    v_mov_b32 v25, s24
    v_lshlrev_b32 v25, 5, v25
    s_mov_b64 exec, 3
    buffer_load_dword v24, v25, s[16:19], 0 offen sc1
    s_mov_b64 exec, -1
an1_90:
    s_mov_b32 s25, 204800
    s_add_u32 m0, s27, 0
    s_nop 0
    buffer_load_dwordx4 v48, s[12:15], s25 offen offset:0 lds
    s_add_u32 m0, s27, 3968
    s_nop 0
    buffer_load_dwordx4 v48, s[12:15], s25 offen offset:128 lds
    s_mov_b32 s25, 215040
    s_add_u32 m0, s27, 1024
    s_nop 0
    buffer_load_dwordx4 v48, s[12:15], s25 offen offset:0 lds
    s_add_u32 m0, s27, 4992
    s_nop 0
    buffer_load_dwordx4 v48, s[12:15], s25 offen offset:128 lds
    s_waitcnt lgkmcnt(0)
    s_waitcnt vmcnt(8)
    s_barrier
    ds_read_b64_tr_b16 a[32:33], v50 offset:32768
    ds_read_b64_tr_b16 a[34:35], v50 offset:33280
    ds_read_b64_tr_b16 a[36:37], v50 offset:32776
    ds_read_b64_tr_b16 a[38:39], v50 offset:33288
    ds_read_b64_tr_b16 a[40:41], v51 offset:32768
    ds_read_b64_tr_b16 a[42:43], v51 offset:33280
    ds_read_b64_tr_b16 a[44:45], v51 offset:32776
    ds_read_b64_tr_b16 a[46:47], v51 offset:33288
    s_mov_b32 s25, 256000
    s_add_u32 m0, s27, 16384
    s_nop 0
    buffer_load_dwordx4 v48, s[12:15], s25 offen offset:0 lds
    s_add_u32 m0, s27, 20352
    s_nop 0
    buffer_load_dwordx4 v48, s[12:15], s25 offen offset:128 lds
    s_mov_b32 s25, 266240
    s_add_u32 m0, s27, 17408
    s_nop 0
    buffer_load_dwordx4 v48, s[12:15], s25 offen offset:0 lds
    s_add_u32 m0, s27, 21376
    s_nop 0
    buffer_load_dwordx4 v48, s[12:15], s25 offen offset:128 lds
    s_waitcnt lgkmcnt(0)
    s_waitcnt vmcnt(8)
    s_barrier
    ds_read_b64_tr_b16 a[48:49], v50 offset:49152
    ds_read_b64_tr_b16 a[50:51], v50 offset:49664
    ds_read_b64_tr_b16 a[52:53], v50 offset:49160
    ds_read_b64_tr_b16 a[54:55], v50 offset:49672
    ds_read_b64_tr_b16 a[56:57], v51 offset:49152
    ds_read_b64_tr_b16 a[58:59], v51 offset:49664
    ds_read_b64_tr_b16 a[60:61], v51 offset:49160
    ds_read_b64_tr_b16 a[62:63], v51 offset:49672
    s_mov_b32 s25, 307200
    s_add_u32 m0, s27, 32768
    s_nop 0
    buffer_load_dwordx4 v48, s[12:15], s25 offen offset:0 lds
    s_add_u32 m0, s27, 36736
    s_nop 0
    buffer_load_dwordx4 v48, s[12:15], s25 offen offset:128 lds
    s_mov_b32 s25, 317440
    s_add_u32 m0, s27, 33792
    s_nop 0
    buffer_load_dwordx4 v48, s[12:15], s25 offen offset:0 lds
    s_add_u32 m0, s27, 37760
    s_nop 0
    buffer_load_dwordx4 v48, s[12:15], s25 offen offset:128 lds
    s_waitcnt lgkmcnt(0)
    s_waitcnt vmcnt(8)
    s_barrier
    ds_read_b64_tr_b16 a[64:65], v50 offset:0
    ds_read_b64_tr_b16 a[66:67], v50 offset:512
    ds_read_b64_tr_b16 a[68:69], v50 offset:8
    ds_read_b64_tr_b16 a[70:71], v50 offset:520
    ds_read_b64_tr_b16 a[72:73], v51 offset:0
    ds_read_b64_tr_b16 a[74:75], v51 offset:512
    ds_read_b64_tr_b16 a[76:77], v51 offset:8
    ds_read_b64_tr_b16 a[78:79], v51 offset:520
    s_cmp_lg_u32 s23, 0
    s_cbranch_scc1 an2_91
    s_mov_b32 s29, 0
    s_branch gse_94
gs_92:
    v_mov_b32 v25, s24
    v_lshlrev_b32 v25, 5, v25
    s_mov_b64 exec, 3
    buffer_load_dword v24, v25, s[16:19], 0 offen sc1
    s_mov_b64 exec, -1
    s_waitcnt vmcnt(0)
gse_94:
    s_mov_b64 exec, 3
    v_cmp_eq_u32 vcc, 0, v24
    s_mov_b64 exec, -1
    s_nop 1
    s_cbranch_vccz gsd_93
    s_sleep 2
    s_add_u32 s29, s29, 1
    s_cmp_lt_u32 s29, 20000
    s_cbranch_scc1 gs_92
    s_mov_b32 s29, 99
    s_branch L_fail
gsd_93:
    s_cmp_lg_u32 s23, 0
    s_cbranch_scc1 ann_95
    s_getreg_b32 s25, hwreg(HW_REG_XCC_ID, 0, 4)
    s_add_u32 s25, s25, 1
    v_mov_b32 v24, s25
    v_lshlrev_b32 v25, 26, v1
    s_lshr_b32 s26, s2, 3
    s_lshl_b32 s26, s26, 7
    s_add_u32 s26, s26, s21
    s_add_u32 s26, s26, 0x8000
    buffer_store_dword v24, v25, s[4:7], s26 offen sc1
ann_95:
an2_91:
    s_mov_b32 s25, 358400
    s_add_u32 m0, s27, 49152
    s_nop 0
    buffer_load_dwordx4 v48, s[12:15], s25 offen offset:0 lds
    s_add_u32 m0, s27, 53120
    s_nop 0
    buffer_load_dwordx4 v48, s[12:15], s25 offen offset:128 lds
    s_mov_b32 s25, 368640
    s_add_u32 m0, s27, 50176
    s_nop 0
    buffer_load_dwordx4 v48, s[12:15], s25 offen offset:0 lds
    s_add_u32 m0, s27, 54144
    s_nop 0
    buffer_load_dwordx4 v48, s[12:15], s25 offen offset:128 lds
    s_waitcnt lgkmcnt(0)
    s_waitcnt vmcnt(8)
    s_barrier
    ds_read_b64_tr_b16 a[80:81], v50 offset:16384
    ds_read_b64_tr_b16 a[82:83], v50 offset:16896
    ds_read_b64_tr_b16 a[84:85], v50 offset:16392
    ds_read_b64_tr_b16 a[86:87], v50 offset:16904
    ds_read_b64_tr_b16 a[88:89], v51 offset:16384
    ds_read_b64_tr_b16 a[90:91], v51 offset:16896
    ds_read_b64_tr_b16 a[92:93], v51 offset:16392
    ds_read_b64_tr_b16 a[94:95], v51 offset:16904
    s_mov_b32 s25, 409600
    s_add_u32 m0, s27, 0
    s_nop 0
    buffer_load_dwordx4 v48, s[12:15], s25 offen offset:0 lds
    s_add_u32 m0, s27, 3968
    s_nop 0
    buffer_load_dwordx4 v48, s[12:15], s25 offen offset:128 lds
    s_mov_b32 s25, 419840
    s_add_u32 m0, s27, 1024
    s_nop 0
    buffer_load_dwordx4 v48, s[12:15], s25 offen offset:0 lds
    s_add_u32 m0, s27, 4992
    s_nop 0
    buffer_load_dwordx4 v48, s[12:15], s25 offen offset:128 lds
    s_waitcnt lgkmcnt(0)
    s_waitcnt vmcnt(8)
    s_barrier
    ds_read_b64_tr_b16 a[96:97], v50 offset:32768
    ds_read_b64_tr_b16 a[98:99], v50 offset:33280
    ds_read_b64_tr_b16 a[100:101], v50 offset:32776
    ds_read_b64_tr_b16 a[102:103], v50 offset:33288
    ds_read_b64_tr_b16 a[104:105], v51 offset:32768
    ds_read_b64_tr_b16 a[106:107], v51 offset:33280
    ds_read_b64_tr_b16 a[108:109], v51 offset:32776
    ds_read_b64_tr_b16 a[110:111], v51 offset:33288
    s_mov_b32 s25, 460800
    s_add_u32 m0, s27, 16384
    s_nop 0
    buffer_load_dwordx4 v48, s[12:15], s25 offen offset:0 lds
    s_add_u32 m0, s27, 20352
    s_nop 0
    buffer_load_dwordx4 v48, s[12:15], s25 offen offset:128 lds
    s_mov_b32 s25, 471040
    s_add_u32 m0, s27, 17408
    s_nop 0
    buffer_load_dwordx4 v48, s[12:15], s25 offen offset:0 lds
    s_add_u32 m0, s27, 21376
    s_nop 0
    buffer_load_dwordx4 v48, s[12:15], s25 offen offset:128 lds
    s_waitcnt lgkmcnt(0)
    s_waitcnt vmcnt(8)
    s_barrier
    ds_read_b64_tr_b16 a[112:113], v50 offset:49152
    ds_read_b64_tr_b16 a[114:115], v50 offset:49664
    ds_read_b64_tr_b16 a[116:117], v50 offset:49160
    ds_read_b64_tr_b16 a[118:119], v50 offset:49672
    ds_read_b64_tr_b16 a[120:121], v51 offset:49152
    ds_read_b64_tr_b16 a[122:123], v51 offset:49664
    ds_read_b64_tr_b16 a[124:125], v51 offset:49160
    ds_read_b64_tr_b16 a[126:127], v51 offset:49672
    s_mov_b32 s25, 512000
    s_add_u32 m0, s27, 32768
    s_nop 0
    buffer_load_dwordx4 v48, s[12:15], s25 offen offset:0 lds
    s_add_u32 m0, s27, 36736
    s_nop 0
    buffer_load_dwordx4 v48, s[12:15], s25 offen offset:128 lds
    s_mov_b32 s25, 522240
    s_add_u32 m0, s27, 33792
    s_nop 0
    buffer_load_dwordx4 v48, s[12:15], s25 offen offset:0 lds
    s_add_u32 m0, s27, 37760
    s_nop 0
    buffer_load_dwordx4 v48, s[12:15], s25 offen offset:128 lds
    s_waitcnt lgkmcnt(0)
    s_waitcnt vmcnt(8)
    s_barrier
    ds_read_b64_tr_b16 a[128:129], v50 offset:0
    ds_read_b64_tr_b16 a[130:131], v50 offset:512
    ds_read_b64_tr_b16 a[132:133], v50 offset:8
    ds_read_b64_tr_b16 a[134:135], v50 offset:520
    ds_read_b64_tr_b16 a[136:137], v51 offset:0
    ds_read_b64_tr_b16 a[138:139], v51 offset:512
    ds_read_b64_tr_b16 a[140:141], v51 offset:8
    ds_read_b64_tr_b16 a[142:143], v51 offset:520
    s_mov_b32 s25, 563200
    s_add_u32 m0, s27, 49152
    s_nop 0
    buffer_load_dwordx4 v48, s[12:15], s25 offen offset:0 lds
    s_add_u32 m0, s27, 53120
    s_nop 0
    buffer_load_dwordx4 v48, s[12:15], s25 offen offset:128 lds
    s_mov_b32 s25, 573440
    s_add_u32 m0, s27, 50176
    s_nop 0
    buffer_load_dwordx4 v48, s[12:15], s25 offen offset:0 lds
    s_add_u32 m0, s27, 54144
    s_nop 0
    buffer_load_dwordx4 v48, s[12:15], s25 offen offset:128 lds
    s_waitcnt lgkmcnt(0)
    s_waitcnt vmcnt(8)
    s_barrier
    ds_read_b64_tr_b16 a[144:145], v50 offset:16384
    ds_read_b64_tr_b16 a[146:147], v50 offset:16896
    ds_read_b64_tr_b16 a[148:149], v50 offset:16392
    ds_read_b64_tr_b16 a[150:151], v50 offset:16904
    ds_read_b64_tr_b16 a[152:153], v51 offset:16384
    ds_read_b64_tr_b16 a[154:155], v51 offset:16896
    ds_read_b64_tr_b16 a[156:157], v51 offset:16392
    ds_read_b64_tr_b16 a[158:159], v51 offset:16904
    s_mov_b32 s25, 614400
    s_add_u32 m0, s27, 0
    s_nop 0
    buffer_load_dwordx4 v48, s[12:15], s25 offen offset:0 lds
    s_add_u32 m0, s27, 3968
    s_nop 0
    buffer_load_dwordx4 v48, s[12:15], s25 offen offset:128 lds
    s_mov_b32 s25, 624640
    s_add_u32 m0, s27, 1024
    s_nop 0
    buffer_load_dwordx4 v48, s[12:15], s25 offen offset:0 lds
    s_add_u32 m0, s27, 4992
    s_nop 0
    buffer_load_dwordx4 v48, s[12:15], s25 offen offset:128 lds
    s_waitcnt lgkmcnt(0)
    s_waitcnt vmcnt(8)
    s_barrier
    ds_read_b64_tr_b16 a[160:161], v50 offset:32768
    ds_read_b64_tr_b16 a[162:163], v50 offset:33280
    ds_read_b64_tr_b16 a[164:165], v50 offset:32776
    ds_read_b64_tr_b16 a[166:167], v50 offset:33288
    ds_read_b64_tr_b16 a[168:169], v51 offset:32768
    ds_read_b64_tr_b16 a[170:171], v51 offset:33280
    ds_read_b64_tr_b16 a[172:173], v51 offset:32776
    ds_read_b64_tr_b16 a[174:175], v51 offset:33288
    s_mov_b32 s25, 665600
    s_add_u32 m0, s27, 16384
    s_nop 0
    buffer_load_dwordx4 v48, s[12:15], s25 offen offset:0 lds
    s_add_u32 m0, s27, 20352
    s_nop 0
    buffer_load_dwordx4 v48, s[12:15], s25 offen offset:128 lds
    s_mov_b32 s25, 675840
    s_add_u32 m0, s27, 17408
    s_nop 0
    buffer_load_dwordx4 v48, s[12:15], s25 offen offset:0 lds
    s_add_u32 m0, s27, 21376
    s_nop 0
    buffer_load_dwordx4 v48, s[12:15], s25 offen offset:128 lds
    s_waitcnt lgkmcnt(0)
    s_waitcnt vmcnt(8)
    s_barrier
    ds_read_b64_tr_b16 a[176:177], v50 offset:49152
    ds_read_b64_tr_b16 a[178:179], v50 offset:49664
    ds_read_b64_tr_b16 a[180:181], v50 offset:49160
    ds_read_b64_tr_b16 a[182:183], v50 offset:49672
    ds_read_b64_tr_b16 a[184:185], v51 offset:49152
    ds_read_b64_tr_b16 a[186:187], v51 offset:49664
    ds_read_b64_tr_b16 a[188:189], v51 offset:49160
    ds_read_b64_tr_b16 a[190:191], v51 offset:49672
    s_mov_b32 s25, 716800
    s_add_u32 m0, s27, 32768
    s_nop 0
    buffer_load_dwordx4 v48, s[12:15], s25 offen offset:0 lds
    s_add_u32 m0, s27, 36736
    s_nop 0
    buffer_load_dwordx4 v48, s[12:15], s25 offen offset:128 lds
    s_mov_b32 s25, 727040
    s_add_u32 m0, s27, 33792
    s_nop 0
    buffer_load_dwordx4 v48, s[12:15], s25 offen offset:0 lds
    s_add_u32 m0, s27, 37760
    s_nop 0
    buffer_load_dwordx4 v48, s[12:15], s25 offen offset:128 lds
    s_waitcnt lgkmcnt(0)
    s_waitcnt vmcnt(8)
    s_barrier
    ds_read_b64_tr_b16 a[192:193], v50 offset:0
    ds_read_b64_tr_b16 a[194:195], v50 offset:512
    ds_read_b64_tr_b16 a[196:197], v50 offset:8
    ds_read_b64_tr_b16 a[198:199], v50 offset:520
    ds_read_b64_tr_b16 a[200:201], v51 offset:0
    ds_read_b64_tr_b16 a[202:203], v51 offset:512
    ds_read_b64_tr_b16 a[204:205], v51 offset:8
    ds_read_b64_tr_b16 a[206:207], v51 offset:520
    s_mov_b32 s25, 768000
    s_add_u32 m0, s27, 49152
    s_nop 0
    buffer_load_dwordx4 v48, s[12:15], s25 offen offset:0 lds
    s_add_u32 m0, s27, 53120
    s_nop 0
    buffer_load_dwordx4 v48, s[12:15], s25 offen offset:128 lds
    s_mov_b32 s25, 778240
    s_add_u32 m0, s27, 50176
    s_nop 0
    buffer_load_dwordx4 v48, s[12:15], s25 offen offset:0 lds
    s_add_u32 m0, s27, 54144
    s_nop 0
    buffer_load_dwordx4 v48, s[12:15], s25 offen offset:128 lds
    s_waitcnt lgkmcnt(0)
    s_waitcnt vmcnt(8)
    s_barrier
    ds_read_b64_tr_b16 a[208:209], v50 offset:16384
    ds_read_b64_tr_b16 a[210:211], v50 offset:16896
    ds_read_b64_tr_b16 a[212:213], v50 offset:16392
    ds_read_b64_tr_b16 a[214:215], v50 offset:16904
    ds_read_b64_tr_b16 a[216:217], v51 offset:16384
    ds_read_b64_tr_b16 a[218:219], v51 offset:16896
    ds_read_b64_tr_b16 a[220:221], v51 offset:16392
    ds_read_b64_tr_b16 a[222:223], v51 offset:16904
    s_mov_b32 s25, 0
    s_add_u32 m0, s27, 0
    s_nop 0
    buffer_load_dwordx4 v49, s[12:15], s25 offen offset:0 lds
    s_add_u32 m0, s27, 3968
    s_nop 0
    buffer_load_dwordx4 v49, s[12:15], s25 offen offset:128 lds
    s_mov_b32 s25, 51200
    s_add_u32 m0, s27, 1024
    s_nop 0
    buffer_load_dwordx4 v49, s[12:15], s25 offen offset:0 lds
    s_add_u32 m0, s27, 4992
    s_nop 0
    buffer_load_dwordx4 v49, s[12:15], s25 offen offset:128 lds
    s_waitcnt lgkmcnt(0)
    s_waitcnt vmcnt(8)
    s_barrier
    ds_read_b64_tr_b16 a[224:225], v50 offset:32768
    ds_read_b64_tr_b16 a[226:227], v50 offset:33280
    ds_read_b64_tr_b16 a[228:229], v50 offset:32776
    ds_read_b64_tr_b16 a[230:231], v50 offset:33288
    ds_read_b64_tr_b16 a[232:233], v51 offset:32768
    ds_read_b64_tr_b16 a[234:235], v51 offset:33280
    ds_read_b64_tr_b16 a[236:237], v51 offset:32776
    ds_read_b64_tr_b16 a[238:239], v51 offset:33288
    s_mov_b32 s25, 204800
    s_add_u32 m0, s27, 16384
    s_nop 0
    buffer_load_dwordx4 v49, s[12:15], s25 offen offset:0 lds
    s_add_u32 m0, s27, 20352
    s_nop 0
    buffer_load_dwordx4 v49, s[12:15], s25 offen offset:128 lds
    s_mov_b32 s25, 256000
    s_add_u32 m0, s27, 17408
    s_nop 0
    buffer_load_dwordx4 v49, s[12:15], s25 offen offset:0 lds
    s_add_u32 m0, s27, 21376
    s_nop 0
    buffer_load_dwordx4 v49, s[12:15], s25 offen offset:128 lds
    s_waitcnt lgkmcnt(0)
    s_waitcnt vmcnt(8)
    s_barrier
    ds_read_b64_tr_b16 a[240:241], v50 offset:49152
    ds_read_b64_tr_b16 a[242:243], v50 offset:49664
    ds_read_b64_tr_b16 a[244:245], v50 offset:49160
    ds_read_b64_tr_b16 a[246:247], v50 offset:49672
    ds_read_b64_tr_b16 a[248:249], v51 offset:49152
    ds_read_b64_tr_b16 a[250:251], v51 offset:49664
    ds_read_b64_tr_b16 a[252:253], v51 offset:49160
    ds_read_b64_tr_b16 a[254:255], v51 offset:49672
    s_mov_b32 s25, 409600
    s_add_u32 m0, s27, 32768
    s_nop 0
    buffer_load_dwordx4 v49, s[12:15], s25 offen offset:0 lds
    s_add_u32 m0, s27, 36736
    s_nop 0
    buffer_load_dwordx4 v49, s[12:15], s25 offen offset:128 lds
    s_mov_b32 s25, 460800
    s_add_u32 m0, s27, 33792
    s_nop 0
    buffer_load_dwordx4 v49, s[12:15], s25 offen offset:0 lds
    s_add_u32 m0, s27, 37760
    s_nop 0
    buffer_load_dwordx4 v49, s[12:15], s25 offen offset:128 lds
    s_waitcnt lgkmcnt(0)
    s_waitcnt vmcnt(8)
    s_barrier
    ds_read_b64_tr_b16 v[192:193], v50 offset:0
    ds_read_b64_tr_b16 v[194:195], v50 offset:512
    ds_read_b64_tr_b16 v[196:197], v50 offset:8
    ds_read_b64_tr_b16 v[198:199], v50 offset:520
    ds_read_b64_tr_b16 v[200:201], v51 offset:0
    ds_read_b64_tr_b16 v[202:203], v51 offset:512
    ds_read_b64_tr_b16 v[204:205], v51 offset:8
    ds_read_b64_tr_b16 v[206:207], v51 offset:520
    s_mov_b32 s25, 614400
    s_add_u32 m0, s27, 49152
    s_nop 0
    buffer_load_dwordx4 v49, s[12:15], s25 offen offset:0 lds
    s_add_u32 m0, s27, 53120
    s_nop 0
    buffer_load_dwordx4 v49, s[12:15], s25 offen offset:128 lds
    s_mov_b32 s25, 665600
    s_add_u32 m0, s27, 50176
    s_nop 0
    buffer_load_dwordx4 v49, s[12:15], s25 offen offset:0 lds
    s_add_u32 m0, s27, 54144
    s_nop 0
    buffer_load_dwordx4 v49, s[12:15], s25 offen offset:128 lds
    s_waitcnt lgkmcnt(0)
    s_waitcnt vmcnt(8)
    s_barrier
    ds_read_b64_tr_b16 v[208:209], v50 offset:16384
    ds_read_b64_tr_b16 v[210:211], v50 offset:16896
    ds_read_b64_tr_b16 v[212:213], v50 offset:16392
    ds_read_b64_tr_b16 v[214:215], v50 offset:16904
    ds_read_b64_tr_b16 v[216:217], v51 offset:16384
    ds_read_b64_tr_b16 v[218:219], v51 offset:16896
    ds_read_b64_tr_b16 v[220:221], v51 offset:16392
    ds_read_b64_tr_b16 v[222:223], v51 offset:16904
    s_waitcnt lgkmcnt(0)
    s_waitcnt vmcnt(4)
    s_barrier
    ds_read_b64_tr_b16 v[224:225], v50 offset:32768
    ds_read_b64_tr_b16 v[226:227], v50 offset:33280
    ds_read_b64_tr_b16 v[228:229], v50 offset:32776
    ds_read_b64_tr_b16 v[230:231], v50 offset:33288
    ds_read_b64_tr_b16 v[232:233], v51 offset:32768
    ds_read_b64_tr_b16 v[234:235], v51 offset:33280
    ds_read_b64_tr_b16 v[236:237], v51 offset:32776
    ds_read_b64_tr_b16 v[238:239], v51 offset:33288
RE_p2:
    s_waitcnt lgkmcnt(0)
    s_waitcnt vmcnt(0)
    s_barrier
    ds_read_b64_tr_b16 v[240:241], v50 offset:49152
    ds_read_b64_tr_b16 v[242:243], v50 offset:49664
    ds_read_b64_tr_b16 v[244:245], v50 offset:49160
    ds_read_b64_tr_b16 v[246:247], v50 offset:49672
    ds_read_b64_tr_b16 v[248:249], v51 offset:49152
    ds_read_b64_tr_b16 v[250:251], v51 offset:49664
    ds_read_b64_tr_b16 v[252:253], v51 offset:49160
    ds_read_b64_tr_b16 v[254:255], v51 offset:49672
    s_waitcnt lgkmcnt(0)
    s_waitcnt lgkmcnt(0)
    s_barrier
S_p2:
    s_mov_b32 s55, 0
Dp2:
    s_mov_b32 s75, s88
    s_mov_b32 s29, 0
gs_96:
    v_lshlrev_b32 v26, 7, v1
    s_add_u32 s26, s21, 0x8000
    s_mov_b32 exec_hi, 0
    buffer_load_dword v24, v26, s[4:7], s26 offen sc1
    s_mov_b32 exec_hi, -1
    s_waitcnt vmcnt(0)
gse_98:
    s_mov_b32 exec_hi, 0
    v_cmp_eq_u32 vcc, 0, v24
    s_mov_b32 exec_hi, -1
    s_nop 1
    s_cbranch_vccz gsd_97
    s_sleep 2
    s_add_u32 s29, s29, 1
    s_cmp_lt_u32 s29, 20000
    s_cbranch_scc1 gs_96
    s_mov_b32 s29, 98
    s_branch L_fail
gsd_97:
    s_getreg_b32 s25, hwreg(HW_REG_XCC_ID, 0, 4)
    s_add_u32 s25, s25, 1
    s_mov_b32 exec_hi, 0
    v_cmp_ne_u32 vcc, s25, v24
    s_mov_b32 exec_hi, -1
    s_nop 0
    s_cmp_eq_u64 vcc, 0
    s_cselect_b32 s20, 0, 0xff
    s_lshr_b32 s26, s2, 3
    s_add_u32 s26, s26, 0
    s_lshl_b32 s26, s26, 7
    s_add_u32 s26, s26, s54
    s_lshl_b32 s25, s23, 2
    s_add_u32 s60, s26, s25
    s_cmp_eq_u32 s20, 0
    s_cselect_b32 s61, s60, 0x2000000
    s_mov_b32 s78, 63
    s_mov_b32 s64, s63
    s_add_u32 s65, s63, s66
    v_add_u32 v6, s64, v2
    v_add_u32 v8, s64, v12
    v_add_u32 v9, 2048, v8
    s_mov_b32 s80, 0
    s_mov_b32 s77, 0x2000000
    s_mov_b32 s68, 0x2000000
    s_mov_b32 s69, 0x2000000
    s_mov_b32 s81, 0x2000000
    s_mov_b32 s82, s83
    s_mov_b32 s29, 0
spin_100:
    buffer_load_dwordx4 v[24:27], v20, s[4:7], s79 offen sc1
    s_waitcnt vmcnt(0)
    v_max3_u32 v28, v24, v25, v26
    v_max_u32 v28, v28, v27
    v_cmp_lt_u32 vcc, s78, v28
    s_nop 1
    s_cbranch_vccz spind_101
    s_sleep 3
    s_add_u32 s29, s29, 1
    s_cmp_lt_u32 s29, 20000
    s_cbranch_scc1 spin_100
    s_mov_b32 s29, 21
    s_branch L_fail
spind_101:
    s_bitcmp1_b32 s20, 0
    s_cbranch_scc0 acq_102
    buffer_inv sc1
    s_waitcnt vmcnt(0)
acq_102:
G_p2:
    s_cmp_eq_u32 s22, 18
    s_cbranch_scc1 pair_103
    s_add_u32 m0, s65, 0
    s_nop 0
    buffer_load_dwordx4 v2, s[4:7], s75 offen offset:0 sc1 lds
    buffer_load_dwordx4 v2, s[4:7], s75 offen offset:1024 sc1 lds
    buffer_load_dwordx4 v2, s[4:7], s75 offen offset:2048 sc1 lds
    buffer_load_dwordx4 v2, s[4:7], s75 offen offset:3072 sc1 lds
    s_add_u32 m0, s65, 4096
    s_nop 0
    buffer_load_dwordx4 v3, s[4:7], s75 offen offset:0 sc1 lds
skp_99:
    s_mov_b32 m0, s56
    s_nop 0
    buffer_load_dwordx4 v56, s[8:11], s82 offen sc1 lds
    s_mov_b32 m0, s57
    s_nop 0
    buffer_load_dwordx4 v57, s[8:11], s82 offen sc1 lds
    s_sub_u32 s82, s83, 40960
    s_mov_b32 s78, 62
    buffer_load_dwordx4 v[24:27], v20, s[4:7], s79 offen sc1
    s_add_u32 s75, s75, 20480
    s_add_u32 s64, s64, 20480
    s_sub_u32 s65, s64, s63
    s_cmp_eq_u32 s65, 61440
    s_cselect_b32 s64, s63, s64
    s_add_u32 s65, s64, s66
    s_add_u32 s73, s73, 1
    v_mov_b32 v15, s73
    s_waitcnt vmcnt(0)
    ds_write_b32 v13, v15
    s_mov_b32 s29, 0
sys_124:
    ds_read_b128 v[16:19], v14
    s_waitcnt lgkmcnt(0)
    v_min3_u32 v16, v16, v17, v18
    v_min_u32 v16, v16, v19
    s_nop 0
    v_readfirstlane_b32 s67, v16
    s_nop 0
    s_cmp_lt_u32 s67, s73
    s_cbranch_scc0 syd_125
    s_add_u32 s29, s29, 1
    s_cmp_lt_u32 s29, 160000
    s_cbranch_scc1 sys_124
    s_mov_b32 s29, 25
    s_branch L_fail
syd_125:
    ds_read_b128 v[140:143], v6 offset:0
    ds_read_b128 v[144:147], v6 offset:1024
    ds_read_b128 v[148:151], v6 offset:2048
    ds_read_b128 v[152:155], v6 offset:3072
    s_waitcnt lgkmcnt(0)
p2loop_105:
    s_waitcnt lgkmcnt(3)
    v_mfma_f32_16x16x32_bf16 v[160:163], a[0:3], v[140:143], 0
    ds_read_b128 v[156:159], v6 offset:4096
    v_add_f32 v176, v176, v70
    v_mfma_f32_16x16x32_bf16 v[164:167], a[4:7], v[140:143], 0
    v_add_u32 v7, s64, v2
    v_add_u32 v10, s64, v12
    v_mfma_f32_16x16x32_bf16 v[168:171], a[8:11], v[140:143], 0
    v_add_u32 v11, 2048, v10
    v_add_f32 v177, v177, v71
    v_mfma_f32_16x16x32_bf16 v[172:175], a[12:15], v[140:143], 0
    s_waitcnt lgkmcnt(2)
    buffer_load_dwordx4 v[24:27], v20, s[4:7], s79 offen sc1
    v_mfma_f32_16x16x32_bf16 v[160:163], a[16:19], v[144:147], v[160:163]
    ds_read_b128 v[140:143], v6 offset:5120
    v_add_f32 v178, v178, v72
    v_mfma_f32_16x16x32_bf16 v[164:167], a[20:23], v[144:147], v[164:167]
    v_add_f32 v179, v179, v73
    v_add_f32 v180, v180, v74
    v_mfma_f32_16x16x32_bf16 v[168:171], a[24:27], v[144:147], v[168:171]
    v_add_f32 v181, v181, v75
    v_add_f32 v182, v182, v76
    v_mfma_f32_16x16x32_bf16 v[172:175], a[28:31], v[144:147], v[172:175]
    v_add_f32 v183, v183, v77
    v_cvt_pk_bf16_f32 v30, v176, v177
    v_mfma_f32_16x16x32_bf16 v[160:163], a[32:35], v[148:151], v[160:163]
    ds_read_b128 v[144:147], v6 offset:6144
    v_cvt_pk_bf16_f32 v31, v178, v179
    v_mfma_f32_16x16x32_bf16 v[164:167], a[36:39], v[148:151], v[164:167]
    v_cvt_pk_bf16_f32 v32, v180, v181
    v_cvt_pk_bf16_f32 v33, v182, v183
    v_mfma_f32_16x16x32_bf16 v[168:171], a[40:43], v[148:151], v[168:171]
    v_add_f32 v184, v184, v78
    v_add_f32 v185, v185, v79
    v_mfma_f32_16x16x32_bf16 v[172:175], a[44:47], v[148:151], v[172:175]
    s_waitcnt lgkmcnt(1)
    v_add_f32 v186, v186, v80
    v_add_f32 v187, v187, v81
    v_mfma_f32_16x16x32_bf16 v[160:163], a[48:51], v[152:155], v[160:163]
    ds_read_b128 v[148:151], v6 offset:7168
    v_add_f32 v188, v188, v82
    v_mfma_f32_16x16x32_bf16 v[164:167], a[52:55], v[152:155], v[164:167]
    v_add_f32 v189, v189, v83
    v_add_f32 v190, v190, v84
    v_mfma_f32_16x16x32_bf16 v[168:171], a[56:59], v[152:155], v[168:171]
    v_add_f32 v191, v191, v85
    v_cvt_pk_bf16_f32 v34, v184, v185
    v_mfma_f32_16x16x32_bf16 v[172:175], a[60:63], v[152:155], v[172:175]
    v_cvt_pk_bf16_f32 v35, v186, v187
    v_cvt_pk_bf16_f32 v36, v188, v189
    v_mfma_f32_16x16x32_bf16 v[160:163], a[64:67], v[156:159], v[160:163]
    ds_read_b128 v[152:155], v6 offset:8192
    s_waitcnt vmcnt(0)
    v_max3_u32 v28, v24, v25, v26
    v_mfma_f32_16x16x32_bf16 v[164:167], a[68:71], v[156:159], v[164:167]
    v_max3_u32 v28, v28, v27, s20
    v_cmp_lt_u32 vcc, s78, v28
    v_mfma_f32_16x16x32_bf16 v[168:171], a[72:75], v[156:159], v[168:171]
    v_cvt_pk_bf16_f32 v37, v190, v191
    v_mfma_f32_16x16x32_bf16 v[172:175], a[76:79], v[156:159], v[172:175]
    buffer_store_dwordx4 v[30:33], v2, s[4:7], s77 offen offset:0
    v_mfma_f32_16x16x32_bf16 v[160:163], a[80:83], v[140:143], v[160:163]
    ds_read_b128 v[156:159], v6 offset:9216
    v_mfma_f32_16x16x32_bf16 v[164:167], a[84:87], v[140:143], v[164:167]
    buffer_store_dwordx4 v[34:37], v2, s[4:7], s77 offen offset:1024
    v_mfma_f32_16x16x32_bf16 v[168:171], a[88:91], v[140:143], v[168:171]
    s_cbranch_vccnz slow_106
ret_107:
    s_add_u32 m0, s65, 0
    v_mfma_f32_16x16x32_bf16 v[172:175], a[92:95], v[140:143], v[172:175]
    s_waitcnt lgkmcnt(1)
    buffer_load_dwordx4 v2, s[4:7], s75 offen offset:0 sc1 lds
    v_mfma_f32_16x16x32_bf16 v[160:163], a[96:99], v[144:147], v[160:163]
    ds_read_b128 v[140:143], v6 offset:10240
    ds_read_b128 v[60:63], v58 offset:0
    v_mfma_f32_16x16x32_bf16 v[164:167], a[100:103], v[144:147], v[164:167]
    buffer_load_dwordx4 v2, s[4:7], s75 offen offset:1024 sc1 lds
    v_mfma_f32_16x16x32_bf16 v[168:171], a[104:107], v[144:147], v[168:171]
    buffer_load_dwordx4 v2, s[4:7], s75 offen offset:2048 sc1 lds
    v_mfma_f32_16x16x32_bf16 v[172:175], a[108:111], v[144:147], v[172:175]
    ds_read_b128 v[64:67], v59 offset:0
    v_add_f32 v38, v176, v177
    v_mfma_f32_16x16x32_bf16 v[160:163], a[112:115], v[148:151], v[160:163]
    ds_read_b128 v[144:147], v6 offset:11264
    v_mul_f32 v39, v176, v176
    v_mfma_f32_16x16x32_bf16 v[164:167], a[116:119], v[148:151], v[164:167]
    buffer_load_dwordx4 v2, s[4:7], s75 offen offset:3072 sc1 lds
    v_mfma_f32_16x16x32_bf16 v[168:171], a[120:123], v[148:151], v[168:171]
    s_add_u32 m0, s65, 4096
    v_fmac_f32 v39, v177, v177
    v_add_f32 v38, v38, v178
    v_mfma_f32_16x16x32_bf16 v[172:175], a[124:127], v[148:151], v[172:175]
    v_fmac_f32 v39, v178, v178
    v_add_f32 v38, v38, v179
    v_mfma_f32_16x16x32_bf16 v[160:163], a[128:131], v[152:155], v[160:163]
    ds_read_b128 v[148:151], v6 offset:12288
    v_fmac_f32 v39, v179, v179
    v_mfma_f32_16x16x32_bf16 v[164:167], a[132:135], v[152:155], v[164:167]
    buffer_load_dwordx4 v3, s[4:7], s75 offen offset:0 sc1 lds
    v_mfma_f32_16x16x32_bf16 v[168:171], a[136:139], v[152:155], v[168:171]
    s_mov_b32 m0, s58
    v_add_f32 v38, v38, v180
    v_fmac_f32 v39, v180, v180
    v_mfma_f32_16x16x32_bf16 v[172:175], a[140:143], v[152:155], v[172:175]
    s_waitcnt lgkmcnt(1)
    buffer_load_dwordx4 v56, s[8:11], s82 offen sc1 lds
    v_mfma_f32_16x16x32_bf16 v[160:163], a[144:147], v[156:159], v[160:163]
    s_mov_b32 m0, s59
    ds_read_b128 v[152:155], v6 offset:13312
    v_add_f32 v38, v38, v181
    v_mfma_f32_16x16x32_bf16 v[164:167], a[148:151], v[156:159], v[164:167]
    buffer_load_dwordx4 v57, s[8:11], s82 offen sc1 lds
    v_mfma_f32_16x16x32_bf16 v[168:171], a[152:155], v[156:159], v[168:171]
    s_add_u32 s64, s64, 20480
    v_fmac_f32 v39, v181, v181
    v_add_f32 v38, v38, v182
    v_mfma_f32_16x16x32_bf16 v[172:175], a[156:159], v[156:159], v[172:175]
    v_fmac_f32 v39, v182, v182
    v_add_f32 v38, v38, v183
    v_mfma_f32_16x16x32_bf16 v[160:163], a[160:163], v[140:143], v[160:163]
    s_sub_u32 s65, s64, s63
    ds_read_b128 v[156:159], v6 offset:14336
    v_fmac_f32 v39, v183, v183
    v_mfma_f32_16x16x32_bf16 v[164:167], a[164:167], v[140:143], v[164:167]
    s_cmp_eq_u32 s65, 61440
    v_add_f32 v38, v38, v184
    v_fmac_f32 v39, v184, v184
    v_mfma_f32_16x16x32_bf16 v[168:171], a[168:171], v[140:143], v[168:171]
    s_cselect_b32 s64, s63, s64
    v_add_f32 v38, v38, v185
    v_fmac_f32 v39, v185, v185
    v_mfma_f32_16x16x32_bf16 v[172:175], a[172:175], v[140:143], v[172:175]
    v_add_f32 v38, v38, v186
    v_fmac_f32 v39, v186, v186
    v_mfma_f32_16x16x32_bf16 v[160:163], a[176:179], v[144:147], v[160:163]
    s_add_u32 s65, s64, s66
    ds_read_b128 v[140:143], v6 offset:15360
    v_add_f32 v38, v38, v187
    v_mfma_f32_16x16x32_bf16 v[164:167], a[180:183], v[144:147], v[164:167]
    s_waitcnt vmcnt(7)
    v_sub_u32_e64 v22, 64, s80
    v_fmac_f32 v39, v187, v187
    v_mfma_f32_16x16x32_bf16 v[168:171], a[184:187], v[144:147], v[168:171]
    s_cmp_lt_u32 s80, 30
    buffer_store_dword v22, v21, s[4:7], s61 offen
    v_mfma_f32_16x16x32_bf16 v[172:175], a[188:191], v[144:147], v[172:175]
    s_waitcnt lgkmcnt(1)
    v_add_f32 v38, v38, v188
    v_fmac_f32 v39, v188, v188
    v_mfma_f32_16x16x32_bf16 v[160:163], a[192:195], v[148:151], v[160:163]
    s_cselect_b32 s26, 20480, 0
    ds_read2_b64 v[144:147], v8 offset0:0 offset1:16
    v_add_f32 v38, v38, v189
    v_mfma_f32_16x16x32_bf16 v[164:167], a[196:199], v[148:151], v[164:167]
    s_subb_u32 s78, s78, 0
    v_fmac_f32 v39, v189, v189
    v_add_f32 v38, v38, v190
    v_mfma_f32_16x16x32_bf16 v[168:171], a[200:203], v[148:151], v[168:171]
    s_lshl_b32 s26, s26, 1
    v_fmac_f32 v39, v190, v190
    v_add_f32 v38, v38, v191
    v_mfma_f32_16x16x32_bf16 v[172:175], a[204:207], v[148:151], v[172:175]
    v_fmac_f32 v39, v191, v191
    s_sub_u32 s82, s82, s26
    v_mfma_f32_16x16x32_bf16 v[160:163], a[208:211], v[152:155], v[160:163]
    s_cmp_eq_u32 s80, 14
    ds_read2_b64 v[148:151], v8 offset0:128 offset1:144
    s_cselect_b32 s82, s83, s82
    v_mfma_f32_16x16x32_bf16 v[164:167], a[212:215], v[152:155], v[164:167]
    s_cselect_b32 s8, s52, s8
    v_permlane32_swap_b32 v38, v39
    v_mfma_f32_16x16x32_bf16 v[168:171], a[216:219], v[152:155], v[168:171]
    s_cselect_b32 s9, s53, s9
    v_add_f32 v38, v38, v39
    v_mov_b32 v39, v38
    v_mfma_f32_16x16x32_bf16 v[172:175], a[220:223], v[152:155], v[172:175]
    s_add_u32 s26, s80, 2
    s_and_b32 s26, s26, 7
    v_mfma_f32_16x16x32_bf16 v[160:163], a[224:227], v[156:159], v[160:163]
    s_mul_i32 s26, s26, 20480
    ds_read2_b64 v[152:155], v9 offset0:0 offset1:16
    s_add_u32 s75, s88, s26
    v_mfma_f32_16x16x32_bf16 v[164:167], a[228:231], v[156:159], v[164:167]
    s_and_b32 s26, s80, 15
    v_permlane16_swap_b32 v38, v39
    v_mfma_f32_16x16x32_bf16 v[168:171], a[232:235], v[156:159], v[168:171]
    s_mul_i32 s25, s26, 20480
    v_add_f32 v40, v38, v39
    s_add_u32 s77, s25, s86
    v_mfma_f32_16x16x32_bf16 v[172:175], a[236:239], v[156:159], v[172:175]
    s_waitcnt lgkmcnt(1)
    buffer_store_dword v40, v68, s[4:7], s81 offen
    v_mfma_f32_16x16x32_bf16 v[160:163], a[240:243], v[140:143], v[160:163]
    s_lshl_b32 s25, s26, 11
    ds_read2_b64 v[156:159], v9 offset0:128 offset1:144
    v_lshlrev_b32 v70, 16, v60
    v_mfma_f32_16x16x32_bf16 v[164:167], a[244:247], v[140:143], v[164:167]
    s_add_u32 s81, s25, s87
    v_and_b32 v71, 0xffff0000, v60
    v_lshlrev_b32 v72, 16, v61
    v_mfma_f32_16x16x32_bf16 v[168:171], a[248:251], v[140:143], v[168:171]
    s_add_u32 s80, s80, 1
    v_and_b32 v73, 0xffff0000, v61
    v_lshlrev_b32 v74, 16, v62
    v_mfma_f32_16x16x32_bf16 v[172:175], a[252:255], v[140:143], v[172:175]
    v_and_b32 v75, 0xffff0000, v62
    v_lshlrev_b32 v76, 16, v63
    v_mfma_f32_16x16x32_bf16 v[160:163], v[192:195], v[144:147], v[160:163]
    v_and_b32 v77, 0xffff0000, v63
    v_lshlrev_b32 v78, 16, v64
    v_mfma_f32_16x16x32_bf16 v[164:167], v[196:199], v[144:147], v[164:167]
    v_and_b32 v79, 0xffff0000, v64
    v_lshlrev_b32 v80, 16, v65
    v_mfma_f32_16x16x32_bf16 v[168:171], v[200:203], v[144:147], v[168:171]
    v_and_b32 v81, 0xffff0000, v65
    v_lshlrev_b32 v82, 16, v66
    v_mfma_f32_16x16x32_bf16 v[172:175], v[204:207], v[144:147], v[172:175]
    v_and_b32 v83, 0xffff0000, v66
    v_lshlrev_b32 v84, 16, v67
    v_mfma_f32_16x16x32_bf16 v[160:163], v[208:211], v[148:151], v[160:163]
    v_and_b32 v85, 0xffff0000, v67
    v_mfma_f32_16x16x32_bf16 v[164:167], v[212:215], v[148:151], v[164:167]
    s_waitcnt vmcnt(4)
    s_barrier
    v_mfma_f32_16x16x32_bf16 v[168:171], v[216:219], v[148:151], v[168:171]
    ds_read_b128 v[140:143], v7 offset:0
    v_mfma_f32_16x16x32_bf16 v[172:175], v[220:223], v[148:151], v[172:175]
    s_waitcnt lgkmcnt(1)
    ds_read_b128 v[144:147], v7 offset:1024
    v_mfma_f32_16x16x32_bf16 v[160:163], v[224:227], v[152:155], v[160:163]
    ds_read_b128 v[148:151], v7 offset:2048
    v_mfma_f32_16x16x32_bf16 v[164:167], v[228:231], v[152:155], v[164:167]
    v_mfma_f32_16x16x32_bf16 v[168:171], v[232:235], v[152:155], v[168:171]
    v_mfma_f32_16x16x32_bf16 v[172:175], v[236:239], v[152:155], v[172:175]
    v_mfma_f32_16x16x32_bf16 v[160:163], v[240:243], v[156:159], v[160:163]
    ds_read_b128 v[152:155], v7 offset:3072
    v_mfma_f32_16x16x32_bf16 v[164:167], v[244:247], v[156:159], v[164:167]
    v_mfma_f32_16x16x32_bf16 v[168:171], v[248:251], v[156:159], v[168:171]
    v_mfma_f32_16x16x32_bf16 v[172:175], v[252:255], v[156:159], v[172:175]
    s_waitcnt lgkmcnt(3)
    v_mfma_f32_16x16x32_bf16 v[176:179], a[0:3], v[140:143], 0
    ds_read_b128 v[156:159], v7 offset:4096
    s_nop 0
    v_add_f32 v160, v160, v70
    v_mfma_f32_16x16x32_bf16 v[180:183], a[4:7], v[140:143], 0
    v_add_u32 v6, s64, v2
    v_add_u32 v8, s64, v12
    v_mfma_f32_16x16x32_bf16 v[184:187], a[8:11], v[140:143], 0
    v_add_u32 v9, 2048, v8
    v_add_f32 v161, v161, v71
    v_mfma_f32_16x16x32_bf16 v[188:191], a[12:15], v[140:143], 0
    s_waitcnt lgkmcnt(2)
    buffer_load_dwordx4 v[24:27], v20, s[4:7], s79 offen sc1
    v_mfma_f32_16x16x32_bf16 v[176:179], a[16:19], v[144:147], v[176:179]
    ds_read_b128 v[140:143], v7 offset:5120
    v_add_f32 v162, v162, v72
    v_mfma_f32_16x16x32_bf16 v[180:183], a[20:23], v[144:147], v[180:183]
    v_add_f32 v163, v163, v73
    v_add_f32 v164, v164, v74
    v_mfma_f32_16x16x32_bf16 v[184:187], a[24:27], v[144:147], v[184:187]
    v_add_f32 v165, v165, v75
    v_add_f32 v166, v166, v76
    v_mfma_f32_16x16x32_bf16 v[188:191], a[28:31], v[144:147], v[188:191]
    v_add_f32 v167, v167, v77
    v_cvt_pk_bf16_f32 v30, v160, v161
    v_mfma_f32_16x16x32_bf16 v[176:179], a[32:35], v[148:151], v[176:179]
    ds_read_b128 v[144:147], v7 offset:6144
    v_cvt_pk_bf16_f32 v31, v162, v163
    v_mfma_f32_16x16x32_bf16 v[180:183], a[36:39], v[148:151], v[180:183]
    v_cvt_pk_bf16_f32 v32, v164, v165
    v_cvt_pk_bf16_f32 v33, v166, v167
    v_mfma_f32_16x16x32_bf16 v[184:187], a[40:43], v[148:151], v[184:187]
    v_add_f32 v168, v168, v78
    v_add_f32 v169, v169, v79
    v_mfma_f32_16x16x32_bf16 v[188:191], a[44:47], v[148:151], v[188:191]
    s_waitcnt lgkmcnt(1)
    v_add_f32 v170, v170, v80
    v_add_f32 v171, v171, v81
    v_mfma_f32_16x16x32_bf16 v[176:179], a[48:51], v[152:155], v[176:179]
    ds_read_b128 v[148:151], v7 offset:7168
    v_add_f32 v172, v172, v82
    v_mfma_f32_16x16x32_bf16 v[180:183], a[52:55], v[152:155], v[180:183]
    v_add_f32 v173, v173, v83
    v_add_f32 v174, v174, v84
    v_mfma_f32_16x16x32_bf16 v[184:187], a[56:59], v[152:155], v[184:187]
    v_add_f32 v175, v175, v85
    v_cvt_pk_bf16_f32 v34, v168, v169
    v_mfma_f32_16x16x32_bf16 v[188:191], a[60:63], v[152:155], v[188:191]
    v_cvt_pk_bf16_f32 v35, v170, v171
    v_cvt_pk_bf16_f32 v36, v172, v173
    v_mfma_f32_16x16x32_bf16 v[176:179], a[64:67], v[156:159], v[176:179]
    ds_read_b128 v[152:155], v7 offset:8192
    s_waitcnt vmcnt(0)
    v_max3_u32 v28, v24, v25, v26
    v_mfma_f32_16x16x32_bf16 v[180:183], a[68:71], v[156:159], v[180:183]
    v_max3_u32 v28, v28, v27, s20
    v_cmp_lt_u32 vcc, s78, v28
    v_mfma_f32_16x16x32_bf16 v[184:187], a[72:75], v[156:159], v[184:187]
    v_cvt_pk_bf16_f32 v37, v174, v175
    v_mfma_f32_16x16x32_bf16 v[188:191], a[76:79], v[156:159], v[188:191]
    buffer_store_dwordx4 v[30:33], v2, s[4:7], s77 offen offset:0
    v_mfma_f32_16x16x32_bf16 v[176:179], a[80:83], v[140:143], v[176:179]
    ds_read_b128 v[156:159], v7 offset:9216
    v_mfma_f32_16x16x32_bf16 v[180:183], a[84:87], v[140:143], v[180:183]
    buffer_store_dwordx4 v[34:37], v2, s[4:7], s77 offen offset:1024
    v_mfma_f32_16x16x32_bf16 v[184:187], a[88:91], v[140:143], v[184:187]
    s_cbranch_vccnz slow_115
ret_116:
    s_add_u32 m0, s65, 0
    v_mfma_f32_16x16x32_bf16 v[188:191], a[92:95], v[140:143], v[188:191]
    s_waitcnt lgkmcnt(1)
    buffer_load_dwordx4 v2, s[4:7], s75 offen offset:0 sc1 lds
    v_mfma_f32_16x16x32_bf16 v[176:179], a[96:99], v[144:147], v[176:179]
    ds_read_b128 v[140:143], v7 offset:10240
    ds_read_b128 v[60:63], v58 offset:8192
    v_mfma_f32_16x16x32_bf16 v[180:183], a[100:103], v[144:147], v[180:183]
    buffer_load_dwordx4 v2, s[4:7], s75 offen offset:1024 sc1 lds
    v_mfma_f32_16x16x32_bf16 v[184:187], a[104:107], v[144:147], v[184:187]
    buffer_load_dwordx4 v2, s[4:7], s75 offen offset:2048 sc1 lds
    v_mfma_f32_16x16x32_bf16 v[188:191], a[108:111], v[144:147], v[188:191]
    ds_read_b128 v[64:67], v59 offset:8192
    v_add_f32 v38, v160, v161
    v_mfma_f32_16x16x32_bf16 v[176:179], a[112:115], v[148:151], v[176:179]
    ds_read_b128 v[144:147], v7 offset:11264
    v_mul_f32 v39, v160, v160
    v_mfma_f32_16x16x32_bf16 v[180:183], a[116:119], v[148:151], v[180:183]
    buffer_load_dwordx4 v2, s[4:7], s75 offen offset:3072 sc1 lds
    v_mfma_f32_16x16x32_bf16 v[184:187], a[120:123], v[148:151], v[184:187]
    s_add_u32 m0, s65, 4096
    v_fmac_f32 v39, v161, v161
    v_add_f32 v38, v38, v162
    v_mfma_f32_16x16x32_bf16 v[188:191], a[124:127], v[148:151], v[188:191]
    v_fmac_f32 v39, v162, v162
    v_add_f32 v38, v38, v163
    v_mfma_f32_16x16x32_bf16 v[176:179], a[128:131], v[152:155], v[176:179]
    ds_read_b128 v[148:151], v7 offset:12288
    v_fmac_f32 v39, v163, v163
    v_mfma_f32_16x16x32_bf16 v[180:183], a[132:135], v[152:155], v[180:183]
    buffer_load_dwordx4 v3, s[4:7], s75 offen offset:0 sc1 lds
    v_mfma_f32_16x16x32_bf16 v[184:187], a[136:139], v[152:155], v[184:187]
    s_mov_b32 m0, s56
    v_add_f32 v38, v38, v164
    v_fmac_f32 v39, v164, v164
    v_mfma_f32_16x16x32_bf16 v[188:191], a[140:143], v[152:155], v[188:191]
    s_waitcnt lgkmcnt(1)
    buffer_load_dwordx4 v56, s[8:11], s82 offen sc1 lds
    v_mfma_f32_16x16x32_bf16 v[176:179], a[144:147], v[156:159], v[176:179]
    s_mov_b32 m0, s57
    ds_read_b128 v[152:155], v7 offset:13312
    v_add_f32 v38, v38, v165
    v_mfma_f32_16x16x32_bf16 v[180:183], a[148:151], v[156:159], v[180:183]
    buffer_load_dwordx4 v57, s[8:11], s82 offen sc1 lds
    v_mfma_f32_16x16x32_bf16 v[184:187], a[152:155], v[156:159], v[184:187]
    s_add_u32 s64, s64, 20480
    v_fmac_f32 v39, v165, v165
    v_add_f32 v38, v38, v166
    v_mfma_f32_16x16x32_bf16 v[188:191], a[156:159], v[156:159], v[188:191]
    v_fmac_f32 v39, v166, v166
    v_add_f32 v38, v38, v167
    v_mfma_f32_16x16x32_bf16 v[176:179], a[160:163], v[140:143], v[176:179]
    s_sub_u32 s65, s64, s63
    ds_read_b128 v[156:159], v7 offset:14336
    v_fmac_f32 v39, v167, v167
    v_mfma_f32_16x16x32_bf16 v[180:183], a[164:167], v[140:143], v[180:183]
    s_cmp_eq_u32 s65, 61440
    v_add_f32 v38, v38, v168
    v_fmac_f32 v39, v168, v168
    v_mfma_f32_16x16x32_bf16 v[184:187], a[168:171], v[140:143], v[184:187]
    s_cselect_b32 s64, s63, s64
    v_add_f32 v38, v38, v169
    v_fmac_f32 v39, v169, v169
    v_mfma_f32_16x16x32_bf16 v[188:191], a[172:175], v[140:143], v[188:191]
    v_add_f32 v38, v38, v170
    v_fmac_f32 v39, v170, v170
    v_mfma_f32_16x16x32_bf16 v[176:179], a[176:179], v[144:147], v[176:179]
    s_add_u32 s65, s64, s66
    ds_read_b128 v[140:143], v7 offset:15360
    v_add_f32 v38, v38, v171
    v_mfma_f32_16x16x32_bf16 v[180:183], a[180:183], v[144:147], v[180:183]
    s_waitcnt vmcnt(7)
    v_sub_u32_e64 v22, 64, s80
    v_fmac_f32 v39, v171, v171
    v_mfma_f32_16x16x32_bf16 v[184:187], a[184:187], v[144:147], v[184:187]
    s_cmp_lt_u32 s80, 30
    buffer_store_dword v22, v21, s[4:7], s61 offen
    v_mfma_f32_16x16x32_bf16 v[188:191], a[188:191], v[144:147], v[188:191]
    s_waitcnt lgkmcnt(1)
    v_add_f32 v38, v38, v172
    v_fmac_f32 v39, v172, v172
    v_mfma_f32_16x16x32_bf16 v[176:179], a[192:195], v[148:151], v[176:179]
    s_cselect_b32 s26, 20480, 0
    ds_read2_b64 v[144:147], v10 offset0:0 offset1:16
    v_add_f32 v38, v38, v173
    v_mfma_f32_16x16x32_bf16 v[180:183], a[196:199], v[148:151], v[180:183]
    s_subb_u32 s78, s78, 0
    v_fmac_f32 v39, v173, v173
    v_add_f32 v38, v38, v174
    v_mfma_f32_16x16x32_bf16 v[184:187], a[200:203], v[148:151], v[184:187]
    s_lshl_b32 s26, s26, 1
    v_fmac_f32 v39, v174, v174
    v_add_f32 v38, v38, v175
    v_mfma_f32_16x16x32_bf16 v[188:191], a[204:207], v[148:151], v[188:191]
    v_fmac_f32 v39, v175, v175
    s_sub_u32 s82, s82, s26
    v_mfma_f32_16x16x32_bf16 v[176:179], a[208:211], v[152:155], v[176:179]
    s_cmp_eq_u32 s80, 14
    ds_read2_b64 v[148:151], v10 offset0:128 offset1:144
    s_cselect_b32 s82, s83, s82
    v_mfma_f32_16x16x32_bf16 v[180:183], a[212:215], v[152:155], v[180:183]
    s_cselect_b32 s8, s52, s8
    v_permlane32_swap_b32 v38, v39
    v_mfma_f32_16x16x32_bf16 v[184:187], a[216:219], v[152:155], v[184:187]
    s_cselect_b32 s9, s53, s9
    v_add_f32 v38, v38, v39
    v_mov_b32 v39, v38
    v_mfma_f32_16x16x32_bf16 v[188:191], a[220:223], v[152:155], v[188:191]
    s_add_u32 s26, s80, 2
    s_and_b32 s26, s26, 7
    v_mfma_f32_16x16x32_bf16 v[176:179], a[224:227], v[156:159], v[176:179]
    s_mul_i32 s26, s26, 20480
    ds_read2_b64 v[152:155], v11 offset0:0 offset1:16
    s_add_u32 s75, s88, s26
    v_mfma_f32_16x16x32_bf16 v[180:183], a[228:231], v[156:159], v[180:183]
    s_and_b32 s26, s80, 15
    v_permlane16_swap_b32 v38, v39
    v_mfma_f32_16x16x32_bf16 v[184:187], a[232:235], v[156:159], v[184:187]
    s_mul_i32 s25, s26, 20480
    v_add_f32 v40, v38, v39
    s_add_u32 s77, s25, s86
    v_mfma_f32_16x16x32_bf16 v[188:191], a[236:239], v[156:159], v[188:191]
    s_waitcnt lgkmcnt(1)
    buffer_store_dword v40, v68, s[4:7], s81 offen
    v_mfma_f32_16x16x32_bf16 v[176:179], a[240:243], v[140:143], v[176:179]
    s_lshl_b32 s25, s26, 11
    ds_read2_b64 v[156:159], v11 offset0:128 offset1:144
    v_lshlrev_b32 v70, 16, v60
    v_mfma_f32_16x16x32_bf16 v[180:183], a[244:247], v[140:143], v[180:183]
    s_add_u32 s81, s25, s87
    v_and_b32 v71, 0xffff0000, v60
    v_lshlrev_b32 v72, 16, v61
    v_mfma_f32_16x16x32_bf16 v[184:187], a[248:251], v[140:143], v[184:187]
    s_add_u32 s80, s80, 1
    v_and_b32 v73, 0xffff0000, v61
    v_lshlrev_b32 v74, 16, v62
    v_mfma_f32_16x16x32_bf16 v[188:191], a[252:255], v[140:143], v[188:191]
    v_and_b32 v75, 0xffff0000, v62
    v_lshlrev_b32 v76, 16, v63
    v_mfma_f32_16x16x32_bf16 v[176:179], v[192:195], v[144:147], v[176:179]
    s_cmp_lt_u32 s80, 32
    v_and_b32 v77, 0xffff0000, v63
    v_lshlrev_b32 v78, 16, v64
    v_mfma_f32_16x16x32_bf16 v[180:183], v[196:199], v[144:147], v[180:183]
    v_and_b32 v79, 0xffff0000, v64
    v_lshlrev_b32 v80, 16, v65
    v_mfma_f32_16x16x32_bf16 v[184:187], v[200:203], v[144:147], v[184:187]
    v_and_b32 v81, 0xffff0000, v65
    v_lshlrev_b32 v82, 16, v66
    v_mfma_f32_16x16x32_bf16 v[188:191], v[204:207], v[144:147], v[188:191]
    v_and_b32 v83, 0xffff0000, v66
    v_lshlrev_b32 v84, 16, v67
    v_mfma_f32_16x16x32_bf16 v[176:179], v[208:211], v[148:151], v[176:179]
    v_and_b32 v85, 0xffff0000, v67
    v_mfma_f32_16x16x32_bf16 v[180:183], v[212:215], v[148:151], v[180:183]
    s_waitcnt vmcnt(4)
    s_barrier
    v_mfma_f32_16x16x32_bf16 v[184:187], v[216:219], v[148:151], v[184:187]
    ds_read_b128 v[140:143], v6 offset:0
    v_mfma_f32_16x16x32_bf16 v[188:191], v[220:223], v[148:151], v[188:191]
    s_waitcnt lgkmcnt(1)
    ds_read_b128 v[144:147], v6 offset:1024
    v_mfma_f32_16x16x32_bf16 v[176:179], v[224:227], v[152:155], v[176:179]
    ds_read_b128 v[148:151], v6 offset:2048
    v_mfma_f32_16x16x32_bf16 v[180:183], v[228:231], v[152:155], v[180:183]
    v_mfma_f32_16x16x32_bf16 v[184:187], v[232:235], v[152:155], v[184:187]
    v_mfma_f32_16x16x32_bf16 v[188:191], v[236:239], v[152:155], v[188:191]
    v_mfma_f32_16x16x32_bf16 v[176:179], v[240:243], v[156:159], v[176:179]
    ds_read_b128 v[152:155], v6 offset:3072
    v_mfma_f32_16x16x32_bf16 v[180:183], v[244:247], v[156:159], v[180:183]
    v_mfma_f32_16x16x32_bf16 v[184:187], v[248:251], v[156:159], v[184:187]
    v_mfma_f32_16x16x32_bf16 v[188:191], v[252:255], v[156:159], v[188:191]
    s_cbranch_scc1 p2loop_105
gx_104:
F_p2:
    s_waitcnt lgkmcnt(0)
    s_nop 7
    v_add_f32 v176, v176, v70
    v_add_f32 v177, v177, v71
    v_add_f32 v178, v178, v72
    v_add_f32 v179, v179, v73
    v_add_f32 v180, v180, v74
    v_add_f32 v181, v181, v75
    v_add_f32 v182, v182, v76
    v_add_f32 v183, v183, v77
    v_cvt_pk_bf16_f32 v30, v176, v177
    v_cvt_pk_bf16_f32 v31, v178, v179
    v_cvt_pk_bf16_f32 v32, v180, v181
    v_cvt_pk_bf16_f32 v33, v182, v183
    v_add_f32 v184, v184, v78
    v_add_f32 v185, v185, v79
    v_add_f32 v186, v186, v80
    v_add_f32 v187, v187, v81
    v_add_f32 v188, v188, v82
    v_add_f32 v189, v189, v83
    v_add_f32 v190, v190, v84
    v_add_f32 v191, v191, v85
    v_cvt_pk_bf16_f32 v34, v184, v185
    v_cvt_pk_bf16_f32 v35, v186, v187
    v_cvt_pk_bf16_f32 v36, v188, v189
    v_cvt_pk_bf16_f32 v37, v190, v191
    buffer_store_dwordx4 v[30:33], v2, s[4:7], s77 offen offset:0
    buffer_store_dwordx4 v[34:37], v2, s[4:7], s77 offen offset:1024
    v_add_f32 v38, v176, v177
    v_mul_f32 v39, v176, v176
    v_fmac_f32 v39, v177, v177
    v_add_f32 v38, v38, v178
    v_fmac_f32 v39, v178, v178
    v_add_f32 v38, v38, v179
    v_fmac_f32 v39, v179, v179
    v_add_f32 v38, v38, v180
    v_fmac_f32 v39, v180, v180
    v_add_f32 v38, v38, v181
    v_fmac_f32 v39, v181, v181
    v_add_f32 v38, v38, v182
    v_fmac_f32 v39, v182, v182
    v_add_f32 v38, v38, v183
    v_fmac_f32 v39, v183, v183
    v_add_f32 v38, v38, v184
    v_fmac_f32 v39, v184, v184
    v_add_f32 v38, v38, v185
    v_fmac_f32 v39, v185, v185
    v_add_f32 v38, v38, v186
    s_waitcnt vmcnt(0)
    v_sub_u32_e64 v22, 64, s80
    s_bitcmp1_b32 s20, 0
    s_cbranch_scc1 pub_169
pubr_170:
    buffer_store_dword v22, v21, s[4:7], s61 offen
    v_fmac_f32 v39, v186, v186
    v_add_f32 v38, v38, v187
    v_fmac_f32 v39, v187, v187
    v_add_f32 v38, v38, v188
    v_fmac_f32 v39, v188, v188
    v_add_f32 v38, v38, v189
    v_fmac_f32 v39, v189, v189
    v_add_f32 v38, v38, v190
    v_fmac_f32 v39, v190, v190
    v_add_f32 v38, v38, v191
    v_fmac_f32 v39, v191, v191
    s_nop 1
    v_permlane32_swap_b32 v38, v39
    v_add_f32 v38, v38, v39
    v_mov_b32 v39, v38
    s_nop 1
    v_permlane16_swap_b32 v38, v39
    v_add_f32 v40, v38, v39
    buffer_store_dword v40, v68, s[4:7], s81 offen
    s_mov_b32 s80, 33
    s_waitcnt vmcnt(0)
    v_sub_u32_e64 v22, 64, s80
    s_bitcmp1_b32 s20, 0
    s_cbranch_scc1 pub_171
pubr_172:
    buffer_store_dword v22, v21, s[4:7], s61 offen
    s_cmp_lg_u32 s55, 0
    s_cbranch_scc1 Dp2
    s_cmp_lg_u32 s74, 0
    s_cbranch_scc1 clr_173
    v_mov_b32 v22, 0
    s_lshl_b32 s25, s24, 5
    buffer_store_dword v22, v21, s[16:19], s25 offen sc1
clr_173:
    s_endpgm
pair_103:
    s_add_u32 m0, s65, 0
    s_nop 0
    buffer_load_dwordx4 v2, s[4:7], s75 offen offset:0 sc1 lds
    buffer_load_dwordx4 v2, s[4:7], s75 offen offset:1024 sc1 lds
    buffer_load_dwordx4 v2, s[4:7], s75 offen offset:2048 sc1 lds
    buffer_load_dwordx4 v2, s[4:7], s75 offen offset:3072 sc1 lds
    s_add_u32 m0, s65, 4096
    s_nop 0
    buffer_load_dwordx4 v3, s[4:7], s75 offen offset:0 sc1 lds
    s_add_u32 m0, s65, 10240
    s_nop 0
    buffer_load_dwordx4 v4, s[4:7], s75 offen offset:0 sc1 lds
    buffer_load_dwordx4 v4, s[4:7], s75 offen offset:1024 sc1 lds
    buffer_load_dwordx4 v4, s[4:7], s75 offen offset:2048 sc1 lds
    buffer_load_dwordx4 v4, s[4:7], s75 offen offset:3072 sc1 lds
    s_add_u32 m0, s65, 14336
    s_nop 0
    buffer_load_dwordx4 v5, s[4:7], s75 offen offset:0 sc1 lds
    s_mov_b32 m0, s56
    s_nop 0
    buffer_load_dwordx4 v56, s[8:11], s82 offen sc1 lds
    s_mov_b32 m0, s57
    s_nop 0
    buffer_load_dwordx4 v57, s[8:11], s82 offen sc1 lds
    s_sub_u32 s82, s83, 40960
    s_mov_b32 s78, 62
    buffer_load_dwordx4 v[24:27], v20, s[4:7], s79 offen sc1
    s_add_u32 s75, s75, 20480
    s_add_u32 s64, s64, 20480
    s_sub_u32 s65, s64, s63
    s_cmp_eq_u32 s65, 61440
    s_cselect_b32 s64, s63, s64
    s_add_u32 s65, s64, s66
    s_add_u32 s73, s73, 1
    v_mov_b32 v15, s73
    s_waitcnt vmcnt(0)
    ds_write_b32 v13, v15
    s_mov_b32 s29, 0
sys_167:
    ds_read_b32 v16, v14
    s_waitcnt lgkmcnt(0)
    v_readfirstlane_b32 s67, v16
    s_nop 0
    s_cmp_lt_u32 s67, s73
    s_cbranch_scc0 syd_168
    s_add_u32 s29, s29, 1
    s_cmp_lt_u32 s29, 160000
    s_cbranch_scc1 sys_167
    s_mov_b32 s29, 25
    s_branch L_fail
syd_168:
    ds_read_b128 v[140:143], v6 offset:0
    ds_read_b128 v[144:147], v6 offset:1024
    ds_read_b128 v[148:151], v6 offset:2048
    ds_read_b128 v[152:155], v6 offset:3072
    s_waitcnt lgkmcnt(0)
p2mloop_126:
    s_waitcnt lgkmcnt(1)
    v_mfma_f32_16x16x32_bf16 v[160:163], a[0:3], v[140:143], 0
    s_add_u32 s73, s73, 1
    ds_read_b128 v[156:159], v6 offset:4096
    v_mov_b32 v15, s73
    v_mfma_f32_16x16x32_bf16 v[164:167], a[4:7], v[140:143], 0
    s_waitcnt vmcnt(4)
    v_max3_u32 v28, v24, v25, v26
    v_max3_u32 v28, v28, v27, s20
    v_mfma_f32_16x16x32_bf16 v[168:171], a[8:11], v[140:143], 0
    v_cmp_lt_u32 vcc, s78, v28
    v_add_f32 v176, v176, v70
    v_mfma_f32_16x16x32_bf16 v[172:175], a[12:15], v[140:143], 0
    v_add_f32 v177, v177, v71
    v_add_f32 v178, v178, v72
    v_mfma_f32_16x16x32_bf16 v[160:163], a[16:19], v[144:147], v[160:163]
    s_cmp_eq_u64 vcc, 0
    ds_read_b128 v[140:143], v6 offset:5120
    v_add_f32 v179, v179, v73
    v_mfma_f32_16x16x32_bf16 v[164:167], a[20:23], v[144:147], v[164:167]
    s_cselect_b32 s76, s75, 0x2000000
    buffer_load_dwordx4 v[24:27], v20, s[4:7], s79 offen sc1
    v_mfma_f32_16x16x32_bf16 v[168:171], a[24:27], v[144:147], v[168:171]
    s_add_u32 m0, s65, 0
    v_add_f32 v180, v180, v74
    v_add_f32 v181, v181, v75
    v_mfma_f32_16x16x32_bf16 v[172:175], a[28:31], v[144:147], v[172:175]
    buffer_load_dwordx4 v2, s[4:7], s76 offen offset:0 sc1 lds
    v_mfma_f32_16x16x32_bf16 v[160:163], a[32:35], v[148:151], v[160:163]
    s_waitcnt vmcnt(3)
    ds_read_b128 v[144:147], v6 offset:6144
    v_add_f32 v182, v182, v76
    v_mfma_f32_16x16x32_bf16 v[164:167], a[36:39], v[148:151], v[164:167]
    ds_write_b32 v13, v15
    v_mfma_f32_16x16x32_bf16 v[168:171], a[40:43], v[148:151], v[168:171]
    buffer_load_dwordx4 v2, s[4:7], s76 offen offset:1024 sc1 lds
    v_mfma_f32_16x16x32_bf16 v[172:175], a[44:47], v[148:151], v[172:175]
    s_waitcnt lgkmcnt(2)
    v_add_f32 v183, v183, v77
    v_cvt_pk_bf16_f32 v30, v176, v177
    v_mfma_f32_16x16x32_bf16 v[160:163], a[48:51], v[152:155], v[160:163]
    ds_read_b128 v[148:151], v6 offset:7168
    v_cvt_pk_bf16_f32 v31, v178, v179
    v_mfma_f32_16x16x32_bf16 v[164:167], a[52:55], v[152:155], v[164:167]
    buffer_load_dwordx4 v2, s[4:7], s76 offen offset:2048 sc1 lds
    v_mfma_f32_16x16x32_bf16 v[168:171], a[56:59], v[152:155], v[168:171]
    ds_read_b32 v16, v14
    v_cvt_pk_bf16_f32 v32, v180, v181
    v_mfma_f32_16x16x32_bf16 v[172:175], a[60:63], v[152:155], v[172:175]
    v_cvt_pk_bf16_f32 v33, v182, v183
    v_add_f32 v184, v184, v78
    v_mfma_f32_16x16x32_bf16 v[160:163], a[64:67], v[156:159], v[160:163]
    ds_read_b128 v[152:155], v6 offset:8192
    v_add_f32 v185, v185, v79
    v_mfma_f32_16x16x32_bf16 v[164:167], a[68:71], v[156:159], v[164:167]
    v_add_f32 v186, v186, v80
    v_add_f32 v187, v187, v81
    v_mfma_f32_16x16x32_bf16 v[168:171], a[72:75], v[156:159], v[168:171]
    buffer_load_dwordx4 v2, s[4:7], s76 offen offset:3072 sc1 lds
    v_mfma_f32_16x16x32_bf16 v[172:175], a[76:79], v[156:159], v[172:175]
    v_add_f32 v188, v188, v82
    v_add_f32 v189, v189, v83
    v_mfma_f32_16x16x32_bf16 v[160:163], a[80:83], v[140:143], v[160:163]
    s_add_u32 m0, s65, 4096
    ds_read_b128 v[156:159], v6 offset:9216
    s_waitcnt lgkmcnt(2)
    v_readfirstlane_b32 s67, v16
    v_mfma_f32_16x16x32_bf16 v[164:167], a[84:87], v[140:143], v[164:167]
    s_cmp_lt_u32 s67, s73
    v_add_f32 v190, v190, v84
    v_add_f32 v191, v191, v85
    v_mfma_f32_16x16x32_bf16 v[168:171], a[88:91], v[140:143], v[168:171]
    s_cbranch_scc1 syw_139
syr_140:
    v_add_u32 v7, s64, v2
    v_add_u32 v10, s64, v12
    v_mfma_f32_16x16x32_bf16 v[172:175], a[92:95], v[140:143], v[172:175]
    v_add_u32 v11, 2048, v10
    v_cvt_pk_bf16_f32 v34, v184, v185
    v_mfma_f32_16x16x32_bf16 v[160:163], a[96:99], v[144:147], v[160:163]
    s_add_u32 s73, s73, 1
    ds_read_b128 v[140:143], v6 offset:10240
    v_mov_b32 v15, s73
    v_mfma_f32_16x16x32_bf16 v[164:167], a[100:103], v[144:147], v[164:167]
    buffer_load_dwordx4 v3, s[4:7], s76 offen offset:0 sc1 lds
    v_mfma_f32_16x16x32_bf16 v[168:171], a[104:107], v[144:147], v[168:171]
    v_cvt_pk_bf16_f32 v35, v186, v187
    v_cvt_pk_bf16_f32 v36, v188, v189
    v_mfma_f32_16x16x32_bf16 v[172:175], a[108:111], v[144:147], v[172:175]
    v_cvt_pk_bf16_f32 v37, v190, v191
    v_mfma_f32_16x16x32_bf16 v[160:163], a[112:115], v[148:151], v[160:163]
    ds_read_b128 v[144:147], v6 offset:11264
    v_mfma_f32_16x16x32_bf16 v[164:167], a[116:119], v[148:151], v[164:167]
    buffer_store_dwordx4 v[30:33], v2, s[4:7], s77 offen offset:0
    v_mfma_f32_16x16x32_bf16 v[168:171], a[120:123], v[148:151], v[168:171]
    buffer_store_dwordx4 v[34:37], v2, s[4:7], s77 offen offset:1024
    v_mfma_f32_16x16x32_bf16 v[172:175], a[124:127], v[148:151], v[172:175]
    s_cbranch_vccnz late_127
later_128:
    s_mov_b32 m0, s58
    s_waitcnt lgkmcnt(1)
    v_mfma_f32_16x16x32_bf16 v[160:163], a[128:131], v[152:155], v[160:163]
    ds_read_b128 v[148:151], v6 offset:12288
    ds_read_b128 v[60:63], v58 offset:0
    v_mfma_f32_16x16x32_bf16 v[164:167], a[132:135], v[152:155], v[164:167]
    buffer_load_dwordx4 v56, s[8:11], s82 offen sc1 lds
    v_mfma_f32_16x16x32_bf16 v[168:171], a[136:139], v[152:155], v[168:171]
    s_mov_b32 m0, s59
    ds_read_b128 v[64:67], v59 offset:0
    v_add_f32 v38, v176, v177
    v_mfma_f32_16x16x32_bf16 v[172:175], a[140:143], v[152:155], v[172:175]
    buffer_load_dwordx4 v57, s[8:11], s82 offen sc1 lds
    v_mfma_f32_16x16x32_bf16 v[160:163], a[144:147], v[156:159], v[160:163]
    s_add_u32 m0, s65, 10240
    ds_read_b128 v[152:155], v6 offset:13312
    v_mul_f32 v39, v176, v176
    v_mfma_f32_16x16x32_bf16 v[164:167], a[148:151], v[156:159], v[164:167]
    s_cmp_lt_u32 s80, 30
    v_fmac_f32 v39, v177, v177
    v_add_f32 v38, v38, v178
    v_mfma_f32_16x16x32_bf16 v[168:171], a[152:155], v[156:159], v[168:171]
    s_cselect_b32 s26, 20480, 0
    v_fmac_f32 v39, v178, v178
    v_add_f32 v38, v38, v179
    v_mfma_f32_16x16x32_bf16 v[172:175], a[156:159], v[156:159], v[172:175]
    buffer_load_dwordx4 v4, s[4:7], s76 offen offset:0 sc1 lds
    v_mfma_f32_16x16x32_bf16 v[160:163], a[160:163], v[140:143], v[160:163]
    s_subb_u32 s78, s78, 0
    ds_read_b128 v[156:159], v6 offset:14336
    v_fmac_f32 v39, v179, v179
    v_mfma_f32_16x16x32_bf16 v[164:167], a[164:167], v[140:143], v[164:167]
    s_lshl_b32 s26, s26, 1
    v_add_f32 v38, v38, v180
    v_fmac_f32 v39, v180, v180
    v_mfma_f32_16x16x32_bf16 v[168:171], a[168:171], v[140:143], v[168:171]
    s_sub_u32 s82, s82, s26
    v_add_f32 v38, v38, v181
    v_fmac_f32 v39, v181, v181
    v_mfma_f32_16x16x32_bf16 v[172:175], a[172:175], v[140:143], v[172:175]
    s_waitcnt lgkmcnt(1)
    v_add_f32 v38, v38, v182
    v_fmac_f32 v39, v182, v182
    v_mfma_f32_16x16x32_bf16 v[160:163], a[176:179], v[144:147], v[160:163]
    s_cmp_eq_u32 s80, 14
    ds_read_b128 v[140:143], v6 offset:15360
    v_add_f32 v38, v38, v183
    v_mfma_f32_16x16x32_bf16 v[164:167], a[180:183], v[144:147], v[164:167]
    s_cselect_b32 s82, s83, s82
    buffer_load_dwordx4 v4, s[4:7], s76 offen offset:1024 sc1 lds
    v_mfma_f32_16x16x32_bf16 v[168:171], a[184:187], v[144:147], v[168:171]
    s_cselect_b32 s8, s52, s8
    v_fmac_f32 v39, v183, v183
    v_add_f32 v38, v38, v184
    v_mfma_f32_16x16x32_bf16 v[172:175], a[188:191], v[144:147], v[172:175]
    v_fmac_f32 v39, v184, v184
    v_add_f32 v38, v38, v185
    v_mfma_f32_16x16x32_bf16 v[160:163], a[192:195], v[148:151], v[160:163]
    s_cselect_b32 s9, s53, s9
    ds_read2_b64 v[144:147], v8 offset0:0 offset1:16
    v_fmac_f32 v39, v185, v185
    v_mfma_f32_16x16x32_bf16 v[164:167], a[196:199], v[148:151], v[164:167]
    s_cbranch_vccnz sw_137
swr_138:
    v_add_f32 v38, v38, v186
    v_fmac_f32 v39, v186, v186
    v_mfma_f32_16x16x32_bf16 v[168:171], a[200:203], v[148:151], v[168:171]
    s_waitcnt vmcnt(6)
    ds_write_b32 v13, v15
    v_mfma_f32_16x16x32_bf16 v[172:175], a[204:207], v[148:151], v[172:175]
    buffer_load_dwordx4 v4, s[4:7], s76 offen offset:2048 sc1 lds
    v_mfma_f32_16x16x32_bf16 v[160:163], a[208:211], v[152:155], v[160:163]
    s_add_u32 s26, s80, 2
    ds_read2_b64 v[148:151], v8 offset0:128 offset1:144
    v_add_f32 v38, v38, v187
    v_mfma_f32_16x16x32_bf16 v[164:167], a[212:215], v[152:155], v[164:167]
    s_and_b32 s26, s26, 7
    buffer_load_dwordx4 v[24:27], v20, s[4:7], s79 offen sc1
    v_mfma_f32_16x16x32_bf16 v[168:171], a[216:219], v[152:155], v[168:171]
    s_mul_i32 s26, s26, 20480
    v_fmac_f32 v39, v187, v187
    v_add_f32 v38, v38, v188
    v_mfma_f32_16x16x32_bf16 v[172:175], a[220:223], v[152:155], v[172:175]
    s_waitcnt lgkmcnt(2)
    v_fmac_f32 v39, v188, v188
    v_add_f32 v38, v38, v189
    v_mfma_f32_16x16x32_bf16 v[160:163], a[224:227], v[156:159], v[160:163]
    s_add_u32 s75, s88, s26
    ds_read2_b64 v[152:155], v9 offset0:0 offset1:16
    v_fmac_f32 v39, v189, v189
    v_mfma_f32_16x16x32_bf16 v[164:167], a[228:231], v[156:159], v[164:167]
    s_and_b32 s26, s80, 15
    buffer_load_dwordx4 v4, s[4:7], s76 offen offset:3072 sc1 lds
    v_mfma_f32_16x16x32_bf16 v[168:171], a[232:235], v[156:159], v[168:171]
    s_add_u32 m0, s65, 14336
    v_add_f32 v38, v38, v190
    v_fmac_f32 v39, v190, v190
    v_mfma_f32_16x16x32_bf16 v[172:175], a[236:239], v[156:159], v[172:175]
    v_add_f32 v38, v38, v191
    v_fmac_f32 v39, v191, v191
    v_mfma_f32_16x16x32_bf16 v[160:163], a[240:243], v[140:143], v[160:163]
    s_waitcnt vmcnt(7)
    ds_read2_b64 v[156:159], v9 offset0:128 offset1:144
    ds_read_b32 v16, v14
    v_mfma_f32_16x16x32_bf16 v[164:167], a[244:247], v[140:143], v[164:167]
    s_mul_i32 s25, s26, 20480
    v_sub_u32_e64 v22, 64, s80
    s_add_u32 s77, s25, s86
    v_mfma_f32_16x16x32_bf16 v[168:171], a[248:251], v[140:143], v[168:171]
    s_lshl_b32 s25, s26, 11
    buffer_store_dword v22, v21, s[4:7], s61 offen
    v_mfma_f32_16x16x32_bf16 v[172:175], a[252:255], v[140:143], v[172:175]
    buffer_load_dwordx4 v5, s[4:7], s76 offen offset:0 sc1 lds
    v_mfma_f32_16x16x32_bf16 v[160:163], v[192:195], v[144:147], v[160:163]
    s_add_u32 s64, s64, 20480
    v_permlane32_swap_b32 v38, v39
    v_mfma_f32_16x16x32_bf16 v[164:167], v[196:199], v[144:147], v[164:167]
    s_sub_u32 s65, s64, s63
    v_add_f32 v38, v38, v39
    v_mov_b32 v39, v38
    v_mfma_f32_16x16x32_bf16 v[168:171], v[200:203], v[144:147], v[168:171]
    s_cmp_eq_u32 s65, 61440
    s_waitcnt lgkmcnt(0)
    v_readfirstlane_b32 s67, v16
    s_cselect_b32 s64, s63, s64
    v_mfma_f32_16x16x32_bf16 v[172:175], v[204:207], v[144:147], v[172:175]
    v_permlane16_swap_b32 v38, v39
    v_mfma_f32_16x16x32_bf16 v[160:163], v[208:211], v[148:151], v[160:163]
    s_cmp_lt_u32 s67, s73
    v_add_f32 v40, v38, v39
    s_cbranch_scc1 syw_143
syr_144:
    v_mfma_f32_16x16x32_bf16 v[164:167], v[212:215], v[148:151], v[164:167]
    s_add_u32 s65, s64, s66
    buffer_store_dword v40, v68, s[4:7], s81 offen
    v_mfma_f32_16x16x32_bf16 v[168:171], v[216:219], v[148:151], v[168:171]
    s_add_u32 s81, s25, s87
    ds_read_b128 v[140:143], v7 offset:0
    v_lshlrev_b32 v70, 16, v60
    v_mfma_f32_16x16x32_bf16 v[172:175], v[220:223], v[148:151], v[172:175]
    ds_read_b128 v[144:147], v7 offset:1024
    v_and_b32 v71, 0xffff0000, v60
    v_mfma_f32_16x16x32_bf16 v[160:163], v[224:227], v[152:155], v[160:163]
    s_add_u32 s80, s80, 1
    ds_read_b128 v[148:151], v7 offset:2048
    v_lshlrev_b32 v72, 16, v61
    v_mfma_f32_16x16x32_bf16 v[164:167], v[228:231], v[152:155], v[164:167]
    v_and_b32 v73, 0xffff0000, v61
    v_lshlrev_b32 v74, 16, v62
    v_mfma_f32_16x16x32_bf16 v[168:171], v[232:235], v[152:155], v[168:171]
    v_and_b32 v75, 0xffff0000, v62
    v_lshlrev_b32 v76, 16, v63
    v_mfma_f32_16x16x32_bf16 v[172:175], v[236:239], v[152:155], v[172:175]
    v_and_b32 v77, 0xffff0000, v63
    v_lshlrev_b32 v78, 16, v64
    v_mfma_f32_16x16x32_bf16 v[160:163], v[240:243], v[156:159], v[160:163]
    ds_read_b128 v[152:155], v7 offset:3072
    v_and_b32 v79, 0xffff0000, v64
    v_mfma_f32_16x16x32_bf16 v[164:167], v[244:247], v[156:159], v[164:167]
    v_lshlrev_b32 v80, 16, v65
    v_and_b32 v81, 0xffff0000, v65
    v_mfma_f32_16x16x32_bf16 v[168:171], v[248:251], v[156:159], v[168:171]
    v_lshlrev_b32 v82, 16, v66
    v_and_b32 v83, 0xffff0000, v66
    v_mfma_f32_16x16x32_bf16 v[172:175], v[252:255], v[156:159], v[172:175]
    s_waitcnt lgkmcnt(1)
    v_lshlrev_b32 v84, 16, v67
    v_and_b32 v85, 0xffff0000, v67
    v_mfma_f32_16x16x32_bf16 v[176:179], a[0:3], v[140:143], 0
    s_add_u32 s73, s73, 1
    ds_read_b128 v[156:159], v7 offset:4096
    v_mov_b32 v15, s73
    v_mfma_f32_16x16x32_bf16 v[180:183], a[4:7], v[140:143], 0
    s_waitcnt vmcnt(4)
    v_max3_u32 v28, v24, v25, v26
    v_max3_u32 v28, v28, v27, s20
    v_mfma_f32_16x16x32_bf16 v[184:187], a[8:11], v[140:143], 0
    v_cmp_lt_u32 vcc, s78, v28
    v_add_f32 v160, v160, v70
    v_mfma_f32_16x16x32_bf16 v[188:191], a[12:15], v[140:143], 0
    v_add_f32 v161, v161, v71
    v_add_f32 v162, v162, v72
    v_mfma_f32_16x16x32_bf16 v[176:179], a[16:19], v[144:147], v[176:179]
    s_cmp_eq_u64 vcc, 0
    ds_read_b128 v[140:143], v7 offset:5120
    v_add_f32 v163, v163, v73
    v_mfma_f32_16x16x32_bf16 v[180:183], a[20:23], v[144:147], v[180:183]
    s_cselect_b32 s76, s75, 0x2000000
    buffer_load_dwordx4 v[24:27], v20, s[4:7], s79 offen sc1
    v_mfma_f32_16x16x32_bf16 v[184:187], a[24:27], v[144:147], v[184:187]
    s_add_u32 m0, s65, 0
    v_add_f32 v164, v164, v74
    v_add_f32 v165, v165, v75
    v_mfma_f32_16x16x32_bf16 v[188:191], a[28:31], v[144:147], v[188:191]
    buffer_load_dwordx4 v2, s[4:7], s76 offen offset:0 sc1 lds
    v_mfma_f32_16x16x32_bf16 v[176:179], a[32:35], v[148:151], v[176:179]
    s_waitcnt vmcnt(3)
    ds_read_b128 v[144:147], v7 offset:6144
    v_add_f32 v166, v166, v76
    v_mfma_f32_16x16x32_bf16 v[180:183], a[36:39], v[148:151], v[180:183]
    ds_write_b32 v13, v15
    v_mfma_f32_16x16x32_bf16 v[184:187], a[40:43], v[148:151], v[184:187]
    buffer_load_dwordx4 v2, s[4:7], s76 offen offset:1024 sc1 lds
    v_mfma_f32_16x16x32_bf16 v[188:191], a[44:47], v[148:151], v[188:191]
    s_waitcnt lgkmcnt(2)
    v_add_f32 v167, v167, v77
    v_cvt_pk_bf16_f32 v30, v160, v161
    v_mfma_f32_16x16x32_bf16 v[176:179], a[48:51], v[152:155], v[176:179]
    ds_read_b128 v[148:151], v7 offset:7168
    v_cvt_pk_bf16_f32 v31, v162, v163
    v_mfma_f32_16x16x32_bf16 v[180:183], a[52:55], v[152:155], v[180:183]
    buffer_load_dwordx4 v2, s[4:7], s76 offen offset:2048 sc1 lds
    v_mfma_f32_16x16x32_bf16 v[184:187], a[56:59], v[152:155], v[184:187]
    ds_read_b32 v16, v14
    v_cvt_pk_bf16_f32 v32, v164, v165
    v_mfma_f32_16x16x32_bf16 v[188:191], a[60:63], v[152:155], v[188:191]
    v_cvt_pk_bf16_f32 v33, v166, v167
    v_add_f32 v168, v168, v78
    v_mfma_f32_16x16x32_bf16 v[176:179], a[64:67], v[156:159], v[176:179]
    ds_read_b128 v[152:155], v7 offset:8192
    v_add_f32 v169, v169, v79
    v_mfma_f32_16x16x32_bf16 v[180:183], a[68:71], v[156:159], v[180:183]
    v_add_f32 v170, v170, v80
    v_add_f32 v171, v171, v81
    v_mfma_f32_16x16x32_bf16 v[184:187], a[72:75], v[156:159], v[184:187]
    buffer_load_dwordx4 v2, s[4:7], s76 offen offset:3072 sc1 lds
    v_mfma_f32_16x16x32_bf16 v[188:191], a[76:79], v[156:159], v[188:191]
    v_add_f32 v172, v172, v82
    v_add_f32 v173, v173, v83
    v_mfma_f32_16x16x32_bf16 v[176:179], a[80:83], v[140:143], v[176:179]
    s_add_u32 m0, s65, 4096
    ds_read_b128 v[156:159], v7 offset:9216
    s_waitcnt lgkmcnt(2)
    v_readfirstlane_b32 s67, v16
    v_mfma_f32_16x16x32_bf16 v[180:183], a[84:87], v[140:143], v[180:183]
    s_cmp_lt_u32 s67, s73
    v_add_f32 v174, v174, v84
    v_add_f32 v175, v175, v85
    v_mfma_f32_16x16x32_bf16 v[184:187], a[88:91], v[140:143], v[184:187]
    s_cbranch_scc1 syw_159
syr_160:
    v_add_u32 v6, s64, v2
    v_add_u32 v8, s64, v12
    v_mfma_f32_16x16x32_bf16 v[188:191], a[92:95], v[140:143], v[188:191]
    v_add_u32 v9, 2048, v8
    v_cvt_pk_bf16_f32 v34, v168, v169
    v_mfma_f32_16x16x32_bf16 v[176:179], a[96:99], v[144:147], v[176:179]
    s_add_u32 s73, s73, 1
    ds_read_b128 v[140:143], v7 offset:10240
    v_mov_b32 v15, s73
    v_mfma_f32_16x16x32_bf16 v[180:183], a[100:103], v[144:147], v[180:183]
    buffer_load_dwordx4 v3, s[4:7], s76 offen offset:0 sc1 lds
    v_mfma_f32_16x16x32_bf16 v[184:187], a[104:107], v[144:147], v[184:187]
    v_cvt_pk_bf16_f32 v35, v170, v171
    v_cvt_pk_bf16_f32 v36, v172, v173
    v_mfma_f32_16x16x32_bf16 v[188:191], a[108:111], v[144:147], v[188:191]
    v_cvt_pk_bf16_f32 v37, v174, v175
    v_mfma_f32_16x16x32_bf16 v[176:179], a[112:115], v[148:151], v[176:179]
    ds_read_b128 v[144:147], v7 offset:11264
    v_mfma_f32_16x16x32_bf16 v[180:183], a[116:119], v[148:151], v[180:183]
    buffer_store_dwordx4 v[30:33], v2, s[4:7], s77 offen offset:0
    v_mfma_f32_16x16x32_bf16 v[184:187], a[120:123], v[148:151], v[184:187]
    buffer_store_dwordx4 v[34:37], v2, s[4:7], s77 offen offset:1024
    v_mfma_f32_16x16x32_bf16 v[188:191], a[124:127], v[148:151], v[188:191]
    s_cbranch_vccnz late_147
later_148:
    s_mov_b32 m0, s56
    s_waitcnt lgkmcnt(1)
    v_mfma_f32_16x16x32_bf16 v[176:179], a[128:131], v[152:155], v[176:179]
    ds_read_b128 v[148:151], v7 offset:12288
    ds_read_b128 v[60:63], v58 offset:8192
    v_mfma_f32_16x16x32_bf16 v[180:183], a[132:135], v[152:155], v[180:183]
    buffer_load_dwordx4 v56, s[8:11], s82 offen sc1 lds
    v_mfma_f32_16x16x32_bf16 v[184:187], a[136:139], v[152:155], v[184:187]
    s_mov_b32 m0, s57
    ds_read_b128 v[64:67], v59 offset:8192
    v_add_f32 v38, v160, v161
    v_mfma_f32_16x16x32_bf16 v[188:191], a[140:143], v[152:155], v[188:191]
    buffer_load_dwordx4 v57, s[8:11], s82 offen sc1 lds
    v_mfma_f32_16x16x32_bf16 v[176:179], a[144:147], v[156:159], v[176:179]
    s_add_u32 m0, s65, 10240
    ds_read_b128 v[152:155], v7 offset:13312
    v_mul_f32 v39, v160, v160
    v_mfma_f32_16x16x32_bf16 v[180:183], a[148:151], v[156:159], v[180:183]
    s_cmp_lt_u32 s80, 30
    v_fmac_f32 v39, v161, v161
    v_add_f32 v38, v38, v162
    v_mfma_f32_16x16x32_bf16 v[184:187], a[152:155], v[156:159], v[184:187]
    s_cselect_b32 s26, 20480, 0
    v_fmac_f32 v39, v162, v162
    v_add_f32 v38, v38, v163
    v_mfma_f32_16x16x32_bf16 v[188:191], a[156:159], v[156:159], v[188:191]
    buffer_load_dwordx4 v4, s[4:7], s76 offen offset:0 sc1 lds
    v_mfma_f32_16x16x32_bf16 v[176:179], a[160:163], v[140:143], v[176:179]
    s_subb_u32 s78, s78, 0
    ds_read_b128 v[156:159], v7 offset:14336
    v_fmac_f32 v39, v163, v163
    v_mfma_f32_16x16x32_bf16 v[180:183], a[164:167], v[140:143], v[180:183]
    s_lshl_b32 s26, s26, 1
    v_add_f32 v38, v38, v164
    v_fmac_f32 v39, v164, v164
    v_mfma_f32_16x16x32_bf16 v[184:187], a[168:171], v[140:143], v[184:187]
    s_sub_u32 s82, s82, s26
    v_add_f32 v38, v38, v165
    v_fmac_f32 v39, v165, v165
    v_mfma_f32_16x16x32_bf16 v[188:191], a[172:175], v[140:143], v[188:191]
    s_waitcnt lgkmcnt(1)
    v_add_f32 v38, v38, v166
    v_fmac_f32 v39, v166, v166
    v_mfma_f32_16x16x32_bf16 v[176:179], a[176:179], v[144:147], v[176:179]
    s_cmp_eq_u32 s80, 14
    ds_read_b128 v[140:143], v7 offset:15360
    v_add_f32 v38, v38, v167
    v_mfma_f32_16x16x32_bf16 v[180:183], a[180:183], v[144:147], v[180:183]
    s_cselect_b32 s82, s83, s82
    buffer_load_dwordx4 v4, s[4:7], s76 offen offset:1024 sc1 lds
    v_mfma_f32_16x16x32_bf16 v[184:187], a[184:187], v[144:147], v[184:187]
    s_cselect_b32 s8, s52, s8
    v_fmac_f32 v39, v167, v167
    v_add_f32 v38, v38, v168
    v_mfma_f32_16x16x32_bf16 v[188:191], a[188:191], v[144:147], v[188:191]
    v_fmac_f32 v39, v168, v168
    v_add_f32 v38, v38, v169
    v_mfma_f32_16x16x32_bf16 v[176:179], a[192:195], v[148:151], v[176:179]
    s_cselect_b32 s9, s53, s9
    ds_read2_b64 v[144:147], v10 offset0:0 offset1:16
    v_fmac_f32 v39, v169, v169
    v_mfma_f32_16x16x32_bf16 v[180:183], a[196:199], v[148:151], v[180:183]
    s_cbranch_vccnz sw_157
swr_158:
    v_add_f32 v38, v38, v170
    v_fmac_f32 v39, v170, v170
    v_mfma_f32_16x16x32_bf16 v[184:187], a[200:203], v[148:151], v[184:187]
    s_waitcnt vmcnt(6)
    ds_write_b32 v13, v15
    v_mfma_f32_16x16x32_bf16 v[188:191], a[204:207], v[148:151], v[188:191]
    buffer_load_dwordx4 v4, s[4:7], s76 offen offset:2048 sc1 lds
    v_mfma_f32_16x16x32_bf16 v[176:179], a[208:211], v[152:155], v[176:179]
    s_add_u32 s26, s80, 2
    ds_read2_b64 v[148:151], v10 offset0:128 offset1:144
    v_add_f32 v38, v38, v171
    v_mfma_f32_16x16x32_bf16 v[180:183], a[212:215], v[152:155], v[180:183]
    s_and_b32 s26, s26, 7
    buffer_load_dwordx4 v[24:27], v20, s[4:7], s79 offen sc1
    v_mfma_f32_16x16x32_bf16 v[184:187], a[216:219], v[152:155], v[184:187]
    s_mul_i32 s26, s26, 20480
    v_fmac_f32 v39, v171, v171
    v_add_f32 v38, v38, v172
    v_mfma_f32_16x16x32_bf16 v[188:191], a[220:223], v[152:155], v[188:191]
    s_waitcnt lgkmcnt(2)
    v_fmac_f32 v39, v172, v172
    v_add_f32 v38, v38, v173
    v_mfma_f32_16x16x32_bf16 v[176:179], a[224:227], v[156:159], v[176:179]
    s_add_u32 s75, s88, s26
    ds_read2_b64 v[152:155], v11 offset0:0 offset1:16
    v_fmac_f32 v39, v173, v173
    v_mfma_f32_16x16x32_bf16 v[180:183], a[228:231], v[156:159], v[180:183]
    s_and_b32 s26, s80, 15
    buffer_load_dwordx4 v4, s[4:7], s76 offen offset:3072 sc1 lds
    v_mfma_f32_16x16x32_bf16 v[184:187], a[232:235], v[156:159], v[184:187]
    s_add_u32 m0, s65, 14336
    v_add_f32 v38, v38, v174
    v_fmac_f32 v39, v174, v174
    v_mfma_f32_16x16x32_bf16 v[188:191], a[236:239], v[156:159], v[188:191]
    v_add_f32 v38, v38, v175
    v_fmac_f32 v39, v175, v175
    v_mfma_f32_16x16x32_bf16 v[176:179], a[240:243], v[140:143], v[176:179]
    s_waitcnt vmcnt(7)
    ds_read2_b64 v[156:159], v11 offset0:128 offset1:144
    ds_read_b32 v16, v14
    v_mfma_f32_16x16x32_bf16 v[180:183], a[244:247], v[140:143], v[180:183]
    s_mul_i32 s25, s26, 20480
    v_sub_u32_e64 v22, 64, s80
    s_add_u32 s77, s25, s86
    v_mfma_f32_16x16x32_bf16 v[184:187], a[248:251], v[140:143], v[184:187]
    s_lshl_b32 s25, s26, 11
    buffer_store_dword v22, v21, s[4:7], s61 offen
    v_mfma_f32_16x16x32_bf16 v[188:191], a[252:255], v[140:143], v[188:191]
    buffer_load_dwordx4 v5, s[4:7], s76 offen offset:0 sc1 lds
    v_mfma_f32_16x16x32_bf16 v[176:179], v[192:195], v[144:147], v[176:179]
    s_add_u32 s64, s64, 20480
    v_permlane32_swap_b32 v38, v39
    v_mfma_f32_16x16x32_bf16 v[180:183], v[196:199], v[144:147], v[180:183]
    s_sub_u32 s65, s64, s63
    v_add_f32 v38, v38, v39
    v_mov_b32 v39, v38
    v_mfma_f32_16x16x32_bf16 v[184:187], v[200:203], v[144:147], v[184:187]
    s_cmp_eq_u32 s65, 61440
    s_waitcnt lgkmcnt(0)
    v_readfirstlane_b32 s67, v16
    s_cselect_b32 s64, s63, s64
    v_mfma_f32_16x16x32_bf16 v[188:191], v[204:207], v[144:147], v[188:191]
    v_permlane16_swap_b32 v38, v39
    v_mfma_f32_16x16x32_bf16 v[176:179], v[208:211], v[148:151], v[176:179]
    s_cmp_lt_u32 s67, s73
    v_add_f32 v40, v38, v39
    s_cbranch_scc1 syw_163
syr_164:
    v_mfma_f32_16x16x32_bf16 v[180:183], v[212:215], v[148:151], v[180:183]
    s_add_u32 s65, s64, s66
    buffer_store_dword v40, v68, s[4:7], s81 offen
    v_mfma_f32_16x16x32_bf16 v[184:187], v[216:219], v[148:151], v[184:187]
    s_add_u32 s81, s25, s87
    ds_read_b128 v[140:143], v6 offset:0
    v_lshlrev_b32 v70, 16, v60
    v_mfma_f32_16x16x32_bf16 v[188:191], v[220:223], v[148:151], v[188:191]
    ds_read_b128 v[144:147], v6 offset:1024
    v_and_b32 v71, 0xffff0000, v60
    v_mfma_f32_16x16x32_bf16 v[176:179], v[224:227], v[152:155], v[176:179]
    s_add_u32 s80, s80, 1
    ds_read_b128 v[148:151], v6 offset:2048
    v_lshlrev_b32 v72, 16, v61
    v_mfma_f32_16x16x32_bf16 v[180:183], v[228:231], v[152:155], v[180:183]
    s_cmp_lt_u32 s80, 32
    v_and_b32 v73, 0xffff0000, v61
    v_lshlrev_b32 v74, 16, v62
    v_mfma_f32_16x16x32_bf16 v[184:187], v[232:235], v[152:155], v[184:187]
    v_and_b32 v75, 0xffff0000, v62
    v_lshlrev_b32 v76, 16, v63
    v_mfma_f32_16x16x32_bf16 v[188:191], v[236:239], v[152:155], v[188:191]
    v_and_b32 v77, 0xffff0000, v63
    v_lshlrev_b32 v78, 16, v64
    v_mfma_f32_16x16x32_bf16 v[176:179], v[240:243], v[156:159], v[176:179]
    ds_read_b128 v[152:155], v6 offset:3072
    v_and_b32 v79, 0xffff0000, v64
    v_mfma_f32_16x16x32_bf16 v[180:183], v[244:247], v[156:159], v[180:183]
    v_lshlrev_b32 v80, 16, v65
    v_and_b32 v81, 0xffff0000, v65
    v_mfma_f32_16x16x32_bf16 v[184:187], v[248:251], v[156:159], v[184:187]
    v_lshlrev_b32 v82, 16, v66
    v_and_b32 v83, 0xffff0000, v66
    v_mfma_f32_16x16x32_bf16 v[188:191], v[252:255], v[156:159], v[188:191]
    v_lshlrev_b32 v84, 16, v67
    v_and_b32 v85, 0xffff0000, v67
    s_cbranch_scc1 p2mloop_126
    s_branch gx_104
pub_108:
    s_nop 1
    s_waitcnt vmcnt(0)
    buffer_wbl2 sc1
    s_waitcnt vmcnt(0)
    buffer_store_dword v22, v21, s[4:7], s60 offen sc1
    s_branch pubr_109
slow_106:
    s_cselect_b32 s28, 1, 0
    s_waitcnt vmcnt(0)
    v_sub_u32_e64 v22, 64, s80
    s_bitcmp1_b32 s20, 0
    s_cbranch_scc1 pub_108
pubr_109:
    buffer_store_dword v22, v21, s[4:7], s61 offen
    s_mov_b32 s29, 0
spin_110:
    buffer_load_dwordx4 v[24:27], v20, s[4:7], s79 offen sc1
    s_waitcnt vmcnt(0)
    v_max3_u32 v28, v24, v25, v26
    v_max_u32 v28, v28, v27
    v_cmp_lt_u32 vcc, s78, v28
    s_nop 1
    s_cbranch_vccz spind_111
    s_sleep 3
    s_add_u32 s29, s29, 1
    s_cmp_lt_u32 s29, 20000
    s_cbranch_scc1 spin_110
    s_mov_b32 s29, 22
    s_branch L_fail
spind_111:
    s_bitcmp1_b32 s20, 0
    s_cbranch_scc0 acq_112
    buffer_inv sc1
    s_waitcnt vmcnt(0)
acq_112:
    s_cmp_lg_u32 s28, 0
    s_branch ret_107
pub_117:
    s_nop 1
    s_waitcnt vmcnt(0)
    buffer_wbl2 sc1
    s_waitcnt vmcnt(0)
    buffer_store_dword v22, v21, s[4:7], s60 offen sc1
    s_branch pubr_118
slow_115:
    s_cselect_b32 s28, 1, 0
    s_waitcnt vmcnt(0)
    v_sub_u32_e64 v22, 64, s80
    s_bitcmp1_b32 s20, 0
    s_cbranch_scc1 pub_117
pubr_118:
    buffer_store_dword v22, v21, s[4:7], s61 offen
    s_mov_b32 s29, 0
spin_119:
    buffer_load_dwordx4 v[24:27], v20, s[4:7], s79 offen sc1
    s_waitcnt vmcnt(0)
    v_max3_u32 v28, v24, v25, v26
    v_max_u32 v28, v28, v27
    v_cmp_lt_u32 vcc, s78, v28
    s_nop 1
    s_cbranch_vccz spind_120
    s_sleep 3
    s_add_u32 s29, s29, 1
    s_cmp_lt_u32 s29, 20000
    s_cbranch_scc1 spin_119
    s_mov_b32 s29, 22
    s_branch L_fail
spind_120:
    s_bitcmp1_b32 s20, 0
    s_cbranch_scc0 acq_121
    buffer_inv sc1
    s_waitcnt vmcnt(0)
acq_121:
    s_cmp_lg_u32 s28, 0
    s_branch ret_116
pub_130:
    s_nop 1
    s_waitcnt vmcnt(0)
    buffer_wbl2 sc1
    s_waitcnt vmcnt(0)
    buffer_store_dword v22, v21, s[4:7], s60 offen sc1
    s_branch pubr_131
late_127:
    s_nop 3
    s_cselect_b32 s28, 1, 0
    s_waitcnt vmcnt(7)
    v_max3_u32 v28, v24, v25, v26
    v_max3_u32 v28, v28, v27, s20
    v_cmp_lt_u32 vcc, s78, v28
    s_nop 1
    s_cbranch_vccz lgo_129
    s_waitcnt vmcnt(0)
    v_sub_u32_e64 v22, 64, s80
    s_bitcmp1_b32 s20, 0
    s_cbranch_scc1 pub_130
pubr_131:
    buffer_store_dword v22, v21, s[4:7], s61 offen
    s_mov_b32 s70, s80
    s_mov_b32 s29, 0
spin_132:
    buffer_load_dwordx4 v[24:27], v20, s[4:7], s79 offen sc1
    s_waitcnt vmcnt(0)
    v_max3_u32 v28, v24, v25, v26
    v_max_u32 v28, v28, v27
    v_cmp_lt_u32 vcc, s78, v28
    s_nop 1
    s_cbranch_vccz spind_133
    s_sleep 3
    s_add_u32 s29, s29, 1
    s_cmp_lt_u32 s29, 20000
    s_cbranch_scc1 spin_132
    s_mov_b32 s29, 22
    s_branch L_fail
spind_133:
lgo_129:
    s_bitcmp1_b32 s20, 0
    s_cbranch_scc0 acq_134
    buffer_inv sc1
    s_waitcnt vmcnt(0)
acq_134:
    s_mov_b32 s76, s75
    s_add_u32 m0, s65, 0
    s_nop 0
    buffer_load_dwordx4 v2, s[4:7], s76 offen offset:0 sc1 lds
    buffer_load_dwordx4 v2, s[4:7], s76 offen offset:1024 sc1 lds
    buffer_load_dwordx4 v2, s[4:7], s76 offen offset:2048 sc1 lds
    buffer_load_dwordx4 v2, s[4:7], s76 offen offset:3072 sc1 lds
    s_add_u32 m0, s65, 4096
    s_nop 0
    buffer_load_dwordx4 v3, s[4:7], s76 offen offset:0 sc1 lds
    v_cmp_eq_u32 vcc, v1, v1
    s_cmp_lg_u32 s28, 0
    s_branch later_128
sw_137:
    s_waitcnt vmcnt(4)
    s_branch swr_138
syw_139:
    s_mov_b32 s29, 0
sys_141:
    ds_read_b32 v16, v14
    s_waitcnt lgkmcnt(0)
    v_readfirstlane_b32 s67, v16
    s_nop 0
    s_cmp_lt_u32 s67, s73
    s_cbranch_scc0 syd_142
    s_add_u32 s29, s29, 1
    s_cmp_lt_u32 s29, 160000
    s_cbranch_scc1 sys_141
    s_mov_b32 s29, 25
    s_branch L_fail
syd_142:
    s_branch syr_140
syw_143:
    s_mov_b32 s29, 0
sys_145:
    ds_read_b32 v16, v14
    s_waitcnt lgkmcnt(0)
    v_readfirstlane_b32 s67, v16
    s_nop 0
    s_cmp_lt_u32 s67, s73
    s_cbranch_scc0 syd_146
    s_add_u32 s29, s29, 1
    s_cmp_lt_u32 s29, 160000
    s_cbranch_scc1 sys_145
    s_mov_b32 s29, 25
    s_branch L_fail
syd_146:
    s_branch syr_144
pub_150:
    s_nop 1
    s_waitcnt vmcnt(0)
    buffer_wbl2 sc1
    s_waitcnt vmcnt(0)
    buffer_store_dword v22, v21, s[4:7], s60 offen sc1
    s_branch pubr_151
late_147:
    s_nop 3
    s_cselect_b32 s28, 1, 0
    s_waitcnt vmcnt(7)
    v_max3_u32 v28, v24, v25, v26
    v_max3_u32 v28, v28, v27, s20
    v_cmp_lt_u32 vcc, s78, v28
    s_nop 1
    s_cbranch_vccz lgo_149
    s_waitcnt vmcnt(0)
    v_sub_u32_e64 v22, 64, s80
    s_bitcmp1_b32 s20, 0
    s_cbranch_scc1 pub_150
pubr_151:
    buffer_store_dword v22, v21, s[4:7], s61 offen
    s_mov_b32 s70, s80
    s_mov_b32 s29, 0
spin_152:
    buffer_load_dwordx4 v[24:27], v20, s[4:7], s79 offen sc1
    s_waitcnt vmcnt(0)
    v_max3_u32 v28, v24, v25, v26
    v_max_u32 v28, v28, v27
    v_cmp_lt_u32 vcc, s78, v28
    s_nop 1
    s_cbranch_vccz spind_153
    s_sleep 3
    s_add_u32 s29, s29, 1
    s_cmp_lt_u32 s29, 20000
    s_cbranch_scc1 spin_152
    s_mov_b32 s29, 22
    s_branch L_fail
spind_153:
lgo_149:
    s_bitcmp1_b32 s20, 0
    s_cbranch_scc0 acq_154
    buffer_inv sc1
    s_waitcnt vmcnt(0)
acq_154:
    s_mov_b32 s76, s75
    s_add_u32 m0, s65, 0
    s_nop 0
    buffer_load_dwordx4 v2, s[4:7], s76 offen offset:0 sc1 lds
    buffer_load_dwordx4 v2, s[4:7], s76 offen offset:1024 sc1 lds
    buffer_load_dwordx4 v2, s[4:7], s76 offen offset:2048 sc1 lds
    buffer_load_dwordx4 v2, s[4:7], s76 offen offset:3072 sc1 lds
    s_add_u32 m0, s65, 4096
    s_nop 0
    buffer_load_dwordx4 v3, s[4:7], s76 offen offset:0 sc1 lds
    v_cmp_eq_u32 vcc, v1, v1
    s_cmp_lg_u32 s28, 0
    s_branch later_148
sw_157:
    s_waitcnt vmcnt(4)
    s_branch swr_158
syw_159:
    s_mov_b32 s29, 0
sys_161:
    ds_read_b32 v16, v14
    s_waitcnt lgkmcnt(0)
    v_readfirstlane_b32 s67, v16
    s_nop 0
    s_cmp_lt_u32 s67, s73
    s_cbranch_scc0 syd_162
    s_add_u32 s29, s29, 1
    s_cmp_lt_u32 s29, 160000
    s_cbranch_scc1 sys_161
    s_mov_b32 s29, 25
    s_branch L_fail
syd_162:
    s_branch syr_160
syw_163:
    s_mov_b32 s29, 0
sys_165:
    ds_read_b32 v16, v14
    s_waitcnt lgkmcnt(0)
    v_readfirstlane_b32 s67, v16
    s_nop 0
    s_cmp_lt_u32 s67, s73
    s_cbranch_scc0 syd_166
    s_add_u32 s29, s29, 1
    s_cmp_lt_u32 s29, 160000
    s_cbranch_scc1 sys_165
    s_mov_b32 s29, 25
    s_branch L_fail
syd_166:
    s_branch syr_164
pub_169:
    s_nop 1
    s_waitcnt vmcnt(0)
    buffer_wbl2 sc1
    s_waitcnt vmcnt(0)
    buffer_store_dword v22, v21, s[4:7], s60 offen sc1
    s_branch pubr_170
pub_171:
    s_nop 1
    s_waitcnt vmcnt(0)
    buffer_wbl2 sc1
    s_waitcnt vmcnt(0)
    buffer_store_dword v22, v21, s[4:7], s60 offen sc1
    s_branch pubr_172
E_p2:
    s_endpgm
L_p3:
    s_sub_u32 s25, s25, 10
    s_mov_b32 s74, s25
    s_and_b32 s62, s23, 1
    s_mov_b32 s12, s40
    s_mov_b32 s13, s41
    s_mov_b32 s14, 0x21c000
    s_mov_b32 s15, 0x20000
    s_mov_b32 s8, s42
    s_mov_b32 s9, s43
    s_mov_b32 s10, 0x21c000
    s_mov_b32 s11, 0x20000
    v_lshrrev_b32 v44, 3, v1
    v_bfe_u32 v45, v1, 4, 1
    v_lshlrev_b32 v45, 2, v45
    v_xor_b32 v45, v1, v45
    v_and_b32 v45, 7, v45
    v_lshlrev_b32 v45, 4, v45
    v_mul_u32_u24 v46, 3456, v44
    v_add_u32 v46, v46, v45
    s_lshr_b32 s28, s74, 1
    s_mul_i32 s25, s62, 55296
    s_lshl_b32 s26, s28, 7
    s_add_u32 s25, s25, s26
    v_add_u32 v48, s25, v46
    s_lshr_b32 s28, s23, 1
    s_lshl_b32 s28, s28, 13
    s_add_u32 s28, s28, 65536
    s_lshl_b32 s27, s62, 11
    s_add_u32 s27, s27, s28
    s_cmp_lg_u32 s23, 0
    s_cbranch_scc1 an1_174
    v_mov_b32 v25, s24
    v_lshlrev_b32 v25, 5, v25
    s_mov_b64 exec, 3
    buffer_load_dword v24, v25, s[16:19], 0 offen sc1
    s_mov_b64 exec, -1
an1_174:
    s_mov_b32 s25, 0
    s_add_u32 m0, s27, 0
    s_nop 0
    buffer_load_dwordx4 v48, s[12:15], s25 offen offset:0 lds
    s_add_u32 m0, s27, 4096
    s_nop 0
    buffer_load_dwordx4 v48, s[8:11], s25 offen offset:0 lds
    s_mov_b32 s25, 27648
    s_add_u32 m0, s27, 1024
    s_nop 0
    buffer_load_dwordx4 v48, s[12:15], s25 offen offset:0 lds
    s_add_u32 m0, s27, 5120
    s_nop 0
    buffer_load_dwordx4 v48, s[8:11], s25 offen offset:0 lds
    s_mov_b32 s25, 110592
    s_add_u32 m0, s27, 16384
    s_nop 0
    buffer_load_dwordx4 v48, s[12:15], s25 offen offset:0 lds
    s_add_u32 m0, s27, 20480
    s_nop 0
    buffer_load_dwordx4 v48, s[8:11], s25 offen offset:0 lds
    s_mov_b32 s25, 138240
    s_add_u32 m0, s27, 17408
    s_nop 0
    buffer_load_dwordx4 v48, s[12:15], s25 offen offset:0 lds
    s_add_u32 m0, s27, 21504
    s_nop 0
    buffer_load_dwordx4 v48, s[8:11], s25 offen offset:0 lds
    v_lshrrev_b32 v44, 4, v1
    v_bfe_u32 v45, v1, 2, 2
    v_and_b32 v46, 3, v1
    v_bfe_u32 v47, v1, 3, 1
    v_lshlrev_b32 v44, 10, v44
    v_lshl_add_u32 v44, v45, 7, v44
    v_lshl_add_u32 v44, v46, 4, v44
    v_lshl_add_u32 v44, v47, 6, v44
    s_lshl_b32 s25, s62, 6
    v_xor_b32 v44, s25, v44
    v_add_u32 v50, s28, v44
    v_mov_b32 v52, 0x3f803f80
    v_mov_b32 v53, 0x3f803f80
    v_mov_b32 v54, 0x3f803f80
    v_mov_b32 v55, 0x3f803f80
    v_lshlrev_b32 v2, 4, v1
    v_add_u32 v3, 4096, v2
    v_mov_b32 v21, 0x80000000
    s_mov_b32 exec_lo, 0x1
    s_mov_b32 exec_hi, 0x0
    v_mov_b32 v21, 0x0
    s_mov_b64 exec, -1
    v_add_u32 v4, 10240, v2
    v_add_u32 v5, 14336, v2
    s_mul_i32 s26, s23, 5120
    s_mul_i32 s25, s62, 5120
    s_cmp_eq_u32 s22, 18
    s_cselect_b32 s26, s25, s26
    s_cselect_b32 s63, 61440, 0
    s_mov_b32 s66, s26
    s_lshl_b32 s25, s23, 2
    s_add_u32 s25, s25, 139264
    v_mov_b32 v13, s25
    s_xor_b32 s25, s25, 4
    s_cmp_eq_u32 s22, 18
    s_cselect_b32 s25, s25, 139264
    v_mov_b32 v14, s25
    v_mov_b32 v15, 0
    ds_write_b32 v13, v15
    s_mov_b32 s73, 0
    s_mul_i32 s25, s24, 1572864
    s_add_u32 s75, s25, s26
    s_add_u32 s75, s75, 0x130000
    s_mov_b32 s88, s75
    s_add_u32 s87, s25, 0x128000
    v_lshlrev_b32 v20, 7, v1
    v_mov_b32 v44, 0x80000000
    s_mov_b32 exec_lo, 0x7ff
    s_mov_b32 exec_hi, 0x0
    v_mov_b32 v44, 0x0
    s_mov_b64 exec, -1
    v_or_b32 v20, v20, v44
    v_mov_b32 v23, 0x0
    s_mov_b32 exec_lo, 0xff
    s_mov_b32 exec_hi, 0x0
    v_mov_b32 v23, 0x5
    s_mov_b64 exec, -1
    s_add_u32 s79, s54, 1024
    s_lshl_b32 s26, s74, 10
    s_add_u32 s25, s25, s26
    s_add_u32 s86, s25, 0x180000
    v_lshlrev_b32 v44, 3, v1
    v_lshrrev_b32 v45, 5, v1
    v_lshl_add_u32 v74, v45, 31, v44
    s_mov_b32 s84, 0x3acccccd
    s_mov_b32 s85, 0x3727c5ac
    s_mov_b32 s77, 0
    s_mov_b32 s81, 0
    s_mov_b32 s80, 0
    s_waitcnt vmcnt(4)
    s_barrier
    ds_read_b64_tr_b16 a[0:1], v50 offset:0
    ds_read_b64_tr_b16 a[2:3], v50 offset:512
    ds_read_b64_tr_b16 a[4:5], v50 offset:8
    ds_read_b64_tr_b16 a[6:7], v50 offset:520
    ds_read_b64_tr_b16 a[8:9], v50 offset:4096
    ds_read_b64_tr_b16 a[10:11], v50 offset:4608
    ds_read_b64_tr_b16 a[12:13], v50 offset:4104
    ds_read_b64_tr_b16 a[14:15], v50 offset:4616
    s_cmp_lg_u32 s23, 0
    s_cbranch_scc1 an2_175
    s_mov_b32 s29, 0
    s_branch gse_178
gs_176:
    v_mov_b32 v25, s24
    v_lshlrev_b32 v25, 5, v25
    s_mov_b64 exec, 3
    buffer_load_dword v24, v25, s[16:19], 0 offen sc1
    s_mov_b64 exec, -1
    s_waitcnt vmcnt(0)
gse_178:
    s_mov_b64 exec, 3
    v_cmp_eq_u32 vcc, 0, v24
    s_mov_b64 exec, -1
    s_nop 1
    s_cbranch_vccz gsd_177
    s_sleep 2
    s_add_u32 s29, s29, 1
    s_cmp_lt_u32 s29, 20000
    s_cbranch_scc1 gs_176
    s_mov_b32 s29, 99
    s_branch L_fail
gsd_177:
    s_cmp_lg_u32 s23, 0
    s_cbranch_scc1 ann_179
    s_getreg_b32 s25, hwreg(HW_REG_XCC_ID, 0, 4)
    s_add_u32 s25, s25, 1
    v_mov_b32 v24, s25
    v_lshlrev_b32 v25, 26, v1
    s_lshr_b32 s26, s2, 3
    s_lshl_b32 s26, s26, 7
    s_add_u32 s26, s26, s21
    s_add_u32 s26, s26, 0x8000
    buffer_store_dword v24, v25, s[4:7], s26 offen sc1
ann_179:
an2_175:
    s_mov_b32 s25, 221184
    s_add_u32 m0, s27, 32768
    s_nop 0
    buffer_load_dwordx4 v48, s[12:15], s25 offen offset:0 lds
    s_add_u32 m0, s27, 36864
    s_nop 0
    buffer_load_dwordx4 v48, s[8:11], s25 offen offset:0 lds
    s_mov_b32 s25, 248832
    s_add_u32 m0, s27, 33792
    s_nop 0
    buffer_load_dwordx4 v48, s[12:15], s25 offen offset:0 lds
    s_add_u32 m0, s27, 37888
    s_nop 0
    buffer_load_dwordx4 v48, s[8:11], s25 offen offset:0 lds
    s_waitcnt lgkmcnt(6)
    v_mfma_f32_16x16x32_bf16 v[56:59], a[0:3], v[52:55], 0
    s_waitcnt lgkmcnt(4)
    v_mfma_f32_16x16x32_bf16 v[60:63], a[4:7], v[52:55], 0
    s_waitcnt lgkmcnt(2)
    v_mfma_f32_16x16x32_bf16 v[64:67], a[8:11], v[52:55], 0
    s_waitcnt lgkmcnt(0)
    v_mfma_f32_16x16x32_bf16 v[68:71], a[12:15], v[52:55], 0
    s_waitcnt vmcnt(4)
    s_barrier
    ds_read_b64_tr_b16 a[16:17], v50 offset:16384
    ds_read_b64_tr_b16 a[18:19], v50 offset:16896
    ds_read_b64_tr_b16 a[20:21], v50 offset:16392
    ds_read_b64_tr_b16 a[22:23], v50 offset:16904
    ds_read_b64_tr_b16 a[24:25], v50 offset:20480
    ds_read_b64_tr_b16 a[26:27], v50 offset:20992
    ds_read_b64_tr_b16 a[28:29], v50 offset:20488
    ds_read_b64_tr_b16 a[30:31], v50 offset:21000
    s_mov_b32 s25, 331776
    s_add_u32 m0, s27, 49152
    s_nop 0
    buffer_load_dwordx4 v48, s[12:15], s25 offen offset:0 lds
    s_add_u32 m0, s27, 53248
    s_nop 0
    buffer_load_dwordx4 v48, s[8:11], s25 offen offset:0 lds
    s_mov_b32 s25, 359424
    s_add_u32 m0, s27, 50176
    s_nop 0
    buffer_load_dwordx4 v48, s[12:15], s25 offen offset:0 lds
    s_add_u32 m0, s27, 54272
    s_nop 0
    buffer_load_dwordx4 v48, s[8:11], s25 offen offset:0 lds
    s_waitcnt lgkmcnt(6)
    v_mfma_f32_16x16x32_bf16 v[56:59], a[16:19], v[52:55], v[56:59]
    s_waitcnt lgkmcnt(4)
    v_mfma_f32_16x16x32_bf16 v[60:63], a[20:23], v[52:55], v[60:63]
    s_waitcnt lgkmcnt(2)
    v_mfma_f32_16x16x32_bf16 v[64:67], a[24:27], v[52:55], v[64:67]
    s_waitcnt lgkmcnt(0)
    v_mfma_f32_16x16x32_bf16 v[68:71], a[28:31], v[52:55], v[68:71]
    s_waitcnt vmcnt(4)
    s_barrier
    ds_read_b64_tr_b16 a[32:33], v50 offset:32768
    ds_read_b64_tr_b16 a[34:35], v50 offset:33280
    ds_read_b64_tr_b16 a[36:37], v50 offset:32776
    ds_read_b64_tr_b16 a[38:39], v50 offset:33288
    ds_read_b64_tr_b16 a[40:41], v50 offset:36864
    ds_read_b64_tr_b16 a[42:43], v50 offset:37376
    ds_read_b64_tr_b16 a[44:45], v50 offset:36872
    ds_read_b64_tr_b16 a[46:47], v50 offset:37384
    s_mov_b32 s25, 442368
    s_add_u32 m0, s27, 0
    s_nop 0
    buffer_load_dwordx4 v48, s[12:15], s25 offen offset:0 lds
    s_add_u32 m0, s27, 4096
    s_nop 0
    buffer_load_dwordx4 v48, s[8:11], s25 offen offset:0 lds
    s_mov_b32 s25, 470016
    s_add_u32 m0, s27, 1024
    s_nop 0
    buffer_load_dwordx4 v48, s[12:15], s25 offen offset:0 lds
    s_add_u32 m0, s27, 5120
    s_nop 0
    buffer_load_dwordx4 v48, s[8:11], s25 offen offset:0 lds
    s_waitcnt lgkmcnt(6)
    v_mfma_f32_16x16x32_bf16 v[56:59], a[32:35], v[52:55], v[56:59]
    s_waitcnt lgkmcnt(4)
    v_mfma_f32_16x16x32_bf16 v[60:63], a[36:39], v[52:55], v[60:63]
    s_waitcnt lgkmcnt(2)
    v_mfma_f32_16x16x32_bf16 v[64:67], a[40:43], v[52:55], v[64:67]
    s_waitcnt lgkmcnt(0)
    v_mfma_f32_16x16x32_bf16 v[68:71], a[44:47], v[52:55], v[68:71]
    s_waitcnt vmcnt(4)
    s_barrier
    ds_read_b64_tr_b16 a[48:49], v50 offset:49152
    ds_read_b64_tr_b16 a[50:51], v50 offset:49664
    ds_read_b64_tr_b16 a[52:53], v50 offset:49160
    ds_read_b64_tr_b16 a[54:55], v50 offset:49672
    ds_read_b64_tr_b16 a[56:57], v50 offset:53248
    ds_read_b64_tr_b16 a[58:59], v50 offset:53760
    ds_read_b64_tr_b16 a[60:61], v50 offset:53256
    ds_read_b64_tr_b16 a[62:63], v50 offset:53768
    s_mov_b32 s25, 552960
    s_add_u32 m0, s27, 16384
    s_nop 0
    buffer_load_dwordx4 v48, s[12:15], s25 offen offset:0 lds
    s_add_u32 m0, s27, 20480
    s_nop 0
    buffer_load_dwordx4 v48, s[8:11], s25 offen offset:0 lds
    s_mov_b32 s25, 580608
    s_add_u32 m0, s27, 17408
    s_nop 0
    buffer_load_dwordx4 v48, s[12:15], s25 offen offset:0 lds
    s_add_u32 m0, s27, 21504
    s_nop 0
    buffer_load_dwordx4 v48, s[8:11], s25 offen offset:0 lds
    s_mov_b32 s25, 663552
    s_add_u32 m0, s27, 32768
    s_nop 0
    buffer_load_dwordx4 v48, s[12:15], s25 offen offset:0 lds
    s_add_u32 m0, s27, 36864
    s_nop 0
    buffer_load_dwordx4 v48, s[8:11], s25 offen offset:0 lds
    s_mov_b32 s25, 691200
    s_add_u32 m0, s27, 33792
    s_nop 0
    buffer_load_dwordx4 v48, s[12:15], s25 offen offset:0 lds
    s_add_u32 m0, s27, 37888
    s_nop 0
    buffer_load_dwordx4 v48, s[8:11], s25 offen offset:0 lds
    s_waitcnt lgkmcnt(6)
    v_mfma_f32_16x16x32_bf16 v[56:59], a[48:51], v[52:55], v[56:59]
    s_waitcnt lgkmcnt(4)
    v_mfma_f32_16x16x32_bf16 v[60:63], a[52:55], v[52:55], v[60:63]
    s_waitcnt lgkmcnt(2)
    v_mfma_f32_16x16x32_bf16 v[64:67], a[56:59], v[52:55], v[64:67]
    s_waitcnt lgkmcnt(0)
    v_mfma_f32_16x16x32_bf16 v[68:71], a[60:63], v[52:55], v[68:71]
    s_waitcnt vmcnt(8)
    s_barrier
    ds_read_b64_tr_b16 a[64:65], v50 offset:0
    ds_read_b64_tr_b16 a[66:67], v50 offset:512
    ds_read_b64_tr_b16 a[68:69], v50 offset:8
    ds_read_b64_tr_b16 a[70:71], v50 offset:520
    ds_read_b64_tr_b16 a[72:73], v50 offset:4096
    ds_read_b64_tr_b16 a[74:75], v50 offset:4608
    ds_read_b64_tr_b16 a[76:77], v50 offset:4104
    ds_read_b64_tr_b16 a[78:79], v50 offset:4616
    s_mov_b32 s25, 774144
    s_add_u32 m0, s27, 49152
    s_nop 0
    buffer_load_dwordx4 v48, s[12:15], s25 offen offset:0 lds
    s_add_u32 m0, s27, 53248
    s_nop 0
    buffer_load_dwordx4 v48, s[8:11], s25 offen offset:0 lds
    s_mov_b32 s25, 801792
    s_add_u32 m0, s27, 50176
    s_nop 0
    buffer_load_dwordx4 v48, s[12:15], s25 offen offset:0 lds
    s_add_u32 m0, s27, 54272
    s_nop 0
    buffer_load_dwordx4 v48, s[8:11], s25 offen offset:0 lds
    s_waitcnt lgkmcnt(6)
    v_mfma_f32_16x16x32_bf16 v[56:59], a[64:67], v[52:55], v[56:59]
    s_waitcnt lgkmcnt(4)
    v_mfma_f32_16x16x32_bf16 v[60:63], a[68:71], v[52:55], v[60:63]
    s_waitcnt lgkmcnt(2)
    v_mfma_f32_16x16x32_bf16 v[64:67], a[72:75], v[52:55], v[64:67]
    s_waitcnt lgkmcnt(0)
    v_mfma_f32_16x16x32_bf16 v[68:71], a[76:79], v[52:55], v[68:71]
    s_waitcnt vmcnt(8)
    s_barrier
    ds_read_b64_tr_b16 a[80:81], v50 offset:16384
    ds_read_b64_tr_b16 a[82:83], v50 offset:16896
    ds_read_b64_tr_b16 a[84:85], v50 offset:16392
    ds_read_b64_tr_b16 a[86:87], v50 offset:16904
    ds_read_b64_tr_b16 a[88:89], v50 offset:20480
    ds_read_b64_tr_b16 a[90:91], v50 offset:20992
    ds_read_b64_tr_b16 a[92:93], v50 offset:20488
    ds_read_b64_tr_b16 a[94:95], v50 offset:21000
    s_mov_b32 s25, 884736
    s_add_u32 m0, s27, 0
    s_nop 0
    buffer_load_dwordx4 v48, s[12:15], s25 offen offset:0 lds
    s_add_u32 m0, s27, 4096
    s_nop 0
    buffer_load_dwordx4 v48, s[8:11], s25 offen offset:0 lds
    s_mov_b32 s25, 912384
    s_add_u32 m0, s27, 1024
    s_nop 0
    buffer_load_dwordx4 v48, s[12:15], s25 offen offset:0 lds
    s_add_u32 m0, s27, 5120
    s_nop 0
    buffer_load_dwordx4 v48, s[8:11], s25 offen offset:0 lds
    s_waitcnt lgkmcnt(6)
    v_mfma_f32_16x16x32_bf16 v[56:59], a[80:83], v[52:55], v[56:59]
    s_waitcnt lgkmcnt(4)
    v_mfma_f32_16x16x32_bf16 v[60:63], a[84:87], v[52:55], v[60:63]
    s_waitcnt lgkmcnt(2)
    v_mfma_f32_16x16x32_bf16 v[64:67], a[88:91], v[52:55], v[64:67]
    s_waitcnt lgkmcnt(0)
    v_mfma_f32_16x16x32_bf16 v[68:71], a[92:95], v[52:55], v[68:71]
    s_waitcnt vmcnt(8)
    s_barrier
    ds_read_b64_tr_b16 a[96:97], v50 offset:32768
    ds_read_b64_tr_b16 a[98:99], v50 offset:33280
    ds_read_b64_tr_b16 a[100:101], v50 offset:32776
    ds_read_b64_tr_b16 a[102:103], v50 offset:33288
    ds_read_b64_tr_b16 a[104:105], v50 offset:36864
    ds_read_b64_tr_b16 a[106:107], v50 offset:37376
    ds_read_b64_tr_b16 a[108:109], v50 offset:36872
    ds_read_b64_tr_b16 a[110:111], v50 offset:37384
    s_mov_b32 s25, 995328
    s_add_u32 m0, s27, 16384
    s_nop 0
    buffer_load_dwordx4 v48, s[12:15], s25 offen offset:0 lds
    s_add_u32 m0, s27, 20480
    s_nop 0
    buffer_load_dwordx4 v48, s[8:11], s25 offen offset:0 lds
    s_mov_b32 s25, 1022976
    s_add_u32 m0, s27, 17408
    s_nop 0
    buffer_load_dwordx4 v48, s[12:15], s25 offen offset:0 lds
    s_add_u32 m0, s27, 21504
    s_nop 0
    buffer_load_dwordx4 v48, s[8:11], s25 offen offset:0 lds
    s_waitcnt lgkmcnt(6)
    v_mfma_f32_16x16x32_bf16 v[56:59], a[96:99], v[52:55], v[56:59]
    s_waitcnt lgkmcnt(4)
    v_mfma_f32_16x16x32_bf16 v[60:63], a[100:103], v[52:55], v[60:63]
    s_waitcnt lgkmcnt(2)
    v_mfma_f32_16x16x32_bf16 v[64:67], a[104:107], v[52:55], v[64:67]
    s_waitcnt lgkmcnt(0)
    v_mfma_f32_16x16x32_bf16 v[68:71], a[108:111], v[52:55], v[68:71]
    s_waitcnt vmcnt(8)
    s_barrier
    ds_read_b64_tr_b16 a[112:113], v50 offset:49152
    ds_read_b64_tr_b16 a[114:115], v50 offset:49664
    ds_read_b64_tr_b16 a[116:117], v50 offset:49160
    ds_read_b64_tr_b16 a[118:119], v50 offset:49672
    ds_read_b64_tr_b16 a[120:121], v50 offset:53248
    ds_read_b64_tr_b16 a[122:123], v50 offset:53760
    ds_read_b64_tr_b16 a[124:125], v50 offset:53256
    ds_read_b64_tr_b16 a[126:127], v50 offset:53768
    s_mov_b32 s25, 1105920
    s_add_u32 m0, s27, 32768
    s_nop 0
    buffer_load_dwordx4 v48, s[12:15], s25 offen offset:0 lds
    s_add_u32 m0, s27, 36864
    s_nop 0
    buffer_load_dwordx4 v48, s[8:11], s25 offen offset:0 lds
    s_mov_b32 s25, 1133568
    s_add_u32 m0, s27, 33792
    s_nop 0
    buffer_load_dwordx4 v48, s[12:15], s25 offen offset:0 lds
    s_add_u32 m0, s27, 37888
    s_nop 0
    buffer_load_dwordx4 v48, s[8:11], s25 offen offset:0 lds
    s_waitcnt lgkmcnt(6)
    v_mfma_f32_16x16x32_bf16 v[56:59], a[112:115], v[52:55], v[56:59]
    s_waitcnt lgkmcnt(4)
    v_mfma_f32_16x16x32_bf16 v[60:63], a[116:119], v[52:55], v[60:63]
    s_waitcnt lgkmcnt(2)
    v_mfma_f32_16x16x32_bf16 v[64:67], a[120:123], v[52:55], v[64:67]
    s_waitcnt lgkmcnt(0)
    v_mfma_f32_16x16x32_bf16 v[68:71], a[124:127], v[52:55], v[68:71]
    s_waitcnt vmcnt(8)
    s_barrier
    ds_read_b64_tr_b16 a[128:129], v50 offset:0
    ds_read_b64_tr_b16 a[130:131], v50 offset:512
    ds_read_b64_tr_b16 a[132:133], v50 offset:8
    ds_read_b64_tr_b16 a[134:135], v50 offset:520
    ds_read_b64_tr_b16 a[136:137], v50 offset:4096
    ds_read_b64_tr_b16 a[138:139], v50 offset:4608
    ds_read_b64_tr_b16 a[140:141], v50 offset:4104
    ds_read_b64_tr_b16 a[142:143], v50 offset:4616
    s_mov_b32 s25, 1216512
    s_add_u32 m0, s27, 49152
    s_nop 0
    buffer_load_dwordx4 v48, s[12:15], s25 offen offset:0 lds
    s_add_u32 m0, s27, 53248
    s_nop 0
    buffer_load_dwordx4 v48, s[8:11], s25 offen offset:0 lds
    s_mov_b32 s25, 1244160
    s_add_u32 m0, s27, 50176
    s_nop 0
    buffer_load_dwordx4 v48, s[12:15], s25 offen offset:0 lds
    s_add_u32 m0, s27, 54272
    s_nop 0
    buffer_load_dwordx4 v48, s[8:11], s25 offen offset:0 lds
    s_waitcnt lgkmcnt(6)
    v_mfma_f32_16x16x32_bf16 v[56:59], a[128:131], v[52:55], v[56:59]
    s_waitcnt lgkmcnt(4)
    v_mfma_f32_16x16x32_bf16 v[60:63], a[132:135], v[52:55], v[60:63]
    s_waitcnt lgkmcnt(2)
    v_mfma_f32_16x16x32_bf16 v[64:67], a[136:139], v[52:55], v[64:67]
    s_waitcnt lgkmcnt(0)
    v_mfma_f32_16x16x32_bf16 v[68:71], a[140:143], v[52:55], v[68:71]
    s_waitcnt vmcnt(8)
    s_barrier
    ds_read_b64_tr_b16 a[144:145], v50 offset:16384
    ds_read_b64_tr_b16 a[146:147], v50 offset:16896
    ds_read_b64_tr_b16 a[148:149], v50 offset:16392
    ds_read_b64_tr_b16 a[150:151], v50 offset:16904
    ds_read_b64_tr_b16 a[152:153], v50 offset:20480
    ds_read_b64_tr_b16 a[154:155], v50 offset:20992
    ds_read_b64_tr_b16 a[156:157], v50 offset:20488
    ds_read_b64_tr_b16 a[158:159], v50 offset:21000
    s_mov_b32 s25, 1327104
    s_add_u32 m0, s27, 0
    s_nop 0
    buffer_load_dwordx4 v48, s[12:15], s25 offen offset:0 lds
    s_add_u32 m0, s27, 4096
    s_nop 0
    buffer_load_dwordx4 v48, s[8:11], s25 offen offset:0 lds
    s_mov_b32 s25, 1354752
    s_add_u32 m0, s27, 1024
    s_nop 0
    buffer_load_dwordx4 v48, s[12:15], s25 offen offset:0 lds
    s_add_u32 m0, s27, 5120
    s_nop 0
    buffer_load_dwordx4 v48, s[8:11], s25 offen offset:0 lds
    s_waitcnt lgkmcnt(6)
    v_mfma_f32_16x16x32_bf16 v[56:59], a[144:147], v[52:55], v[56:59]
    s_waitcnt lgkmcnt(4)
    v_mfma_f32_16x16x32_bf16 v[60:63], a[148:151], v[52:55], v[60:63]
    s_waitcnt lgkmcnt(2)
    v_mfma_f32_16x16x32_bf16 v[64:67], a[152:155], v[52:55], v[64:67]
    s_waitcnt lgkmcnt(0)
    v_mfma_f32_16x16x32_bf16 v[68:71], a[156:159], v[52:55], v[68:71]
    s_waitcnt vmcnt(8)
    s_barrier
    ds_read_b64_tr_b16 a[160:161], v50 offset:32768
    ds_read_b64_tr_b16 a[162:163], v50 offset:33280
    ds_read_b64_tr_b16 a[164:165], v50 offset:32776
    ds_read_b64_tr_b16 a[166:167], v50 offset:33288
    ds_read_b64_tr_b16 a[168:169], v50 offset:36864
    ds_read_b64_tr_b16 a[170:171], v50 offset:37376
    ds_read_b64_tr_b16 a[172:173], v50 offset:36872
    ds_read_b64_tr_b16 a[174:175], v50 offset:37384
    s_mov_b32 s25, 1437696
    s_add_u32 m0, s27, 16384
    s_nop 0
    buffer_load_dwordx4 v48, s[12:15], s25 offen offset:0 lds
    s_add_u32 m0, s27, 20480
    s_nop 0
    buffer_load_dwordx4 v48, s[8:11], s25 offen offset:0 lds
    s_mov_b32 s25, 1465344
    s_add_u32 m0, s27, 17408
    s_nop 0
    buffer_load_dwordx4 v48, s[12:15], s25 offen offset:0 lds
    s_add_u32 m0, s27, 21504
    s_nop 0
    buffer_load_dwordx4 v48, s[8:11], s25 offen offset:0 lds
    s_waitcnt lgkmcnt(6)
    v_mfma_f32_16x16x32_bf16 v[56:59], a[160:163], v[52:55], v[56:59]
    s_waitcnt lgkmcnt(4)
    v_mfma_f32_16x16x32_bf16 v[60:63], a[164:167], v[52:55], v[60:63]
    s_waitcnt lgkmcnt(2)
    v_mfma_f32_16x16x32_bf16 v[64:67], a[168:171], v[52:55], v[64:67]
    s_waitcnt lgkmcnt(0)
    v_mfma_f32_16x16x32_bf16 v[68:71], a[172:175], v[52:55], v[68:71]
    s_waitcnt vmcnt(8)
    s_barrier
    ds_read_b64_tr_b16 a[176:177], v50 offset:49152
    ds_read_b64_tr_b16 a[178:179], v50 offset:49664
    ds_read_b64_tr_b16 a[180:181], v50 offset:49160
    ds_read_b64_tr_b16 a[182:183], v50 offset:49672
    ds_read_b64_tr_b16 a[184:185], v50 offset:53248
    ds_read_b64_tr_b16 a[186:187], v50 offset:53760
    ds_read_b64_tr_b16 a[188:189], v50 offset:53256
    ds_read_b64_tr_b16 a[190:191], v50 offset:53768
    s_mov_b32 s25, 1548288
    s_add_u32 m0, s27, 32768
    s_nop 0
    buffer_load_dwordx4 v48, s[12:15], s25 offen offset:0 lds
    s_add_u32 m0, s27, 36864
    s_nop 0
    buffer_load_dwordx4 v48, s[8:11], s25 offen offset:0 lds
    s_mov_b32 s25, 1575936
    s_add_u32 m0, s27, 33792
    s_nop 0
    buffer_load_dwordx4 v48, s[12:15], s25 offen offset:0 lds
    s_add_u32 m0, s27, 37888
    s_nop 0
    buffer_load_dwordx4 v48, s[8:11], s25 offen offset:0 lds
    s_waitcnt lgkmcnt(6)
    v_mfma_f32_16x16x32_bf16 v[56:59], a[176:179], v[52:55], v[56:59]
    s_waitcnt lgkmcnt(4)
    v_mfma_f32_16x16x32_bf16 v[60:63], a[180:183], v[52:55], v[60:63]
    s_waitcnt lgkmcnt(2)
    v_mfma_f32_16x16x32_bf16 v[64:67], a[184:187], v[52:55], v[64:67]
    s_waitcnt lgkmcnt(0)
    v_mfma_f32_16x16x32_bf16 v[68:71], a[188:191], v[52:55], v[68:71]
    s_waitcnt vmcnt(8)
    s_barrier
    ds_read_b64_tr_b16 a[192:193], v50 offset:0
    ds_read_b64_tr_b16 a[194:195], v50 offset:512
    ds_read_b64_tr_b16 a[196:197], v50 offset:8
    ds_read_b64_tr_b16 a[198:199], v50 offset:520
    ds_read_b64_tr_b16 a[200:201], v50 offset:4096
    ds_read_b64_tr_b16 a[202:203], v50 offset:4608
    ds_read_b64_tr_b16 a[204:205], v50 offset:4104
    ds_read_b64_tr_b16 a[206:207], v50 offset:4616
    v_lshlrev_b32 v26, 7, v1
    s_add_u32 s26, s21, 0x8000
    s_mov_b32 exec_hi, 0
    buffer_load_dword v24, v26, s[4:7], s26 offen sc1
    s_mov_b32 exec_hi, -1
    s_mov_b32 s25, 1658880
    s_add_u32 m0, s27, 49152
    s_nop 0
    buffer_load_dwordx4 v48, s[12:15], s25 offen offset:0 lds
    s_add_u32 m0, s27, 53248
    s_nop 0
    buffer_load_dwordx4 v48, s[8:11], s25 offen offset:0 lds
    s_mov_b32 s25, 1686528
    s_add_u32 m0, s27, 50176
    s_nop 0
    buffer_load_dwordx4 v48, s[12:15], s25 offen offset:0 lds
    s_add_u32 m0, s27, 54272
    s_nop 0
    buffer_load_dwordx4 v48, s[8:11], s25 offen offset:0 lds
    s_waitcnt lgkmcnt(6)
    v_mfma_f32_16x16x32_bf16 v[56:59], a[192:195], v[52:55], v[56:59]
    s_waitcnt lgkmcnt(4)
    v_mfma_f32_16x16x32_bf16 v[60:63], a[196:199], v[52:55], v[60:63]
    s_waitcnt lgkmcnt(2)
    v_mfma_f32_16x16x32_bf16 v[64:67], a[200:203], v[52:55], v[64:67]
    s_waitcnt lgkmcnt(0)
    v_mfma_f32_16x16x32_bf16 v[68:71], a[204:207], v[52:55], v[68:71]
    s_waitcnt vmcnt(9)
    s_barrier
    ds_read_b64_tr_b16 a[208:209], v50 offset:16384
    ds_read_b64_tr_b16 a[210:211], v50 offset:16896
    ds_read_b64_tr_b16 a[212:213], v50 offset:16392
    ds_read_b64_tr_b16 a[214:215], v50 offset:16904
    ds_read_b64_tr_b16 a[216:217], v50 offset:20480
    ds_read_b64_tr_b16 a[218:219], v50 offset:20992
    ds_read_b64_tr_b16 a[220:221], v50 offset:20488
    ds_read_b64_tr_b16 a[222:223], v50 offset:21000
    s_mov_b32 s25, 1769472
    s_add_u32 m0, s27, 0
    s_nop 0
    buffer_load_dwordx4 v48, s[12:15], s25 offen offset:0 lds
    s_add_u32 m0, s27, 4096
    s_nop 0
    buffer_load_dwordx4 v48, s[8:11], s25 offen offset:0 lds
    s_mov_b32 s25, 1797120
    s_add_u32 m0, s27, 1024
    s_nop 0
    buffer_load_dwordx4 v48, s[12:15], s25 offen offset:0 lds
    s_add_u32 m0, s27, 5120
    s_nop 0
    buffer_load_dwordx4 v48, s[8:11], s25 offen offset:0 lds
    s_waitcnt lgkmcnt(6)
    v_mfma_f32_16x16x32_bf16 v[56:59], a[208:211], v[52:55], v[56:59]
    s_waitcnt lgkmcnt(4)
    v_mfma_f32_16x16x32_bf16 v[60:63], a[212:215], v[52:55], v[60:63]
    s_waitcnt lgkmcnt(2)
    v_mfma_f32_16x16x32_bf16 v[64:67], a[216:219], v[52:55], v[64:67]
    s_waitcnt lgkmcnt(0)
    v_mfma_f32_16x16x32_bf16 v[68:71], a[220:223], v[52:55], v[68:71]
    s_waitcnt vmcnt(9)
    s_barrier
    ds_read_b64_tr_b16 a[224:225], v50 offset:32768
    ds_read_b64_tr_b16 a[226:227], v50 offset:33280
    ds_read_b64_tr_b16 a[228:229], v50 offset:32776
    ds_read_b64_tr_b16 a[230:231], v50 offset:33288
    ds_read_b64_tr_b16 a[232:233], v50 offset:36864
    ds_read_b64_tr_b16 a[234:235], v50 offset:37376
    ds_read_b64_tr_b16 a[236:237], v50 offset:36872
    ds_read_b64_tr_b16 a[238:239], v50 offset:37384
    v_lshrrev_b32 v44, 3, v1
    v_mul_u32_u24 v44, 54272, v44
    v_lshl_add_u32 v44, v1, 7, v44
    s_mov_b32 exec_hi, 0xffff
    buffer_load_dword v136, v44, s[4:7], s86 offen sc1
    s_mov_b32 exec_hi, -1
    s_mov_b32 s25, 1880064
    s_add_u32 m0, s27, 16384
    s_nop 0
    buffer_load_dwordx4 v48, s[12:15], s25 offen offset:0 lds
    s_add_u32 m0, s27, 20480
    s_nop 0
    buffer_load_dwordx4 v48, s[8:11], s25 offen offset:0 lds
    s_mov_b32 s25, 1907712
    s_add_u32 m0, s27, 17408
    s_nop 0
    buffer_load_dwordx4 v48, s[12:15], s25 offen offset:0 lds
    s_add_u32 m0, s27, 21504
    s_nop 0
    buffer_load_dwordx4 v48, s[8:11], s25 offen offset:0 lds
    s_waitcnt lgkmcnt(6)
    v_mfma_f32_16x16x32_bf16 v[56:59], a[224:227], v[52:55], v[56:59]
    s_waitcnt lgkmcnt(4)
    v_mfma_f32_16x16x32_bf16 v[60:63], a[228:231], v[52:55], v[60:63]
    s_waitcnt lgkmcnt(2)
    v_mfma_f32_16x16x32_bf16 v[64:67], a[232:235], v[52:55], v[64:67]
    s_waitcnt lgkmcnt(0)
    v_mfma_f32_16x16x32_bf16 v[68:71], a[236:239], v[52:55], v[68:71]
    s_waitcnt vmcnt(9)
    s_barrier
    ds_read_b64_tr_b16 a[240:241], v50 offset:49152
    ds_read_b64_tr_b16 a[242:243], v50 offset:49664
    ds_read_b64_tr_b16 a[244:245], v50 offset:49160
    ds_read_b64_tr_b16 a[246:247], v50 offset:49672
    ds_read_b64_tr_b16 a[248:249], v50 offset:53248
    ds_read_b64_tr_b16 a[250:251], v50 offset:53760
    ds_read_b64_tr_b16 a[252:253], v50 offset:53256
    ds_read_b64_tr_b16 a[254:255], v50 offset:53768
    s_mov_b32 s25, 1990656
    s_add_u32 m0, s27, 32768
    s_nop 0
    buffer_load_dwordx4 v48, s[12:15], s25 offen offset:0 lds
    s_add_u32 m0, s27, 36864
    s_nop 0
    buffer_load_dwordx4 v48, s[8:11], s25 offen offset:0 lds
    s_mov_b32 s25, 2018304
    s_add_u32 m0, s27, 33792
    s_nop 0
    buffer_load_dwordx4 v48, s[12:15], s25 offen offset:0 lds
    s_add_u32 m0, s27, 37888
    s_nop 0
    buffer_load_dwordx4 v48, s[8:11], s25 offen offset:0 lds
    s_waitcnt lgkmcnt(6)
    v_mfma_f32_16x16x32_bf16 v[56:59], a[240:243], v[52:55], v[56:59]
    s_waitcnt lgkmcnt(4)
    v_mfma_f32_16x16x32_bf16 v[60:63], a[244:247], v[52:55], v[60:63]
    s_waitcnt lgkmcnt(2)
    v_mfma_f32_16x16x32_bf16 v[64:67], a[248:251], v[52:55], v[64:67]
    s_waitcnt lgkmcnt(0)
    v_mfma_f32_16x16x32_bf16 v[68:71], a[252:255], v[52:55], v[68:71]
    s_waitcnt vmcnt(9)
    s_barrier
    ds_read_b64_tr_b16 v[192:193], v50 offset:0
    ds_read_b64_tr_b16 v[194:195], v50 offset:512
    ds_read_b64_tr_b16 v[196:197], v50 offset:8
    ds_read_b64_tr_b16 v[198:199], v50 offset:520
    ds_read_b64_tr_b16 v[200:201], v50 offset:4096
    ds_read_b64_tr_b16 v[202:203], v50 offset:4608
    ds_read_b64_tr_b16 v[204:205], v50 offset:4104
    ds_read_b64_tr_b16 v[206:207], v50 offset:4616
    v_mov_b32 v27, v24
    s_mov_b32 s29, 0
    s_branch gse_182
gs_180:
    v_lshlrev_b32 v26, 7, v1
    s_add_u32 s26, s21, 0x8000
    s_mov_b32 exec_hi, 0
    buffer_load_dword v24, v26, s[4:7], s26 offen sc1
    s_mov_b32 exec_hi, -1
    s_waitcnt vmcnt(0)
gse_182:
    s_mov_b32 exec_hi, 0
    v_cmp_eq_u32 vcc, 0, v24
    s_mov_b32 exec_hi, -1
    s_nop 1
    s_cbranch_vccz gsd_181
    s_sleep 2
    s_add_u32 s29, s29, 1
    s_cmp_lt_u32 s29, 20000
    s_cbranch_scc1 gs_180
    s_mov_b32 s29, 98
    s_branch L_fail
gsd_181:
    s_getreg_b32 s25, hwreg(HW_REG_XCC_ID, 0, 4)
    s_add_u32 s25, s25, 1
    s_mov_b32 exec_hi, 0
    v_cmp_ne_u32 vcc, s25, v24
    s_mov_b32 exec_hi, -1
    s_nop 0
    s_cmp_eq_u64 vcc, 0
    s_cselect_b32 s20, 0, 0xff
    s_lshr_b32 s26, s2, 3
    s_add_u32 s26, s26, 1
    s_lshl_b32 s26, s26, 7
    s_add_u32 s26, s26, s54
    s_lshl_b32 s25, s23, 2
    s_add_u32 s60, s26, s25
    s_cmp_eq_u32 s20, 0
    s_cselect_b32 s61, s60, 0x2000000
    s_mov_b32 s25, 2101248
    s_add_u32 m0, s27, 49152
    s_nop 0
    buffer_load_dwordx4 v48, s[12:15], s25 offen offset:0 lds
    s_add_u32 m0, s27, 53248
    s_nop 0
    buffer_load_dwordx4 v48, s[8:11], s25 offen offset:0 lds
    s_mov_b32 s25, 2128896
    s_add_u32 m0, s27, 50176
    s_nop 0
    buffer_load_dwordx4 v48, s[12:15], s25 offen offset:0 lds
    s_add_u32 m0, s27, 54272
    s_nop 0
    buffer_load_dwordx4 v48, s[8:11], s25 offen offset:0 lds
    s_waitcnt lgkmcnt(0)
    v_mfma_f32_16x16x32_bf16 v[56:59], v[192:195], v[52:55], v[56:59]
    v_mfma_f32_16x16x32_bf16 v[60:63], v[196:199], v[52:55], v[60:63]
    v_mfma_f32_16x16x32_bf16 v[64:67], v[200:203], v[52:55], v[64:67]
    v_mfma_f32_16x16x32_bf16 v[68:71], v[204:207], v[52:55], v[68:71]
    s_waitcnt vmcnt(8)
    s_barrier
    ds_read_b64_tr_b16 v[208:209], v50 offset:16384
    ds_read_b64_tr_b16 v[210:211], v50 offset:16896
    ds_read_b64_tr_b16 v[212:213], v50 offset:16392
    ds_read_b64_tr_b16 v[214:215], v50 offset:16904
    ds_read_b64_tr_b16 v[216:217], v50 offset:20480
    ds_read_b64_tr_b16 v[218:219], v50 offset:20992
    ds_read_b64_tr_b16 v[220:221], v50 offset:20488
    ds_read_b64_tr_b16 v[222:223], v50 offset:21000
    buffer_load_dwordx4 v[24:27], v20, s[4:7], s79 offen sc1
    s_waitcnt lgkmcnt(6)
    v_mfma_f32_16x16x32_bf16 v[56:59], v[208:211], v[52:55], v[56:59]
    s_waitcnt lgkmcnt(4)
    v_mfma_f32_16x16x32_bf16 v[60:63], v[212:215], v[52:55], v[60:63]
    s_waitcnt lgkmcnt(2)
    v_mfma_f32_16x16x32_bf16 v[64:67], v[216:219], v[52:55], v[64:67]
    s_waitcnt lgkmcnt(0)
    v_mfma_f32_16x16x32_bf16 v[68:71], v[220:223], v[52:55], v[68:71]
    s_waitcnt vmcnt(5)
    s_barrier
    ds_read_b64_tr_b16 v[224:225], v50 offset:32768
    ds_read_b64_tr_b16 v[226:227], v50 offset:33280
    ds_read_b64_tr_b16 v[228:229], v50 offset:32776
    ds_read_b64_tr_b16 v[230:231], v50 offset:33288
    ds_read_b64_tr_b16 v[232:233], v50 offset:36864
    ds_read_b64_tr_b16 v[234:235], v50 offset:37376
    ds_read_b64_tr_b16 v[236:237], v50 offset:36872
    ds_read_b64_tr_b16 v[238:239], v50 offset:37384
RE_p3:
    s_waitcnt lgkmcnt(6)
    v_mfma_f32_16x16x32_bf16 v[56:59], v[224:227], v[52:55], v[56:59]
    s_waitcnt lgkmcnt(4)
    v_mfma_f32_16x16x32_bf16 v[60:63], v[228:231], v[52:55], v[60:63]
    s_waitcnt lgkmcnt(2)
    v_mfma_f32_16x16x32_bf16 v[64:67], v[232:235], v[52:55], v[64:67]
    s_waitcnt lgkmcnt(0)
    v_mfma_f32_16x16x32_bf16 v[68:71], v[236:239], v[52:55], v[68:71]
    s_waitcnt vmcnt(1)
    s_barrier
    ds_read_b64_tr_b16 v[240:241], v50 offset:49152
    ds_read_b64_tr_b16 v[242:243], v50 offset:49664
    ds_read_b64_tr_b16 v[244:245], v50 offset:49160
    ds_read_b64_tr_b16 v[246:247], v50 offset:49672
    ds_read_b64_tr_b16 v[248:249], v50 offset:53248
    ds_read_b64_tr_b16 v[250:251], v50 offset:53760
    ds_read_b64_tr_b16 v[252:253], v50 offset:53256
    ds_read_b64_tr_b16 v[254:255], v50 offset:53768
    s_mov_b32 s70, 0
    s_mov_b32 s78, 63
    s_waitcnt vmcnt(0)
    v_max3_u32 v28, v24, v25, v26
    v_max3_u32 v28, v28, v27, s20
    v_add_u32 v29, s78, v23
    v_cmp_lt_u32 vcc, v29, v28
    s_cmp_eq_u32 s22, 18
    s_cbranch_scc1 npre_183
    s_cbranch_vccnz npre_183
    s_add_u32 m0, s66, 0
    s_nop 0
    buffer_load_dwordx4 v2, s[4:7], s75 offen offset:0 sc1 lds
    buffer_load_dwordx4 v2, s[4:7], s75 offen offset:1024 sc1 lds
    buffer_load_dwordx4 v2, s[4:7], s75 offen offset:2048 sc1 lds
    buffer_load_dwordx4 v2, s[4:7], s75 offen offset:3072 sc1 lds
    s_add_u32 m0, s66, 4096
    s_nop 0
    buffer_load_dwordx4 v3, s[4:7], s75 offen offset:0 sc1 lds
    s_mov_b32 s70, 1
npre_183:
    s_waitcnt lgkmcnt(6)
    v_mfma_f32_16x16x32_bf16 v[56:59], v[240:243], v[52:55], v[56:59]
    s_waitcnt lgkmcnt(4)
    v_mfma_f32_16x16x32_bf16 v[60:63], v[244:247], v[52:55], v[60:63]
    s_waitcnt lgkmcnt(2)
    v_mfma_f32_16x16x32_bf16 v[64:67], v[248:251], v[52:55], v[64:67]
    s_waitcnt lgkmcnt(0)
    v_mfma_f32_16x16x32_bf16 v[68:71], v[252:255], v[52:55], v[68:71]
    s_waitcnt lgkmcnt(0)
    s_barrier
S_p3:
    s_mov_b32 s55, 0
Dp3:
    s_mov_b32 s78, 63
    s_mov_b32 s64, s63
    s_add_u32 s65, s63, s66
    v_add_u32 v6, s64, v2
    s_mov_b32 s80, 0
    s_mov_b32 s77, 0x2000000
    s_mov_b32 s68, 0x2000000
    s_mov_b32 s69, 0x2000000
    s_mov_b32 s81, s87
    s_cmp_eq_u32 s70, 1
    s_cbranch_scc1 skp_184
    s_mov_b32 s29, 0
spin_185:
    buffer_load_dwordx4 v[24:27], v20, s[4:7], s79 offen sc1
    s_waitcnt vmcnt(0)
    v_max3_u32 v28, v24, v25, v26
    v_max_u32 v28, v28, v27
    v_add_u32 v29, s78, v23
    v_cmp_lt_u32 vcc, v29, v28
    s_nop 1
    s_cbranch_vccz spind_186
    s_sleep 3
    s_add_u32 s29, s29, 1
    s_cmp_lt_u32 s29, 20000
    s_cbranch_scc1 spin_185
    s_mov_b32 s29, 31
    s_branch L_fail
spind_186:
    s_bitcmp1_b32 s20, 0
    s_cbranch_scc0 acq_187
    buffer_inv sc1
    s_waitcnt vmcnt(0)
acq_187:
G_p3:
    s_cmp_eq_u32 s22, 18
    s_cbranch_scc1 pair_188
    s_add_u32 m0, s65, 0
    s_nop 0
    buffer_load_dwordx4 v2, s[4:7], s75 offen offset:0 sc1 lds
    buffer_load_dwordx4 v2, s[4:7], s75 offen offset:1024 sc1 lds
    buffer_load_dwordx4 v2, s[4:7], s75 offen offset:2048 sc1 lds
    buffer_load_dwordx4 v2, s[4:7], s75 offen offset:3072 sc1 lds
    s_add_u32 m0, s65, 4096
    s_nop 0
    buffer_load_dwordx4 v3, s[4:7], s75 offen offset:0 sc1 lds
skp_184:
    s_mov_b32 s78, 62
    buffer_load_dwordx4 v[24:27], v20, s[4:7], s79 offen sc1
    s_add_u32 s75, s75, 20480
    s_add_u32 s64, s64, 20480
    s_sub_u32 s65, s64, s63
    s_cmp_eq_u32 s65, 61440
    s_cselect_b32 s64, s63, s64
    s_add_u32 s65, s64, s66
    s_add_u32 s73, s73, 1
    v_mov_b32 v15, s73
    s_waitcnt vmcnt(0)
    ds_write_b32 v13, v15
    s_mov_b32 s29, 0
sys_209:
    ds_read_b128 v[16:19], v14
    s_waitcnt lgkmcnt(0)
    v_min3_u32 v16, v16, v17, v18
    v_min_u32 v16, v16, v19
    s_nop 0
    v_readfirstlane_b32 s67, v16
    s_nop 0
    s_cmp_lt_u32 s67, s73
    s_cbranch_scc0 syd_210
    s_add_u32 s29, s29, 1
    s_cmp_lt_u32 s29, 160000
    s_cbranch_scc1 sys_209
    s_mov_b32 s29, 35
    s_branch L_fail
syd_210:
    ds_read_b128 v[140:143], v6 offset:0
    ds_read_b128 v[144:147], v6 offset:1024
    ds_read_b128 v[148:151], v6 offset:2048
    ds_read_b128 v[152:155], v6 offset:3072
    s_waitcnt lgkmcnt(0)
p3loop_190:
    s_waitcnt lgkmcnt(2)
    v_mfma_f32_16x16x32_bf16 v[160:163], a[0:3], v[140:143], 0
    ds_read_b128 v[156:159], v6 offset:4096
    v_fma_f32 v176, -v72, v56, v176
    v_mfma_f32_16x16x32_bf16 v[164:167], a[4:7], v[140:143], 0
    v_add_u32 v7, s64, v2
    v_fma_f32 v184, -v72, v64, v184
    v_mfma_f32_16x16x32_bf16 v[168:171], a[8:11], v[140:143], 0
    buffer_load_dwordx4 v[24:27], v20, s[4:7], s79 offen sc1
    v_mfma_f32_16x16x32_bf16 v[172:175], a[12:15], v[140:143], 0
    v_mul_f32 v176, v73, v176
    v_mul_f32 v176, v176, v184
    v_mfma_f32_16x16x32_bf16 v[160:163], a[16:19], v[144:147], v[160:163]
    ds_read_b128 v[140:143], v6 offset:5120
    v_fma_f32 v177, -v72, v57, v177
    v_mfma_f32_16x16x32_bf16 v[164:167], a[20:23], v[144:147], v[164:167]
    v_fma_f32 v185, -v72, v65, v185
    v_mul_f32 v177, v73, v177
    v_mfma_f32_16x16x32_bf16 v[168:171], a[24:27], v[144:147], v[168:171]
    v_mul_f32 v177, v177, v185
    v_cvt_pk_bf16_f32 v30, v176, v177
    v_mfma_f32_16x16x32_bf16 v[172:175], a[28:31], v[144:147], v[172:175]
    s_waitcnt lgkmcnt(1)
    v_fma_f32 v178, -v72, v58, v178
    v_fma_f32 v186, -v72, v66, v186
    v_mfma_f32_16x16x32_bf16 v[160:163], a[32:35], v[148:151], v[160:163]
    ds_read_b128 v[144:147], v6 offset:6144
    v_mul_f32 v178, v73, v178
    v_mfma_f32_16x16x32_bf16 v[164:167], a[36:39], v[148:151], v[164:167]
    v_mul_f32 v178, v178, v186
    v_fma_f32 v179, -v72, v59, v179
    v_mfma_f32_16x16x32_bf16 v[168:171], a[40:43], v[148:151], v[168:171]
    v_fma_f32 v187, -v72, v67, v187
    v_mul_f32 v179, v73, v179
    v_mfma_f32_16x16x32_bf16 v[172:175], a[44:47], v[148:151], v[172:175]
    v_mul_f32 v179, v179, v187
    v_cvt_pk_bf16_f32 v31, v178, v179
    v_mfma_f32_16x16x32_bf16 v[160:163], a[48:51], v[152:155], v[160:163]
    ds_read_b128 v[148:151], v6 offset:7168
    v_fma_f32 v180, -v72, v60, v180
    v_mfma_f32_16x16x32_bf16 v[164:167], a[52:55], v[152:155], v[164:167]
    v_fma_f32 v188, -v72, v68, v188
    v_mul_f32 v180, v73, v180
    v_mfma_f32_16x16x32_bf16 v[168:171], a[56:59], v[152:155], v[168:171]
    v_mul_f32 v180, v180, v188
    v_fma_f32 v181, -v72, v61, v181
    v_mfma_f32_16x16x32_bf16 v[172:175], a[60:63], v[152:155], v[172:175]
    v_fma_f32 v189, -v72, v69, v189
    v_mul_f32 v181, v73, v181
    v_mfma_f32_16x16x32_bf16 v[160:163], a[64:67], v[156:159], v[160:163]
    ds_read_b128 v[152:155], v6 offset:8192
    v_mul_f32 v181, v181, v189
    v_mfma_f32_16x16x32_bf16 v[164:167], a[68:71], v[156:159], v[164:167]
    v_cvt_pk_bf16_f32 v32, v180, v181
    v_fma_f32 v182, -v72, v62, v182
    v_mfma_f32_16x16x32_bf16 v[168:171], a[72:75], v[156:159], v[168:171]
    v_fma_f32 v190, -v72, v70, v190
    v_mul_f32 v182, v73, v182
    v_mfma_f32_16x16x32_bf16 v[172:175], a[76:79], v[156:159], v[172:175]
    s_waitcnt lgkmcnt(1)
    v_mul_f32 v182, v182, v190
    v_fma_f32 v183, -v72, v63, v183
    v_mfma_f32_16x16x32_bf16 v[160:163], a[80:83], v[140:143], v[160:163]
    ds_read_b128 v[156:159], v6 offset:9216
    v_fma_f32 v191, -v72, v71, v191
    v_mfma_f32_16x16x32_bf16 v[164:167], a[84:87], v[140:143], v[164:167]
    v_mul_f32 v183, v73, v183
    v_mul_f32 v183, v183, v191
    v_mfma_f32_16x16x32_bf16 v[168:171], a[88:91], v[140:143], v[168:171]
    v_cvt_pk_bf16_f32 v33, v182, v183
    v_mfma_f32_16x16x32_bf16 v[172:175], a[92:95], v[140:143], v[172:175]
    s_waitcnt vmcnt(0)
    v_max3_u32 v28, v24, v25, v26
    v_max3_u32 v28, v28, v27, s20
    v_mfma_f32_16x16x32_bf16 v[160:163], a[96:99], v[144:147], v[160:163]
    ds_read_b128 v[140:143], v6 offset:10240
    v_add_u32 v29, s78, v23
    v_mfma_f32_16x16x32_bf16 v[164:167], a[100:103], v[144:147], v[164:167]
    v_cmp_lt_u32 vcc, v29, v28
    v_mfma_f32_16x16x32_bf16 v[168:171], a[104:107], v[144:147], v[168:171]
    buffer_store_dwordx4 v[30:33], v2, s[4:7], s77 offen
    v_mfma_f32_16x16x32_bf16 v[172:175], a[108:111], v[144:147], v[172:175]
    s_cbranch_vccnz slow_191
ret_192:
    s_mov_b32 s71, s81
    v_mfma_f32_16x16x32_bf16 v[160:163], a[112:115], v[148:151], v[160:163]
    ds_read_b128 v[144:147], v6 offset:11264
    v_mfma_f32_16x16x32_bf16 v[164:167], a[116:119], v[148:151], v[164:167]
    buffer_load_dwordx4 v[38:41], v2, s[4:7], s71 offen sc1
    v_mfma_f32_16x16x32_bf16 v[168:171], a[120:123], v[148:151], v[168:171]
    buffer_load_dwordx2 v[42:43], v74, s[4:7], s71 offen offset:1024 sc1
    v_mfma_f32_16x16x32_bf16 v[172:175], a[124:127], v[148:151], v[172:175]
    s_add_u32 m0, s65, 0
    s_waitcnt lgkmcnt(2)
    v_mfma_f32_16x16x32_bf16 v[160:163], a[128:131], v[152:155], v[160:163]
    ds_read_b128 v[148:151], v6 offset:12288
    v_mfma_f32_16x16x32_bf16 v[164:167], a[132:135], v[152:155], v[164:167]
    buffer_load_dwordx4 v2, s[4:7], s75 offen offset:0 sc1 lds
    v_mfma_f32_16x16x32_bf16 v[168:171], a[136:139], v[152:155], v[168:171]
    buffer_load_dwordx4 v2, s[4:7], s75 offen offset:1024 sc1 lds
    v_mfma_f32_16x16x32_bf16 v[172:175], a[140:143], v[152:155], v[172:175]
    buffer_load_dwordx4 v2, s[4:7], s75 offen offset:2048 sc1 lds
    v_mfma_f32_16x16x32_bf16 v[160:163], a[144:147], v[156:159], v[160:163]
    ds_read_b128 v[152:155], v6 offset:13312
    v_mfma_f32_16x16x32_bf16 v[164:167], a[148:151], v[156:159], v[164:167]
    buffer_load_dwordx4 v2, s[4:7], s75 offen offset:3072 sc1 lds
    v_mfma_f32_16x16x32_bf16 v[168:171], a[152:155], v[156:159], v[168:171]
    s_add_u32 m0, s65, 4096
    v_mfma_f32_16x16x32_bf16 v[172:175], a[156:159], v[156:159], v[172:175]
    s_waitcnt lgkmcnt(2)
    buffer_load_dwordx4 v3, s[4:7], s75 offen offset:0 sc1 lds
    v_mfma_f32_16x16x32_bf16 v[160:163], a[160:163], v[140:143], v[160:163]
    s_add_u32 s64, s64, 20480
    ds_read_b128 v[156:159], v6 offset:14336
    s_sub_u32 s65, s64, s63
    v_mfma_f32_16x16x32_bf16 v[164:167], a[164:167], v[140:143], v[164:167]
    s_cmp_eq_u32 s65, 61440
    s_cselect_b32 s64, s63, s64
    s_add_u32 s65, s64, s66
    v_mfma_f32_16x16x32_bf16 v[168:171], a[168:171], v[140:143], v[168:171]
    s_cmp_lt_u32 s80, 30
    s_cselect_b32 s26, 20480, 0
    s_sub_u32 s78, s78, 1
    v_mfma_f32_16x16x32_bf16 v[172:175], a[172:175], v[140:143], v[172:175]
    s_add_u32 s26, s80, 2
    s_and_b32 s26, s26, 15
    v_mfma_f32_16x16x32_bf16 v[160:163], a[176:179], v[144:147], v[160:163]
    s_mul_i32 s26, s26, 20480
    ds_read_b128 v[140:143], v6 offset:15360
    s_add_u32 s75, s88, s26
    v_mfma_f32_16x16x32_bf16 v[164:167], a[180:183], v[144:147], v[164:167]
    s_waitcnt vmcnt(7)
    v_sub_u32_e64 v22, 64, s80
    s_mul_i32 s97, s80, 171
    v_mfma_f32_16x16x32_bf16 v[168:171], a[184:187], v[144:147], v[168:171]
    s_lshr_b32 s97, s97, 10
    buffer_store_dword v22, v21, s[4:7], s61 offen
    v_mfma_f32_16x16x32_bf16 v[172:175], a[188:191], v[144:147], v[172:175]
    s_mul_i32 s97, s97, 6
    s_sub_u32 s26, s80, s97
    s_waitcnt lgkmcnt(1)
    v_mfma_f32_16x16x32_bf16 v[160:163], a[192:195], v[148:151], v[160:163]
    s_mul_i32 s25, s26, 55296
    ds_read_b128 v[144:147], v6 offset:16384
    s_add_u32 s77, s25, s86
    v_mfma_f32_16x16x32_bf16 v[164:167], a[196:199], v[148:151], v[164:167]
    s_add_u32 s26, s80, 1
    s_and_b32 s26, s26, 15
    s_lshl_b32 s25, s26, 11
    v_mfma_f32_16x16x32_bf16 v[168:171], a[200:203], v[148:151], v[168:171]
    s_add_u32 s81, s25, s87
    s_add_u32 s80, s80, 1
    v_mfma_f32_16x16x32_bf16 v[172:175], a[204:207], v[148:151], v[172:175]
    v_mfma_f32_16x16x32_bf16 v[160:163], a[208:211], v[152:155], v[160:163]
    ds_read_b128 v[148:151], v6 offset:17408
    v_mfma_f32_16x16x32_bf16 v[164:167], a[212:215], v[152:155], v[164:167]
    v_mfma_f32_16x16x32_bf16 v[168:171], a[216:219], v[152:155], v[168:171]
    v_mfma_f32_16x16x32_bf16 v[172:175], a[220:223], v[152:155], v[172:175]
    v_mfma_f32_16x16x32_bf16 v[160:163], a[224:227], v[156:159], v[160:163]
    ds_read_b128 v[152:155], v6 offset:18432
    v_mfma_f32_16x16x32_bf16 v[164:167], a[228:231], v[156:159], v[164:167]
    v_mfma_f32_16x16x32_bf16 v[168:171], a[232:235], v[156:159], v[168:171]
    v_mfma_f32_16x16x32_bf16 v[172:175], a[236:239], v[156:159], v[172:175]
    s_waitcnt lgkmcnt(2)
    v_mfma_f32_16x16x32_bf16 v[160:163], a[240:243], v[140:143], v[160:163]
    ds_read_b128 v[156:159], v6 offset:19456
    v_mfma_f32_16x16x32_bf16 v[164:167], a[244:247], v[140:143], v[164:167]
    s_waitcnt vmcnt(7)
    v_add_f32 v38, v38, v40
    v_add_f32 v39, v39, v41
    v_mfma_f32_16x16x32_bf16 v[168:171], a[248:251], v[140:143], v[168:171]
    s_waitcnt vmcnt(6)
    v_add_f32 v38, v38, v42
    v_add_f32 v39, v39, v43
    v_mfma_f32_16x16x32_bf16 v[172:175], a[252:255], v[140:143], v[172:175]
    v_mfma_f32_16x16x32_bf16 v[160:163], v[192:195], v[144:147], v[160:163]
    v_permlane32_swap_b32 v38, v39
    v_mfma_f32_16x16x32_bf16 v[164:167], v[196:199], v[144:147], v[164:167]
    v_add_f32 v38, v38, v39
    v_mov_b32 v39, v38
    v_mfma_f32_16x16x32_bf16 v[168:171], v[200:203], v[144:147], v[168:171]
    v_mfma_f32_16x16x32_bf16 v[172:175], v[204:207], v[144:147], v[172:175]
    s_waitcnt lgkmcnt(1)
    v_permlane16_swap_b32 v38, v39
    v_mfma_f32_16x16x32_bf16 v[160:163], v[208:211], v[148:151], v[160:163]
    v_add_f32 v38, v38, v39
    v_mov_b32 v39, v38
    v_mfma_f32_16x16x32_bf16 v[164:167], v[212:215], v[148:151], v[164:167]
    s_waitcnt vmcnt(1)
    s_barrier
    v_mfma_f32_16x16x32_bf16 v[168:171], v[216:219], v[148:151], v[168:171]
    ds_read_b128 v[140:143], v7 offset:0
    v_mfma_f32_16x16x32_bf16 v[172:175], v[220:223], v[148:151], v[172:175]
    ds_read_b128 v[144:147], v7 offset:1024
    v_mfma_f32_16x16x32_bf16 v[160:163], v[224:227], v[152:155], v[160:163]
    ds_read_b128 v[148:151], v7 offset:2048
    v_mfma_f32_16x16x32_bf16 v[164:167], v[228:231], v[152:155], v[164:167]
    v_permlane32_swap_b32 v38, v39
    v_mfma_f32_16x16x32_bf16 v[168:171], v[232:235], v[152:155], v[168:171]
    v_mul_f32 v72, s84, v38
    v_fma_f32 v38, v72, v72, -s85
    v_mfma_f32_16x16x32_bf16 v[172:175], v[236:239], v[152:155], v[172:175]
    s_waitcnt lgkmcnt(3)
    v_fma_f32 v39, v39, s84, -v38
    v_max_f32 v39, s85, v39
    v_mfma_f32_16x16x32_bf16 v[160:163], v[240:243], v[156:159], v[160:163]
    ds_read_b128 v[152:155], v7 offset:3072
    v_mfma_f32_16x16x32_bf16 v[164:167], v[244:247], v[156:159], v[164:167]
    v_rsq_f32 v73, v39
    v_mfma_f32_16x16x32_bf16 v[168:171], v[248:251], v[156:159], v[168:171]
    v_mul_f32 v73, v73, v73
    v_mfma_f32_16x16x32_bf16 v[172:175], v[252:255], v[156:159], v[172:175]
    s_waitcnt lgkmcnt(2)
    v_mfma_f32_16x16x32_bf16 v[176:179], a[0:3], v[140:143], 0
    ds_read_b128 v[156:159], v7 offset:4096
    v_fma_f32 v160, -v72, v56, v160
    v_mfma_f32_16x16x32_bf16 v[180:183], a[4:7], v[140:143], 0
    v_add_u32 v6, s64, v2
    v_fma_f32 v168, -v72, v64, v168
    v_mfma_f32_16x16x32_bf16 v[184:187], a[8:11], v[140:143], 0
    buffer_load_dwordx4 v[24:27], v20, s[4:7], s79 offen sc1
    v_mfma_f32_16x16x32_bf16 v[188:191], a[12:15], v[140:143], 0
    v_mul_f32 v160, v73, v160
    v_mul_f32 v160, v160, v168
    v_mfma_f32_16x16x32_bf16 v[176:179], a[16:19], v[144:147], v[176:179]
    ds_read_b128 v[140:143], v7 offset:5120
    v_fma_f32 v161, -v72, v57, v161
    v_mfma_f32_16x16x32_bf16 v[180:183], a[20:23], v[144:147], v[180:183]
    v_fma_f32 v169, -v72, v65, v169
    v_mul_f32 v161, v73, v161
    v_mfma_f32_16x16x32_bf16 v[184:187], a[24:27], v[144:147], v[184:187]
    v_mul_f32 v161, v161, v169
    v_cvt_pk_bf16_f32 v30, v160, v161
    v_mfma_f32_16x16x32_bf16 v[188:191], a[28:31], v[144:147], v[188:191]
    s_waitcnt lgkmcnt(1)
    v_fma_f32 v162, -v72, v58, v162
    v_fma_f32 v170, -v72, v66, v170
    v_mfma_f32_16x16x32_bf16 v[176:179], a[32:35], v[148:151], v[176:179]
    ds_read_b128 v[144:147], v7 offset:6144
    v_mul_f32 v162, v73, v162
    v_mfma_f32_16x16x32_bf16 v[180:183], a[36:39], v[148:151], v[180:183]
    v_mul_f32 v162, v162, v170
    v_fma_f32 v163, -v72, v59, v163
    v_mfma_f32_16x16x32_bf16 v[184:187], a[40:43], v[148:151], v[184:187]
    v_fma_f32 v171, -v72, v67, v171
    v_mul_f32 v163, v73, v163
    v_mfma_f32_16x16x32_bf16 v[188:191], a[44:47], v[148:151], v[188:191]
    v_mul_f32 v163, v163, v171
    v_cvt_pk_bf16_f32 v31, v162, v163
    v_mfma_f32_16x16x32_bf16 v[176:179], a[48:51], v[152:155], v[176:179]
    ds_read_b128 v[148:151], v7 offset:7168
    v_fma_f32 v164, -v72, v60, v164
    v_mfma_f32_16x16x32_bf16 v[180:183], a[52:55], v[152:155], v[180:183]
    v_fma_f32 v172, -v72, v68, v172
    v_mul_f32 v164, v73, v164
    v_mfma_f32_16x16x32_bf16 v[184:187], a[56:59], v[152:155], v[184:187]
    v_mul_f32 v164, v164, v172
    v_fma_f32 v165, -v72, v61, v165
    v_mfma_f32_16x16x32_bf16 v[188:191], a[60:63], v[152:155], v[188:191]
    v_fma_f32 v173, -v72, v69, v173
    v_mul_f32 v165, v73, v165
    v_mfma_f32_16x16x32_bf16 v[176:179], a[64:67], v[156:159], v[176:179]
    ds_read_b128 v[152:155], v7 offset:8192
    v_mul_f32 v165, v165, v173
    v_mfma_f32_16x16x32_bf16 v[180:183], a[68:71], v[156:159], v[180:183]
    v_cvt_pk_bf16_f32 v32, v164, v165
    v_fma_f32 v166, -v72, v62, v166
    v_mfma_f32_16x16x32_bf16 v[184:187], a[72:75], v[156:159], v[184:187]
    v_fma_f32 v174, -v72, v70, v174
    v_mul_f32 v166, v73, v166
    v_mfma_f32_16x16x32_bf16 v[188:191], a[76:79], v[156:159], v[188:191]
    s_waitcnt lgkmcnt(1)
    v_mul_f32 v166, v166, v174
    v_fma_f32 v167, -v72, v63, v167
    v_mfma_f32_16x16x32_bf16 v[176:179], a[80:83], v[140:143], v[176:179]
    ds_read_b128 v[156:159], v7 offset:9216
    v_fma_f32 v175, -v72, v71, v175
    v_mfma_f32_16x16x32_bf16 v[180:183], a[84:87], v[140:143], v[180:183]
    v_mul_f32 v167, v73, v167
    v_mul_f32 v167, v167, v175
    v_mfma_f32_16x16x32_bf16 v[184:187], a[88:91], v[140:143], v[184:187]
    v_cvt_pk_bf16_f32 v33, v166, v167
    v_mfma_f32_16x16x32_bf16 v[188:191], a[92:95], v[140:143], v[188:191]
    s_waitcnt vmcnt(0)
    v_max3_u32 v28, v24, v25, v26
    v_max3_u32 v28, v28, v27, s20
    v_mfma_f32_16x16x32_bf16 v[176:179], a[96:99], v[144:147], v[176:179]
    ds_read_b128 v[140:143], v7 offset:10240
    v_add_u32 v29, s78, v23
    v_mfma_f32_16x16x32_bf16 v[180:183], a[100:103], v[144:147], v[180:183]
    v_cmp_lt_u32 vcc, v29, v28
    v_mfma_f32_16x16x32_bf16 v[184:187], a[104:107], v[144:147], v[184:187]
    buffer_store_dwordx4 v[30:33], v2, s[4:7], s77 offen
    v_mfma_f32_16x16x32_bf16 v[188:191], a[108:111], v[144:147], v[188:191]
    s_cbranch_vccnz slow_200
ret_201:
    s_mov_b32 s71, s81
    v_mfma_f32_16x16x32_bf16 v[176:179], a[112:115], v[148:151], v[176:179]
    ds_read_b128 v[144:147], v7 offset:11264
    v_mfma_f32_16x16x32_bf16 v[180:183], a[116:119], v[148:151], v[180:183]
    buffer_load_dwordx4 v[38:41], v2, s[4:7], s71 offen sc1
    v_mfma_f32_16x16x32_bf16 v[184:187], a[120:123], v[148:151], v[184:187]
    buffer_load_dwordx2 v[42:43], v74, s[4:7], s71 offen offset:1024 sc1
    v_mfma_f32_16x16x32_bf16 v[188:191], a[124:127], v[148:151], v[188:191]
    s_add_u32 m0, s65, 0
    s_waitcnt lgkmcnt(2)
    v_mfma_f32_16x16x32_bf16 v[176:179], a[128:131], v[152:155], v[176:179]
    ds_read_b128 v[148:151], v7 offset:12288
    v_mfma_f32_16x16x32_bf16 v[180:183], a[132:135], v[152:155], v[180:183]
    buffer_load_dwordx4 v2, s[4:7], s75 offen offset:0 sc1 lds
    v_mfma_f32_16x16x32_bf16 v[184:187], a[136:139], v[152:155], v[184:187]
    buffer_load_dwordx4 v2, s[4:7], s75 offen offset:1024 sc1 lds
    v_mfma_f32_16x16x32_bf16 v[188:191], a[140:143], v[152:155], v[188:191]
    buffer_load_dwordx4 v2, s[4:7], s75 offen offset:2048 sc1 lds
    v_mfma_f32_16x16x32_bf16 v[176:179], a[144:147], v[156:159], v[176:179]
    ds_read_b128 v[152:155], v7 offset:13312
    v_mfma_f32_16x16x32_bf16 v[180:183], a[148:151], v[156:159], v[180:183]
    buffer_load_dwordx4 v2, s[4:7], s75 offen offset:3072 sc1 lds
    v_mfma_f32_16x16x32_bf16 v[184:187], a[152:155], v[156:159], v[184:187]
    s_add_u32 m0, s65, 4096
    v_mfma_f32_16x16x32_bf16 v[188:191], a[156:159], v[156:159], v[188:191]
    s_waitcnt lgkmcnt(2)
    buffer_load_dwordx4 v3, s[4:7], s75 offen offset:0 sc1 lds
    v_mfma_f32_16x16x32_bf16 v[176:179], a[160:163], v[140:143], v[176:179]
    s_add_u32 s64, s64, 20480
    ds_read_b128 v[156:159], v7 offset:14336
    s_sub_u32 s65, s64, s63
    v_mfma_f32_16x16x32_bf16 v[180:183], a[164:167], v[140:143], v[180:183]
    s_cmp_eq_u32 s65, 61440
    s_cselect_b32 s64, s63, s64
    s_add_u32 s65, s64, s66
    v_mfma_f32_16x16x32_bf16 v[184:187], a[168:171], v[140:143], v[184:187]
    s_cmp_lt_u32 s80, 30
    s_cselect_b32 s26, 20480, 0
    s_sub_u32 s78, s78, 1
    v_mfma_f32_16x16x32_bf16 v[188:191], a[172:175], v[140:143], v[188:191]
    s_add_u32 s26, s80, 2
    s_and_b32 s26, s26, 15
    v_mfma_f32_16x16x32_bf16 v[176:179], a[176:179], v[144:147], v[176:179]
    s_mul_i32 s26, s26, 20480
    ds_read_b128 v[140:143], v7 offset:15360
    s_add_u32 s75, s88, s26
    v_mfma_f32_16x16x32_bf16 v[180:183], a[180:183], v[144:147], v[180:183]
    s_waitcnt vmcnt(7)
    v_sub_u32_e64 v22, 64, s80
    s_mul_i32 s97, s80, 171
    v_mfma_f32_16x16x32_bf16 v[184:187], a[184:187], v[144:147], v[184:187]
    s_lshr_b32 s97, s97, 10
    buffer_store_dword v22, v21, s[4:7], s61 offen
    v_mfma_f32_16x16x32_bf16 v[188:191], a[188:191], v[144:147], v[188:191]
    s_mul_i32 s97, s97, 6
    s_sub_u32 s26, s80, s97
    s_waitcnt lgkmcnt(1)
    v_mfma_f32_16x16x32_bf16 v[176:179], a[192:195], v[148:151], v[176:179]
    s_mul_i32 s25, s26, 55296
    ds_read_b128 v[144:147], v7 offset:16384
    s_add_u32 s77, s25, s86
    v_mfma_f32_16x16x32_bf16 v[180:183], a[196:199], v[148:151], v[180:183]
    s_add_u32 s26, s80, 1
    s_and_b32 s26, s26, 15
    s_lshl_b32 s25, s26, 11
    v_mfma_f32_16x16x32_bf16 v[184:187], a[200:203], v[148:151], v[184:187]
    s_add_u32 s81, s25, s87
    s_add_u32 s80, s80, 1
    s_cmp_lt_u32 s80, 32
    v_mfma_f32_16x16x32_bf16 v[188:191], a[204:207], v[148:151], v[188:191]
    v_mfma_f32_16x16x32_bf16 v[176:179], a[208:211], v[152:155], v[176:179]
    ds_read_b128 v[148:151], v7 offset:17408
    v_mfma_f32_16x16x32_bf16 v[180:183], a[212:215], v[152:155], v[180:183]
    v_mfma_f32_16x16x32_bf16 v[184:187], a[216:219], v[152:155], v[184:187]
    v_mfma_f32_16x16x32_bf16 v[188:191], a[220:223], v[152:155], v[188:191]
    v_mfma_f32_16x16x32_bf16 v[176:179], a[224:227], v[156:159], v[176:179]
    ds_read_b128 v[152:155], v7 offset:18432
    v_mfma_f32_16x16x32_bf16 v[180:183], a[228:231], v[156:159], v[180:183]
    v_mfma_f32_16x16x32_bf16 v[184:187], a[232:235], v[156:159], v[184:187]
    v_mfma_f32_16x16x32_bf16 v[188:191], a[236:239], v[156:159], v[188:191]
    s_waitcnt lgkmcnt(2)
    v_mfma_f32_16x16x32_bf16 v[176:179], a[240:243], v[140:143], v[176:179]
    ds_read_b128 v[156:159], v7 offset:19456
    v_mfma_f32_16x16x32_bf16 v[180:183], a[244:247], v[140:143], v[180:183]
    s_waitcnt vmcnt(7)
    v_add_f32 v38, v38, v40
    v_add_f32 v39, v39, v41
    v_mfma_f32_16x16x32_bf16 v[184:187], a[248:251], v[140:143], v[184:187]
    s_waitcnt vmcnt(6)
    v_add_f32 v38, v38, v42
    v_add_f32 v39, v39, v43
    v_mfma_f32_16x16x32_bf16 v[188:191], a[252:255], v[140:143], v[188:191]
    v_mfma_f32_16x16x32_bf16 v[176:179], v[192:195], v[144:147], v[176:179]
    v_permlane32_swap_b32 v38, v39
    v_mfma_f32_16x16x32_bf16 v[180:183], v[196:199], v[144:147], v[180:183]
    v_add_f32 v38, v38, v39
    v_mov_b32 v39, v38
    v_mfma_f32_16x16x32_bf16 v[184:187], v[200:203], v[144:147], v[184:187]
    v_mfma_f32_16x16x32_bf16 v[188:191], v[204:207], v[144:147], v[188:191]
    s_waitcnt lgkmcnt(1)
    v_permlane16_swap_b32 v38, v39
    v_mfma_f32_16x16x32_bf16 v[176:179], v[208:211], v[148:151], v[176:179]
    v_add_f32 v38, v38, v39
    v_mov_b32 v39, v38
    v_mfma_f32_16x16x32_bf16 v[180:183], v[212:215], v[148:151], v[180:183]
    s_waitcnt vmcnt(1)
    s_barrier
    v_mfma_f32_16x16x32_bf16 v[184:187], v[216:219], v[148:151], v[184:187]
    ds_read_b128 v[140:143], v6 offset:0
    v_mfma_f32_16x16x32_bf16 v[188:191], v[220:223], v[148:151], v[188:191]
    ds_read_b128 v[144:147], v6 offset:1024
    v_mfma_f32_16x16x32_bf16 v[176:179], v[224:227], v[152:155], v[176:179]
    ds_read_b128 v[148:151], v6 offset:2048
    v_mfma_f32_16x16x32_bf16 v[180:183], v[228:231], v[152:155], v[180:183]
    v_permlane32_swap_b32 v38, v39
    v_mfma_f32_16x16x32_bf16 v[184:187], v[232:235], v[152:155], v[184:187]
    v_mul_f32 v72, s84, v38
    v_fma_f32 v38, v72, v72, -s85
    v_mfma_f32_16x16x32_bf16 v[188:191], v[236:239], v[152:155], v[188:191]
    s_waitcnt lgkmcnt(3)
    v_fma_f32 v39, v39, s84, -v38
    v_max_f32 v39, s85, v39
    v_mfma_f32_16x16x32_bf16 v[176:179], v[240:243], v[156:159], v[176:179]
    ds_read_b128 v[152:155], v6 offset:3072
    v_mfma_f32_16x16x32_bf16 v[180:183], v[244:247], v[156:159], v[180:183]
    v_rsq_f32 v73, v39
    v_mfma_f32_16x16x32_bf16 v[184:187], v[248:251], v[156:159], v[184:187]
    v_mul_f32 v73, v73, v73
    v_mfma_f32_16x16x32_bf16 v[188:191], v[252:255], v[156:159], v[188:191]
    s_cbranch_scc1 p3loop_190
gx_189:
F_p3:
    s_waitcnt lgkmcnt(0)
    s_nop 7
    v_fma_f32 v176, -v72, v56, v176
    v_fma_f32 v184, -v72, v64, v184
    v_mul_f32 v176, v73, v176
    v_mul_f32 v176, v176, v184
    v_fma_f32 v177, -v72, v57, v177
    v_fma_f32 v185, -v72, v65, v185
    v_mul_f32 v177, v73, v177
    v_mul_f32 v177, v177, v185
    v_cvt_pk_bf16_f32 v30, v176, v177
    v_fma_f32 v178, -v72, v58, v178
    v_fma_f32 v186, -v72, v66, v186
    v_mul_f32 v178, v73, v178
    v_mul_f32 v178, v178, v186
    v_fma_f32 v179, -v72, v59, v179
    v_fma_f32 v187, -v72, v67, v187
    v_mul_f32 v179, v73, v179
    v_mul_f32 v179, v179, v187
    v_cvt_pk_bf16_f32 v31, v178, v179
    v_fma_f32 v180, -v72, v60, v180
    v_fma_f32 v188, -v72, v68, v188
    v_mul_f32 v180, v73, v180
    v_mul_f32 v180, v180, v188
    v_fma_f32 v181, -v72, v61, v181
    v_fma_f32 v189, -v72, v69, v189
    v_mul_f32 v181, v73, v181
    v_mul_f32 v181, v181, v189
    v_cvt_pk_bf16_f32 v32, v180, v181
    v_fma_f32 v182, -v72, v62, v182
    v_fma_f32 v190, -v72, v70, v190
    v_mul_f32 v182, v73, v182
    v_mul_f32 v182, v182, v190
    v_fma_f32 v183, -v72, v63, v183
    v_fma_f32 v191, -v72, v71, v191
    v_mul_f32 v183, v73, v183
    v_mul_f32 v183, v183, v191
    v_cvt_pk_bf16_f32 v33, v182, v183
    buffer_store_dwordx4 v[30:33], v2, s[4:7], s77 offen
    s_waitcnt vmcnt(0)
    v_sub_u32_e64 v22, 64, s80
    s_bitcmp1_b32 s20, 0
    s_cbranch_scc1 pub_254
pubr_255:
    buffer_store_dword v22, v21, s[4:7], s61 offen
    s_cmp_lg_u32 s55, 0
    s_cbranch_scc1 Dp3
    s_endpgm
pair_188:
    s_add_u32 m0, s65, 0
    s_nop 0
    buffer_load_dwordx4 v2, s[4:7], s75 offen offset:0 sc1 lds
    buffer_load_dwordx4 v2, s[4:7], s75 offen offset:1024 sc1 lds
    buffer_load_dwordx4 v2, s[4:7], s75 offen offset:2048 sc1 lds
    buffer_load_dwordx4 v2, s[4:7], s75 offen offset:3072 sc1 lds
    s_add_u32 m0, s65, 4096
    s_nop 0
    buffer_load_dwordx4 v3, s[4:7], s75 offen offset:0 sc1 lds
    s_add_u32 m0, s65, 10240
    s_nop 0
    buffer_load_dwordx4 v4, s[4:7], s75 offen offset:0 sc1 lds
    buffer_load_dwordx4 v4, s[4:7], s75 offen offset:1024 sc1 lds
    buffer_load_dwordx4 v4, s[4:7], s75 offen offset:2048 sc1 lds
    buffer_load_dwordx4 v4, s[4:7], s75 offen offset:3072 sc1 lds
    s_add_u32 m0, s65, 14336
    s_nop 0
    buffer_load_dwordx4 v5, s[4:7], s75 offen offset:0 sc1 lds
    s_mov_b32 s78, 62
    buffer_load_dwordx4 v[24:27], v20, s[4:7], s79 offen sc1
    s_add_u32 s75, s75, 20480
    s_add_u32 s64, s64, 20480
    s_sub_u32 s65, s64, s63
    s_cmp_eq_u32 s65, 61440
    s_cselect_b32 s64, s63, s64
    s_add_u32 s65, s64, s66
    s_add_u32 s73, s73, 1
    v_mov_b32 v15, s73
    s_waitcnt vmcnt(0)
    ds_write_b32 v13, v15
    s_mov_b32 s29, 0
sys_252:
    ds_read_b32 v16, v14
    s_waitcnt lgkmcnt(0)
    v_readfirstlane_b32 s67, v16
    s_nop 0
    s_cmp_lt_u32 s67, s73
    s_cbranch_scc0 syd_253
    s_add_u32 s29, s29, 1
    s_cmp_lt_u32 s29, 160000
    s_cbranch_scc1 sys_252
    s_mov_b32 s29, 35
    s_branch L_fail
syd_253:
    ds_read_b128 v[140:143], v6 offset:0
    ds_read_b128 v[144:147], v6 offset:1024
    ds_read_b128 v[148:151], v6 offset:2048
    ds_read_b128 v[152:155], v6 offset:3072
    s_waitcnt lgkmcnt(0)
p3mloop_211:
    s_waitcnt lgkmcnt(3)
    v_mfma_f32_16x16x32_bf16 v[160:163], a[0:3], v[140:143], 0
    s_add_u32 s73, s73, 1
    ds_read_b128 v[156:159], v6 offset:4096
    v_mov_b32 v15, s73
    v_mfma_f32_16x16x32_bf16 v[164:167], a[4:7], v[140:143], 0
    s_waitcnt vmcnt(3)
    v_max3_u32 v28, v24, v25, v26
    v_max3_u32 v28, v28, v27, s20
    v_mfma_f32_16x16x32_bf16 v[168:171], a[8:11], v[140:143], 0
    v_add_u32 v29, s78, v23
    v_cmp_lt_u32 vcc, v29, v28
    v_mfma_f32_16x16x32_bf16 v[172:175], a[12:15], v[140:143], 0
    s_waitcnt lgkmcnt(2)
    v_fma_f32 v176, -v72, v56, v176
    v_fma_f32 v184, -v72, v64, v184
    v_mfma_f32_16x16x32_bf16 v[160:163], a[16:19], v[144:147], v[160:163]
    s_cmp_eq_u64 vcc, 0
    ds_read_b128 v[140:143], v6 offset:5120
    v_mul_f32 v176, v73, v176
    v_mfma_f32_16x16x32_bf16 v[164:167], a[20:23], v[144:147], v[164:167]
    s_cselect_b32 s76, s75, 0x2000000
    v_mul_f32 v176, v176, v184
    v_fma_f32 v177, -v72, v57, v177
    v_mfma_f32_16x16x32_bf16 v[168:171], a[24:27], v[144:147], v[168:171]
    s_cselect_b32 s71, s81, 0x2000000
    buffer_load_dwordx4 v[24:27], v20, s[4:7], s79 offen sc1
    v_mfma_f32_16x16x32_bf16 v[172:175], a[28:31], v[144:147], v[172:175]
    v_fma_f32 v185, -v72, v65, v185
    v_mul_f32 v177, v73, v177
    v_mfma_f32_16x16x32_bf16 v[160:163], a[32:35], v[148:151], v[160:163]
    s_waitcnt vmcnt(1)
    ds_read_b128 v[144:147], v6 offset:6144
    v_mul_f32 v177, v177, v185
    v_mfma_f32_16x16x32_bf16 v[164:167], a[36:39], v[148:151], v[164:167]
    s_add_u32 m0, s65, 0
    ds_write_b32 v13, v15
    v_mfma_f32_16x16x32_bf16 v[168:171], a[40:43], v[148:151], v[168:171]
    buffer_load_dwordx4 v2, s[4:7], s76 offen offset:0 sc1 lds
    v_mfma_f32_16x16x32_bf16 v[172:175], a[44:47], v[148:151], v[172:175]
    s_waitcnt lgkmcnt(2)
    buffer_load_dwordx4 v2, s[4:7], s76 offen offset:1024 sc1 lds
    v_mfma_f32_16x16x32_bf16 v[160:163], a[48:51], v[152:155], v[160:163]
    ds_read_b128 v[148:151], v6 offset:7168
    v_cvt_pk_bf16_f32 v30, v176, v177
    v_mfma_f32_16x16x32_bf16 v[164:167], a[52:55], v[152:155], v[164:167]
    buffer_load_dwordx4 v2, s[4:7], s76 offen offset:2048 sc1 lds
    v_mfma_f32_16x16x32_bf16 v[168:171], a[56:59], v[152:155], v[168:171]
    ds_read_b32 v16, v14
    v_fma_f32 v178, -v72, v58, v178
    v_mfma_f32_16x16x32_bf16 v[172:175], a[60:63], v[152:155], v[172:175]
    v_fma_f32 v186, -v72, v66, v186
    v_mul_f32 v178, v73, v178
    v_mfma_f32_16x16x32_bf16 v[160:163], a[64:67], v[156:159], v[160:163]
    ds_read_b128 v[152:155], v6 offset:8192
    v_mul_f32 v178, v178, v186
    v_mfma_f32_16x16x32_bf16 v[164:167], a[68:71], v[156:159], v[164:167]
    v_fma_f32 v179, -v72, v59, v179
    v_fma_f32 v187, -v72, v67, v187
    v_mfma_f32_16x16x32_bf16 v[168:171], a[72:75], v[156:159], v[168:171]
    buffer_load_dwordx4 v2, s[4:7], s76 offen offset:3072 sc1 lds
    v_mfma_f32_16x16x32_bf16 v[172:175], a[76:79], v[156:159], v[172:175]
    v_mul_f32 v179, v73, v179
    v_mul_f32 v179, v179, v187
    v_mfma_f32_16x16x32_bf16 v[160:163], a[80:83], v[140:143], v[160:163]
    s_add_u32 m0, s65, 4096
    ds_read_b128 v[156:159], v6 offset:9216
    s_waitcnt lgkmcnt(2)
    v_readfirstlane_b32 s67, v16
    v_mfma_f32_16x16x32_bf16 v[164:167], a[84:87], v[140:143], v[164:167]
    s_cmp_lt_u32 s67, s73
    v_cvt_pk_bf16_f32 v31, v178, v179
    v_fma_f32 v180, -v72, v60, v180
    v_mfma_f32_16x16x32_bf16 v[168:171], a[88:91], v[140:143], v[168:171]
    s_cbranch_scc1 syw_224
syr_225:
    v_add_u32 v7, s64, v2
    v_fma_f32 v188, -v72, v68, v188
    v_mfma_f32_16x16x32_bf16 v[172:175], a[92:95], v[140:143], v[172:175]
    buffer_load_dwordx4 v3, s[4:7], s76 offen offset:0 sc1 lds
    v_mfma_f32_16x16x32_bf16 v[160:163], a[96:99], v[144:147], v[160:163]
    s_add_u32 s73, s73, 1
    ds_read_b128 v[140:143], v6 offset:10240
    v_mov_b32 v15, s73
    v_mfma_f32_16x16x32_bf16 v[164:167], a[100:103], v[144:147], v[164:167]
    buffer_load_dwordx4 v[38:41], v2, s[4:7], s71 offen sc1
    v_mfma_f32_16x16x32_bf16 v[168:171], a[104:107], v[144:147], v[168:171]
    buffer_load_dwordx2 v[42:43], v74, s[4:7], s71 offen offset:1024 sc1
    v_mfma_f32_16x16x32_bf16 v[172:175], a[108:111], v[144:147], v[172:175]
    v_mul_f32 v180, v73, v180
    v_mul_f32 v180, v180, v188
    v_mfma_f32_16x16x32_bf16 v[160:163], a[112:115], v[148:151], v[160:163]
    ds_read_b128 v[144:147], v6 offset:11264
    v_fma_f32 v181, -v72, v61, v181
    v_mfma_f32_16x16x32_bf16 v[164:167], a[116:119], v[148:151], v[164:167]
    v_fma_f32 v189, -v72, v69, v189
    v_mul_f32 v181, v73, v181
    v_mfma_f32_16x16x32_bf16 v[168:171], a[120:123], v[148:151], v[168:171]
    v_mul_f32 v181, v181, v189
    v_cvt_pk_bf16_f32 v32, v180, v181
    v_mfma_f32_16x16x32_bf16 v[172:175], a[124:127], v[148:151], v[172:175]
    s_waitcnt lgkmcnt(1)
    v_fma_f32 v182, -v72, v62, v182
    v_fma_f32 v190, -v72, v70, v190
    v_mfma_f32_16x16x32_bf16 v[160:163], a[128:131], v[152:155], v[160:163]
    ds_read_b128 v[148:151], v6 offset:12288
    v_mul_f32 v182, v73, v182
    v_mfma_f32_16x16x32_bf16 v[164:167], a[132:135], v[152:155], v[164:167]
    v_mul_f32 v182, v182, v190
    v_fma_f32 v183, -v72, v63, v183
    v_mfma_f32_16x16x32_bf16 v[168:171], a[136:139], v[152:155], v[168:171]
    v_fma_f32 v191, -v72, v71, v191
    v_mul_f32 v183, v73, v183
    v_mfma_f32_16x16x32_bf16 v[172:175], a[140:143], v[152:155], v[172:175]
    v_mul_f32 v183, v183, v191
    v_cvt_pk_bf16_f32 v33, v182, v183
    v_mfma_f32_16x16x32_bf16 v[160:163], a[144:147], v[156:159], v[160:163]
    ds_read_b128 v[152:155], v6 offset:13312
    v_mfma_f32_16x16x32_bf16 v[164:167], a[148:151], v[156:159], v[164:167]
    buffer_store_dwordx4 v[30:33], v2, s[4:7], s77 offen
    v_mfma_f32_16x16x32_bf16 v[168:171], a[152:155], v[156:159], v[168:171]
    s_cbranch_vccnz late_212
later_213:
    s_add_u32 m0, s65, 10240
    s_cmp_lt_u32 s80, 30
    v_mfma_f32_16x16x32_bf16 v[172:175], a[156:159], v[156:159], v[172:175]
    buffer_load_dwordx4 v4, s[4:7], s76 offen offset:0 sc1 lds
    v_mfma_f32_16x16x32_bf16 v[160:163], a[160:163], v[140:143], v[160:163]
    s_cselect_b32 s26, 20480, 0
    ds_read_b128 v[156:159], v6 offset:14336
    s_sub_u32 s78, s78, 1
    v_mfma_f32_16x16x32_bf16 v[164:167], a[164:167], v[140:143], v[164:167]
    s_add_u32 s26, s80, 2
    s_and_b32 s26, s26, 15
    s_mul_i32 s26, s26, 20480
    v_mfma_f32_16x16x32_bf16 v[168:171], a[168:171], v[140:143], v[168:171]
    s_add_u32 s75, s88, s26
    s_mul_i32 s97, s80, 171
    s_lshr_b32 s97, s97, 10
    v_mfma_f32_16x16x32_bf16 v[172:175], a[172:175], v[140:143], v[172:175]
    s_mul_i32 s97, s97, 6
    s_sub_u32 s26, s80, s97
    s_waitcnt lgkmcnt(1)
    v_mfma_f32_16x16x32_bf16 v[160:163], a[176:179], v[144:147], v[160:163]
    s_mul_i32 s25, s26, 55296
    ds_read_b128 v[140:143], v6 offset:15360
    s_add_u32 s77, s25, s86
    v_mfma_f32_16x16x32_bf16 v[164:167], a[180:183], v[144:147], v[164:167]
    s_add_u32 s26, s80, 1
    buffer_load_dwordx4 v4, s[4:7], s76 offen offset:1024 sc1 lds
    v_mfma_f32_16x16x32_bf16 v[168:171], a[184:187], v[144:147], v[168:171]
    s_and_b32 s26, s26, 15
    s_lshl_b32 s25, s26, 11
    s_add_u32 s81, s25, s87
    v_mfma_f32_16x16x32_bf16 v[172:175], a[188:191], v[144:147], v[172:175]
    v_mfma_f32_16x16x32_bf16 v[160:163], a[192:195], v[148:151], v[160:163]
    ds_read_b128 v[144:147], v6 offset:16384
    v_mfma_f32_16x16x32_bf16 v[164:167], a[196:199], v[148:151], v[164:167]
    s_cbranch_vccnz sw_222
swr_223:
    s_waitcnt vmcnt(5)
    v_mfma_f32_16x16x32_bf16 v[168:171], a[200:203], v[148:151], v[168:171]
    ds_write_b32 v13, v15
    v_mfma_f32_16x16x32_bf16 v[172:175], a[204:207], v[148:151], v[172:175]
    buffer_load_dwordx4 v4, s[4:7], s76 offen offset:2048 sc1 lds
    v_mfma_f32_16x16x32_bf16 v[160:163], a[208:211], v[152:155], v[160:163]
    ds_read_b128 v[148:151], v6 offset:17408
    v_mfma_f32_16x16x32_bf16 v[164:167], a[212:215], v[152:155], v[164:167]
    buffer_load_dwordx4 v[24:27], v20, s[4:7], s79 offen sc1
    v_mfma_f32_16x16x32_bf16 v[168:171], a[216:219], v[152:155], v[168:171]
    v_mfma_f32_16x16x32_bf16 v[172:175], a[220:223], v[152:155], v[172:175]
    s_waitcnt lgkmcnt(3)
    v_mfma_f32_16x16x32_bf16 v[160:163], a[224:227], v[156:159], v[160:163]
    ds_read_b128 v[152:155], v6 offset:18432
    v_mfma_f32_16x16x32_bf16 v[164:167], a[228:231], v[156:159], v[164:167]
    buffer_load_dwordx4 v4, s[4:7], s76 offen offset:3072 sc1 lds
    v_mfma_f32_16x16x32_bf16 v[168:171], a[232:235], v[156:159], v[168:171]
    s_add_u32 m0, s65, 14336
    s_waitcnt vmcnt(7)
    v_add_f32 v38, v38, v40
    v_add_f32 v39, v39, v41
    v_mfma_f32_16x16x32_bf16 v[172:175], a[236:239], v[156:159], v[172:175]
    s_waitcnt vmcnt(6)
    v_add_f32 v38, v38, v42
    v_add_f32 v39, v39, v43
    v_mfma_f32_16x16x32_bf16 v[160:163], a[240:243], v[140:143], v[160:163]
    s_waitcnt vmcnt(5)
    ds_read_b128 v[156:159], v6 offset:19456
    ds_read_b32 v16, v14
    v_mfma_f32_16x16x32_bf16 v[164:167], a[244:247], v[140:143], v[164:167]
    v_sub_u32_e64 v22, 64, s80
    s_add_u32 s80, s80, 1
    v_mfma_f32_16x16x32_bf16 v[168:171], a[248:251], v[140:143], v[168:171]
    buffer_store_dword v22, v21, s[4:7], s61 offen
    v_mfma_f32_16x16x32_bf16 v[172:175], a[252:255], v[140:143], v[172:175]
    s_waitcnt lgkmcnt(2)
    buffer_load_dwordx4 v5, s[4:7], s76 offen offset:0 sc1 lds
    v_mfma_f32_16x16x32_bf16 v[160:163], v[192:195], v[144:147], v[160:163]
    s_add_u32 s64, s64, 20480
    v_permlane32_swap_b32 v38, v39
    v_mfma_f32_16x16x32_bf16 v[164:167], v[196:199], v[144:147], v[164:167]
    s_sub_u32 s65, s64, s63
    v_add_f32 v38, v38, v39
    v_mov_b32 v39, v38
    v_mfma_f32_16x16x32_bf16 v[168:171], v[200:203], v[144:147], v[168:171]
    s_cmp_eq_u32 s65, 61440
    s_waitcnt lgkmcnt(0)
    v_readfirstlane_b32 s67, v16
    s_cselect_b32 s64, s63, s64
    v_mfma_f32_16x16x32_bf16 v[172:175], v[204:207], v[144:147], v[172:175]
    v_permlane16_swap_b32 v38, v39
    v_mfma_f32_16x16x32_bf16 v[160:163], v[208:211], v[148:151], v[160:163]
    s_cmp_lt_u32 s67, s73
    v_add_f32 v38, v38, v39
    v_mov_b32 v39, v38
    v_mfma_f32_16x16x32_bf16 v[164:167], v[212:215], v[148:151], v[164:167]
    s_cbranch_scc1 syw_228
syr_229:
    v_permlane32_swap_b32 v38, v39
    v_mfma_f32_16x16x32_bf16 v[168:171], v[216:219], v[148:151], v[168:171]
    s_add_u32 s65, s64, s66
    ds_read_b128 v[140:143], v7 offset:0
    v_mul_f32 v72, s84, v38
    v_mfma_f32_16x16x32_bf16 v[172:175], v[220:223], v[148:151], v[172:175]
    ds_read_b128 v[144:147], v7 offset:1024
    v_fma_f32 v38, v72, v72, -s85
    v_mfma_f32_16x16x32_bf16 v[160:163], v[224:227], v[152:155], v[160:163]
    ds_read_b128 v[148:151], v7 offset:2048
    v_fma_f32 v39, v39, s84, -v38
    v_mfma_f32_16x16x32_bf16 v[164:167], v[228:231], v[152:155], v[164:167]
    v_max_f32 v39, s85, v39
    v_mfma_f32_16x16x32_bf16 v[168:171], v[232:235], v[152:155], v[168:171]
    v_rsq_f32 v73, v39
    v_mfma_f32_16x16x32_bf16 v[172:175], v[236:239], v[152:155], v[172:175]
    v_mul_f32 v73, v73, v73
    v_mfma_f32_16x16x32_bf16 v[160:163], v[240:243], v[156:159], v[160:163]
    ds_read_b128 v[152:155], v7 offset:3072
    v_mfma_f32_16x16x32_bf16 v[164:167], v[244:247], v[156:159], v[164:167]
    v_mfma_f32_16x16x32_bf16 v[168:171], v[248:251], v[156:159], v[168:171]
    v_mfma_f32_16x16x32_bf16 v[172:175], v[252:255], v[156:159], v[172:175]
    s_waitcnt lgkmcnt(3)
    v_mfma_f32_16x16x32_bf16 v[176:179], a[0:3], v[140:143], 0
    s_add_u32 s73, s73, 1
    ds_read_b128 v[156:159], v7 offset:4096
    v_mov_b32 v15, s73
    v_mfma_f32_16x16x32_bf16 v[180:183], a[4:7], v[140:143], 0
    s_waitcnt vmcnt(3)
    v_max3_u32 v28, v24, v25, v26
    v_max3_u32 v28, v28, v27, s20
    v_mfma_f32_16x16x32_bf16 v[184:187], a[8:11], v[140:143], 0
    v_add_u32 v29, s78, v23
    v_cmp_lt_u32 vcc, v29, v28
    v_mfma_f32_16x16x32_bf16 v[188:191], a[12:15], v[140:143], 0
    s_waitcnt lgkmcnt(2)
    v_fma_f32 v160, -v72, v56, v160
    v_fma_f32 v168, -v72, v64, v168
    v_mfma_f32_16x16x32_bf16 v[176:179], a[16:19], v[144:147], v[176:179]
    s_cmp_eq_u64 vcc, 0
    ds_read_b128 v[140:143], v7 offset:5120
    v_mul_f32 v160, v73, v160
    v_mfma_f32_16x16x32_bf16 v[180:183], a[20:23], v[144:147], v[180:183]
    s_cselect_b32 s76, s75, 0x2000000
    v_mul_f32 v160, v160, v168
    v_fma_f32 v161, -v72, v57, v161
    v_mfma_f32_16x16x32_bf16 v[184:187], a[24:27], v[144:147], v[184:187]
    s_cselect_b32 s71, s81, 0x2000000
    buffer_load_dwordx4 v[24:27], v20, s[4:7], s79 offen sc1
    v_mfma_f32_16x16x32_bf16 v[188:191], a[28:31], v[144:147], v[188:191]
    v_fma_f32 v169, -v72, v65, v169
    v_mul_f32 v161, v73, v161
    v_mfma_f32_16x16x32_bf16 v[176:179], a[32:35], v[148:151], v[176:179]
    s_waitcnt vmcnt(1)
    ds_read_b128 v[144:147], v7 offset:6144
    v_mul_f32 v161, v161, v169
    v_mfma_f32_16x16x32_bf16 v[180:183], a[36:39], v[148:151], v[180:183]
    s_add_u32 m0, s65, 0
    ds_write_b32 v13, v15
    v_mfma_f32_16x16x32_bf16 v[184:187], a[40:43], v[148:151], v[184:187]
    buffer_load_dwordx4 v2, s[4:7], s76 offen offset:0 sc1 lds
    v_mfma_f32_16x16x32_bf16 v[188:191], a[44:47], v[148:151], v[188:191]
    s_waitcnt lgkmcnt(2)
    buffer_load_dwordx4 v2, s[4:7], s76 offen offset:1024 sc1 lds
    v_mfma_f32_16x16x32_bf16 v[176:179], a[48:51], v[152:155], v[176:179]
    ds_read_b128 v[148:151], v7 offset:7168
    v_cvt_pk_bf16_f32 v30, v160, v161
    v_mfma_f32_16x16x32_bf16 v[180:183], a[52:55], v[152:155], v[180:183]
    buffer_load_dwordx4 v2, s[4:7], s76 offen offset:2048 sc1 lds
    v_mfma_f32_16x16x32_bf16 v[184:187], a[56:59], v[152:155], v[184:187]
    ds_read_b32 v16, v14
    v_fma_f32 v162, -v72, v58, v162
    v_mfma_f32_16x16x32_bf16 v[188:191], a[60:63], v[152:155], v[188:191]
    v_fma_f32 v170, -v72, v66, v170
    v_mul_f32 v162, v73, v162
    v_mfma_f32_16x16x32_bf16 v[176:179], a[64:67], v[156:159], v[176:179]
    ds_read_b128 v[152:155], v7 offset:8192
    v_mul_f32 v162, v162, v170
    v_mfma_f32_16x16x32_bf16 v[180:183], a[68:71], v[156:159], v[180:183]
    v_fma_f32 v163, -v72, v59, v163
    v_fma_f32 v171, -v72, v67, v171
    v_mfma_f32_16x16x32_bf16 v[184:187], a[72:75], v[156:159], v[184:187]
    buffer_load_dwordx4 v2, s[4:7], s76 offen offset:3072 sc1 lds
    v_mfma_f32_16x16x32_bf16 v[188:191], a[76:79], v[156:159], v[188:191]
    v_mul_f32 v163, v73, v163
    v_mul_f32 v163, v163, v171
    v_mfma_f32_16x16x32_bf16 v[176:179], a[80:83], v[140:143], v[176:179]
    s_add_u32 m0, s65, 4096
    ds_read_b128 v[156:159], v7 offset:9216
    s_waitcnt lgkmcnt(2)
    v_readfirstlane_b32 s67, v16
    v_mfma_f32_16x16x32_bf16 v[180:183], a[84:87], v[140:143], v[180:183]
    s_cmp_lt_u32 s67, s73
    v_cvt_pk_bf16_f32 v31, v162, v163
    v_fma_f32 v164, -v72, v60, v164
    v_mfma_f32_16x16x32_bf16 v[184:187], a[88:91], v[140:143], v[184:187]
    s_cbranch_scc1 syw_244
syr_245:
    v_add_u32 v6, s64, v2
    v_fma_f32 v172, -v72, v68, v172
    v_mfma_f32_16x16x32_bf16 v[188:191], a[92:95], v[140:143], v[188:191]
    buffer_load_dwordx4 v3, s[4:7], s76 offen offset:0 sc1 lds
    v_mfma_f32_16x16x32_bf16 v[176:179], a[96:99], v[144:147], v[176:179]
    s_add_u32 s73, s73, 1
    ds_read_b128 v[140:143], v7 offset:10240
    v_mov_b32 v15, s73
    v_mfma_f32_16x16x32_bf16 v[180:183], a[100:103], v[144:147], v[180:183]
    buffer_load_dwordx4 v[38:41], v2, s[4:7], s71 offen sc1
    v_mfma_f32_16x16x32_bf16 v[184:187], a[104:107], v[144:147], v[184:187]
    buffer_load_dwordx2 v[42:43], v74, s[4:7], s71 offen offset:1024 sc1
    v_mfma_f32_16x16x32_bf16 v[188:191], a[108:111], v[144:147], v[188:191]
    v_mul_f32 v164, v73, v164
    v_mul_f32 v164, v164, v172
    v_mfma_f32_16x16x32_bf16 v[176:179], a[112:115], v[148:151], v[176:179]
    ds_read_b128 v[144:147], v7 offset:11264
    v_fma_f32 v165, -v72, v61, v165
    v_mfma_f32_16x16x32_bf16 v[180:183], a[116:119], v[148:151], v[180:183]
    v_fma_f32 v173, -v72, v69, v173
    v_mul_f32 v165, v73, v165
    v_mfma_f32_16x16x32_bf16 v[184:187], a[120:123], v[148:151], v[184:187]
    v_mul_f32 v165, v165, v173
    v_cvt_pk_bf16_f32 v32, v164, v165
    v_mfma_f32_16x16x32_bf16 v[188:191], a[124:127], v[148:151], v[188:191]
    s_waitcnt lgkmcnt(1)
    v_fma_f32 v166, -v72, v62, v166
    v_fma_f32 v174, -v72, v70, v174
    v_mfma_f32_16x16x32_bf16 v[176:179], a[128:131], v[152:155], v[176:179]
    ds_read_b128 v[148:151], v7 offset:12288
    v_mul_f32 v166, v73, v166
    v_mfma_f32_16x16x32_bf16 v[180:183], a[132:135], v[152:155], v[180:183]
    v_mul_f32 v166, v166, v174
    v_fma_f32 v167, -v72, v63, v167
    v_mfma_f32_16x16x32_bf16 v[184:187], a[136:139], v[152:155], v[184:187]
    v_fma_f32 v175, -v72, v71, v175
    v_mul_f32 v167, v73, v167
    v_mfma_f32_16x16x32_bf16 v[188:191], a[140:143], v[152:155], v[188:191]
    v_mul_f32 v167, v167, v175
    v_cvt_pk_bf16_f32 v33, v166, v167
    v_mfma_f32_16x16x32_bf16 v[176:179], a[144:147], v[156:159], v[176:179]
    ds_read_b128 v[152:155], v7 offset:13312
    v_mfma_f32_16x16x32_bf16 v[180:183], a[148:151], v[156:159], v[180:183]
    buffer_store_dwordx4 v[30:33], v2, s[4:7], s77 offen
    v_mfma_f32_16x16x32_bf16 v[184:187], a[152:155], v[156:159], v[184:187]
    s_cbranch_vccnz late_232
later_233:
    s_add_u32 m0, s65, 10240
    s_cmp_lt_u32 s80, 30
    v_mfma_f32_16x16x32_bf16 v[188:191], a[156:159], v[156:159], v[188:191]
    buffer_load_dwordx4 v4, s[4:7], s76 offen offset:0 sc1 lds
    v_mfma_f32_16x16x32_bf16 v[176:179], a[160:163], v[140:143], v[176:179]
    s_cselect_b32 s26, 20480, 0
    ds_read_b128 v[156:159], v7 offset:14336
    s_sub_u32 s78, s78, 1
    v_mfma_f32_16x16x32_bf16 v[180:183], a[164:167], v[140:143], v[180:183]
    s_add_u32 s26, s80, 2
    s_and_b32 s26, s26, 15
    s_mul_i32 s26, s26, 20480
    v_mfma_f32_16x16x32_bf16 v[184:187], a[168:171], v[140:143], v[184:187]
    s_add_u32 s75, s88, s26
    s_mul_i32 s97, s80, 171
    s_lshr_b32 s97, s97, 10
    v_mfma_f32_16x16x32_bf16 v[188:191], a[172:175], v[140:143], v[188:191]
    s_mul_i32 s97, s97, 6
    s_sub_u32 s26, s80, s97
    s_waitcnt lgkmcnt(1)
    v_mfma_f32_16x16x32_bf16 v[176:179], a[176:179], v[144:147], v[176:179]
    s_mul_i32 s25, s26, 55296
    ds_read_b128 v[140:143], v7 offset:15360
    s_add_u32 s77, s25, s86
    v_mfma_f32_16x16x32_bf16 v[180:183], a[180:183], v[144:147], v[180:183]
    s_add_u32 s26, s80, 1
    buffer_load_dwordx4 v4, s[4:7], s76 offen offset:1024 sc1 lds
    v_mfma_f32_16x16x32_bf16 v[184:187], a[184:187], v[144:147], v[184:187]
    s_and_b32 s26, s26, 15
    s_lshl_b32 s25, s26, 11
    s_add_u32 s81, s25, s87
    v_mfma_f32_16x16x32_bf16 v[188:191], a[188:191], v[144:147], v[188:191]
    v_mfma_f32_16x16x32_bf16 v[176:179], a[192:195], v[148:151], v[176:179]
    ds_read_b128 v[144:147], v7 offset:16384
    v_mfma_f32_16x16x32_bf16 v[180:183], a[196:199], v[148:151], v[180:183]
    s_cbranch_vccnz sw_242
swr_243:
    s_waitcnt vmcnt(5)
    v_mfma_f32_16x16x32_bf16 v[184:187], a[200:203], v[148:151], v[184:187]
    ds_write_b32 v13, v15
    v_mfma_f32_16x16x32_bf16 v[188:191], a[204:207], v[148:151], v[188:191]
    buffer_load_dwordx4 v4, s[4:7], s76 offen offset:2048 sc1 lds
    v_mfma_f32_16x16x32_bf16 v[176:179], a[208:211], v[152:155], v[176:179]
    ds_read_b128 v[148:151], v7 offset:17408
    v_mfma_f32_16x16x32_bf16 v[180:183], a[212:215], v[152:155], v[180:183]
    buffer_load_dwordx4 v[24:27], v20, s[4:7], s79 offen sc1
    v_mfma_f32_16x16x32_bf16 v[184:187], a[216:219], v[152:155], v[184:187]
    v_mfma_f32_16x16x32_bf16 v[188:191], a[220:223], v[152:155], v[188:191]
    s_waitcnt lgkmcnt(3)
    v_mfma_f32_16x16x32_bf16 v[176:179], a[224:227], v[156:159], v[176:179]
    ds_read_b128 v[152:155], v7 offset:18432
    v_mfma_f32_16x16x32_bf16 v[180:183], a[228:231], v[156:159], v[180:183]
    buffer_load_dwordx4 v4, s[4:7], s76 offen offset:3072 sc1 lds
    v_mfma_f32_16x16x32_bf16 v[184:187], a[232:235], v[156:159], v[184:187]
    s_add_u32 m0, s65, 14336
    s_waitcnt vmcnt(7)
    v_add_f32 v38, v38, v40
    v_add_f32 v39, v39, v41
    v_mfma_f32_16x16x32_bf16 v[188:191], a[236:239], v[156:159], v[188:191]
    s_waitcnt vmcnt(6)
    v_add_f32 v38, v38, v42
    v_add_f32 v39, v39, v43
    v_mfma_f32_16x16x32_bf16 v[176:179], a[240:243], v[140:143], v[176:179]
    s_waitcnt vmcnt(5)
    ds_read_b128 v[156:159], v7 offset:19456
    ds_read_b32 v16, v14
    v_mfma_f32_16x16x32_bf16 v[180:183], a[244:247], v[140:143], v[180:183]
    v_sub_u32_e64 v22, 64, s80
    s_add_u32 s80, s80, 1
    v_mfma_f32_16x16x32_bf16 v[184:187], a[248:251], v[140:143], v[184:187]
    buffer_store_dword v22, v21, s[4:7], s61 offen
    v_mfma_f32_16x16x32_bf16 v[188:191], a[252:255], v[140:143], v[188:191]
    s_waitcnt lgkmcnt(2)
    buffer_load_dwordx4 v5, s[4:7], s76 offen offset:0 sc1 lds
    v_mfma_f32_16x16x32_bf16 v[176:179], v[192:195], v[144:147], v[176:179]
    s_add_u32 s64, s64, 20480
    v_permlane32_swap_b32 v38, v39
    v_mfma_f32_16x16x32_bf16 v[180:183], v[196:199], v[144:147], v[180:183]
    s_sub_u32 s65, s64, s63
    v_add_f32 v38, v38, v39
    v_mov_b32 v39, v38
    v_mfma_f32_16x16x32_bf16 v[184:187], v[200:203], v[144:147], v[184:187]
    s_cmp_eq_u32 s65, 61440
    s_waitcnt lgkmcnt(0)
    v_readfirstlane_b32 s67, v16
    s_cselect_b32 s64, s63, s64
    v_mfma_f32_16x16x32_bf16 v[188:191], v[204:207], v[144:147], v[188:191]
    v_permlane16_swap_b32 v38, v39
    v_mfma_f32_16x16x32_bf16 v[176:179], v[208:211], v[148:151], v[176:179]
    s_cmp_lt_u32 s67, s73
    v_add_f32 v38, v38, v39
    v_mov_b32 v39, v38
    v_mfma_f32_16x16x32_bf16 v[180:183], v[212:215], v[148:151], v[180:183]
    s_cbranch_scc1 syw_248
syr_249:
    v_permlane32_swap_b32 v38, v39
    v_mfma_f32_16x16x32_bf16 v[184:187], v[216:219], v[148:151], v[184:187]
    s_add_u32 s65, s64, s66
    ds_read_b128 v[140:143], v6 offset:0
    v_mul_f32 v72, s84, v38
    v_mfma_f32_16x16x32_bf16 v[188:191], v[220:223], v[148:151], v[188:191]
    ds_read_b128 v[144:147], v6 offset:1024
    v_fma_f32 v38, v72, v72, -s85
    v_mfma_f32_16x16x32_bf16 v[176:179], v[224:227], v[152:155], v[176:179]
    s_cmp_lt_u32 s80, 32
    ds_read_b128 v[148:151], v6 offset:2048
    v_fma_f32 v39, v39, s84, -v38
    v_mfma_f32_16x16x32_bf16 v[180:183], v[228:231], v[152:155], v[180:183]
    v_max_f32 v39, s85, v39
    v_mfma_f32_16x16x32_bf16 v[184:187], v[232:235], v[152:155], v[184:187]
    v_rsq_f32 v73, v39
    v_mfma_f32_16x16x32_bf16 v[188:191], v[236:239], v[152:155], v[188:191]
    v_mul_f32 v73, v73, v73
    v_mfma_f32_16x16x32_bf16 v[176:179], v[240:243], v[156:159], v[176:179]
    ds_read_b128 v[152:155], v6 offset:3072
    v_mfma_f32_16x16x32_bf16 v[180:183], v[244:247], v[156:159], v[180:183]
    v_mfma_f32_16x16x32_bf16 v[184:187], v[248:251], v[156:159], v[184:187]
    v_mfma_f32_16x16x32_bf16 v[188:191], v[252:255], v[156:159], v[188:191]
    s_cbranch_scc1 p3mloop_211
    s_branch gx_189
pub_193:
    s_nop 1
    s_waitcnt vmcnt(0)
    buffer_wbl2 sc1
    s_waitcnt vmcnt(0)
    buffer_store_dword v22, v21, s[4:7], s60 offen sc1
    s_branch pubr_194
slow_191:
    s_cselect_b32 s28, 1, 0
    s_waitcnt vmcnt(0)
    v_sub_u32_e64 v22, 64, s80
    s_bitcmp1_b32 s20, 0
    s_cbranch_scc1 pub_193
pubr_194:
    buffer_store_dword v22, v21, s[4:7], s61 offen
    s_mov_b32 s29, 0
spin_195:
    buffer_load_dwordx4 v[24:27], v20, s[4:7], s79 offen sc1
    s_waitcnt vmcnt(0)
    v_max3_u32 v28, v24, v25, v26
    v_max_u32 v28, v28, v27
    v_add_u32 v29, s78, v23
    v_cmp_lt_u32 vcc, v29, v28
    s_nop 1
    s_cbranch_vccz spind_196
    s_sleep 3
    s_add_u32 s29, s29, 1
    s_cmp_lt_u32 s29, 20000
    s_cbranch_scc1 spin_195
    s_mov_b32 s29, 32
    s_branch L_fail
spind_196:
    s_bitcmp1_b32 s20, 0
    s_cbranch_scc0 acq_197
    buffer_inv sc1
    s_waitcnt vmcnt(0)
acq_197:
    s_cmp_lg_u32 s28, 0
    s_branch ret_192
pub_202:
    s_nop 1
    s_waitcnt vmcnt(0)
    buffer_wbl2 sc1
    s_waitcnt vmcnt(0)
    buffer_store_dword v22, v21, s[4:7], s60 offen sc1
    s_branch pubr_203
slow_200:
    s_cselect_b32 s28, 1, 0
    s_waitcnt vmcnt(0)
    v_sub_u32_e64 v22, 64, s80
    s_bitcmp1_b32 s20, 0
    s_cbranch_scc1 pub_202
pubr_203:
    buffer_store_dword v22, v21, s[4:7], s61 offen
    s_mov_b32 s29, 0
spin_204:
    buffer_load_dwordx4 v[24:27], v20, s[4:7], s79 offen sc1
    s_waitcnt vmcnt(0)
    v_max3_u32 v28, v24, v25, v26
    v_max_u32 v28, v28, v27
    v_add_u32 v29, s78, v23
    v_cmp_lt_u32 vcc, v29, v28
    s_nop 1
    s_cbranch_vccz spind_205
    s_sleep 3
    s_add_u32 s29, s29, 1
    s_cmp_lt_u32 s29, 20000
    s_cbranch_scc1 spin_204
    s_mov_b32 s29, 32
    s_branch L_fail
spind_205:
    s_bitcmp1_b32 s20, 0
    s_cbranch_scc0 acq_206
    buffer_inv sc1
    s_waitcnt vmcnt(0)
acq_206:
    s_cmp_lg_u32 s28, 0
    s_branch ret_201
pub_215:
    s_nop 1
    s_waitcnt vmcnt(0)
    buffer_wbl2 sc1
    s_waitcnt vmcnt(0)
    buffer_store_dword v22, v21, s[4:7], s60 offen sc1
    s_branch pubr_216
late_212:
    s_nop 3
    s_cselect_b32 s28, 1, 0
    s_waitcnt vmcnt(8)
    v_max3_u32 v28, v24, v25, v26
    v_max3_u32 v28, v28, v27, s20
    v_add_u32 v29, s78, v23
    v_cmp_lt_u32 vcc, v29, v28
    s_nop 1
    s_cbranch_vccz lgo_214
    s_waitcnt vmcnt(0)
    v_sub_u32_e64 v22, 64, s80
    s_bitcmp1_b32 s20, 0
    s_cbranch_scc1 pub_215
pubr_216:
    buffer_store_dword v22, v21, s[4:7], s61 offen
    s_mov_b32 s70, s80
    s_mov_b32 s29, 0
spin_217:
    buffer_load_dwordx4 v[24:27], v20, s[4:7], s79 offen sc1
    s_waitcnt vmcnt(0)
    v_max3_u32 v28, v24, v25, v26
    v_max_u32 v28, v28, v27
    v_add_u32 v29, s78, v23
    v_cmp_lt_u32 vcc, v29, v28
    s_nop 1
    s_cbranch_vccz spind_218
    s_sleep 3
    s_add_u32 s29, s29, 1
    s_cmp_lt_u32 s29, 20000
    s_cbranch_scc1 spin_217
    s_mov_b32 s29, 32
    s_branch L_fail
spind_218:
lgo_214:
    s_bitcmp1_b32 s20, 0
    s_cbranch_scc0 acq_219
    buffer_inv sc1
    s_waitcnt vmcnt(0)
acq_219:
    s_mov_b32 s76, s75
    s_mov_b32 s71, s81
    s_add_u32 m0, s65, 0
    s_nop 0
    buffer_load_dwordx4 v2, s[4:7], s76 offen offset:0 sc1 lds
    buffer_load_dwordx4 v2, s[4:7], s76 offen offset:1024 sc1 lds
    buffer_load_dwordx4 v2, s[4:7], s76 offen offset:2048 sc1 lds
    buffer_load_dwordx4 v2, s[4:7], s76 offen offset:3072 sc1 lds
    s_add_u32 m0, s65, 4096
    s_nop 0
    buffer_load_dwordx4 v3, s[4:7], s76 offen offset:0 sc1 lds
    buffer_load_dwordx4 v[38:41], v2, s[4:7], s71 offen sc1
    buffer_load_dwordx2 v[42:43], v74, s[4:7], s71 offen offset:1024 sc1
    v_cmp_eq_u32 vcc, v1, v1
    s_cmp_lg_u32 s28, 0
    s_branch later_213
sw_222:
    s_waitcnt vmcnt(2)
    s_branch swr_223
syw_224:
    s_mov_b32 s29, 0
sys_226:
    ds_read_b32 v16, v14
    s_waitcnt lgkmcnt(0)
    v_readfirstlane_b32 s67, v16
    s_nop 0
    s_cmp_lt_u32 s67, s73
    s_cbranch_scc0 syd_227
    s_add_u32 s29, s29, 1
    s_cmp_lt_u32 s29, 160000
    s_cbranch_scc1 sys_226
    s_mov_b32 s29, 35
    s_branch L_fail
syd_227:
    s_branch syr_225
syw_228:
    s_mov_b32 s29, 0
sys_230:
    ds_read_b32 v16, v14
    s_waitcnt lgkmcnt(0)
    v_readfirstlane_b32 s67, v16
    s_nop 0
    s_cmp_lt_u32 s67, s73
    s_cbranch_scc0 syd_231
    s_add_u32 s29, s29, 1
    s_cmp_lt_u32 s29, 160000
    s_cbranch_scc1 sys_230
    s_mov_b32 s29, 35
    s_branch L_fail
syd_231:
    s_branch syr_229
pub_235:
    s_nop 1
    s_waitcnt vmcnt(0)
    buffer_wbl2 sc1
    s_waitcnt vmcnt(0)
    buffer_store_dword v22, v21, s[4:7], s60 offen sc1
    s_branch pubr_236
late_232:
    s_nop 3
    s_cselect_b32 s28, 1, 0
    s_waitcnt vmcnt(8)
    v_max3_u32 v28, v24, v25, v26
    v_max3_u32 v28, v28, v27, s20
    v_add_u32 v29, s78, v23
    v_cmp_lt_u32 vcc, v29, v28
    s_nop 1
    s_cbranch_vccz lgo_234
    s_waitcnt vmcnt(0)
    v_sub_u32_e64 v22, 64, s80
    s_bitcmp1_b32 s20, 0
    s_cbranch_scc1 pub_235
pubr_236:
    buffer_store_dword v22, v21, s[4:7], s61 offen
    s_mov_b32 s70, s80
    s_mov_b32 s29, 0
spin_237:
    buffer_load_dwordx4 v[24:27], v20, s[4:7], s79 offen sc1
    s_waitcnt vmcnt(0)
    v_max3_u32 v28, v24, v25, v26
    v_max_u32 v28, v28, v27
    v_add_u32 v29, s78, v23
    v_cmp_lt_u32 vcc, v29, v28
    s_nop 1
    s_cbranch_vccz spind_238
    s_sleep 3
    s_add_u32 s29, s29, 1
    s_cmp_lt_u32 s29, 20000
    s_cbranch_scc1 spin_237
    s_mov_b32 s29, 32
    s_branch L_fail
spind_238:
lgo_234:
    s_bitcmp1_b32 s20, 0
    s_cbranch_scc0 acq_239
    buffer_inv sc1
    s_waitcnt vmcnt(0)
acq_239:
    s_mov_b32 s76, s75
    s_mov_b32 s71, s81
    s_add_u32 m0, s65, 0
    s_nop 0
    buffer_load_dwordx4 v2, s[4:7], s76 offen offset:0 sc1 lds
    buffer_load_dwordx4 v2, s[4:7], s76 offen offset:1024 sc1 lds
    buffer_load_dwordx4 v2, s[4:7], s76 offen offset:2048 sc1 lds
    buffer_load_dwordx4 v2, s[4:7], s76 offen offset:3072 sc1 lds
    s_add_u32 m0, s65, 4096
    s_nop 0
    buffer_load_dwordx4 v3, s[4:7], s76 offen offset:0 sc1 lds
    buffer_load_dwordx4 v[38:41], v2, s[4:7], s71 offen sc1
    buffer_load_dwordx2 v[42:43], v74, s[4:7], s71 offen offset:1024 sc1
    v_cmp_eq_u32 vcc, v1, v1
    s_cmp_lg_u32 s28, 0
    s_branch later_233
sw_242:
    s_waitcnt vmcnt(2)
    s_branch swr_243
syw_244:
    s_mov_b32 s29, 0
sys_246:
    ds_read_b32 v16, v14
    s_waitcnt lgkmcnt(0)
    v_readfirstlane_b32 s67, v16
    s_nop 0
    s_cmp_lt_u32 s67, s73
    s_cbranch_scc0 syd_247
    s_add_u32 s29, s29, 1
    s_cmp_lt_u32 s29, 160000
    s_cbranch_scc1 sys_246
    s_mov_b32 s29, 35
    s_branch L_fail
syd_247:
    s_branch syr_245
syw_248:
    s_mov_b32 s29, 0
sys_250:
    ds_read_b32 v16, v14
    s_waitcnt lgkmcnt(0)
    v_readfirstlane_b32 s67, v16
    s_nop 0
    s_cmp_lt_u32 s67, s73
    s_cbranch_scc0 syd_251
    s_add_u32 s29, s29, 1
    s_cmp_lt_u32 s29, 160000
    s_cbranch_scc1 sys_250
    s_mov_b32 s29, 35
    s_branch L_fail
syd_251:
    s_branch syr_249
pub_254:
    s_nop 1
    s_waitcnt vmcnt(0)
    buffer_wbl2 sc1
    s_waitcnt vmcnt(0)
    buffer_store_dword v22, v21, s[4:7], s60 offen sc1
    s_branch pubr_255
E_p3:
    s_endpgm
L_fail:
    s_mov_b64 exec, 1
    v_mov_b32 v2, 16
    s_lshl_b32 s25, s2, 8
    s_or_b32 s25, s25, s29
    v_mov_b32 v3, s25
    buffer_store_dword v3, v2, s[16:19], 0 offen
L_end:
    s_endpgm
.section .rodata,"a"
.p2align 6
.amdhsa_kernel interleave_layers__sliding_local_dilated__glu_gated_bilinear__prompt_kernel
  .amdhsa_next_free_vgpr 512
  .amdhsa_next_free_sgpr 102
  .amdhsa_accum_offset 256
  .amdhsa_group_segment_fixed_size 0
  .amdhsa_kernarg_size 80
  .amdhsa_user_sgpr_count 2
  .amdhsa_user_sgpr_kernarg_segment_ptr 1
  .amdhsa_system_sgpr_workgroup_id_x 1
.end_amdhsa_kernel
```
